```python
import torch

def _softmax(x, axis=-1):
    return torch.softmax(x, dim=axis)

def _gelu(x):
    return torch.nn.functional.gelu(x, approximate='tanh')

def _silu(x):
    return torch.nn.functional.silu(x)

def _sigmoid(x):
    return torch.sigmoid(x)

def _layernorm(x, axis=-1, eps=1e-05):
    m = x.mean(dim=axis, keepdim=True)
    v = x.var(dim=axis, keepdim=True, unbiased=False)
    return (x - m) / torch.sqrt(v + eps)

def _scatter_add(tgt, idx, src, axis=0):
    return tgt.clone().index_add_(axis, idx, src)

def _segment_sum(src, seg, n):
    out = torch.zeros((n,) + src.shape[1:], dtype=src.dtype)
    return out.index_add_(0, seg, src)

def _pad(x, pw):
    flat = tuple((v for pair in reversed(pw) for v in pair))
    return torch.nn.functional.pad(x, flat)
kernel_name = 'adaLN_cond__ssm_conv_s4d__mixer_gmlp__prompt'

def setup_inputs():

    _w = lambda a: (lambda t: t.to(torch.bfloat16) if t.is_floating_point() else t)(torch.as_tensor(a))

    def _A_setup():
        Bsz, L, D, N = (1, 2048, 512, 128)
        return {'u': _w((lambda *s: torch.randn(*s, dtype=torch.bfloat16) * 0.05)(Bsz, L, D)), 'log_A_real': _w((lambda *s: torch.randn(*s, dtype=torch.bfloat16) * 3.2)(D, N) * 0.5), 'A_imag': _w((lambda *s: torch.randn(*s, dtype=torch.bfloat16) * 0.1)(D, N) * 3.14), 'C_real': _w((lambda *s: torch.randn(*s, dtype=torch.bfloat16) * 0.4)(D, N) / N ** 0.5), 'C_imag': _w((lambda *s: torch.randn(*s, dtype=torch.bfloat16) * 0.4)(D, N) / N ** 0.5), 'log_dt': _w((lambda *s: torch.randn(*s, dtype=torch.bfloat16) * 0.1)(D) * 0.5 - 4.0), 'D_skip': _w((lambda *s: torch.randn(*s, dtype=torch.bfloat16) * 0.1)(D))}
    _A_in = _A_setup()

    def _B_setup():
        B, S, D, F = (1, 2048, 512, 1792)
        Fh = F // 2
        return {'x': _w((lambda *s: torch.randn(*s, dtype=torch.bfloat16) * 0.05)(B, S, D)), 'w_in': _w((lambda *s: torch.randn(*s, dtype=torch.bfloat16) * 0.2)(D, 2 * Fh)), 'w_sp': _w(0.01 * (lambda *s: torch.randn(*s, dtype=torch.bfloat16) * 0.2)(S, S)), 'b_sp': _w(1.0 + 0.01 * (lambda *s: torch.randn(*s, dtype=torch.bfloat16) * 0.05)(S)), 'w_out': _w((lambda *s: torch.randn(*s, dtype=torch.bfloat16) * 0.05)(Fh, D))}
    _B_in = _B_setup()
    return {'A_u': _A_in['u'], 'A_log_A_real': _A_in['log_A_real'], 'A_A_imag': _A_in['A_imag'], 'A_C_real': _A_in['C_real'], 'A_C_imag': _A_in['C_imag'], 'A_log_dt': _A_in['log_dt'], 'A_D_skip': _A_in['D_skip'], 'B_x': _B_in['x'], 'B_w_in': _B_in['w_in'], 'B_w_sp': _B_in['w_sp'], 'B_b_sp': _B_in['b_sp'], 'B_w_out': _B_in['w_out'], 'c': _w((lambda *s: torch.randn(*s, dtype=torch.bfloat16) * 0.1)(1, 512) * 8.0), 'w_mod': _w((lambda *s: torch.randn(*s, dtype=torch.bfloat16) * 0.1)(512, 6 * 512) * 512 ** (-0.5) * 8.0)}

def reference(A_u, A_log_A_real, A_A_imag, A_C_real, A_C_imag, A_log_dt, A_D_skip, B_x, B_w_in, B_w_sp, B_b_sp, B_w_out, c, w_mod):

    def _A_ref(u, log_A_real, A_imag, C_real, C_imag, log_dt, D_skip):
        L = u.shape[1]
        dt = torch.exp(log_dt)
        A = -torch.exp(log_A_real) + 1j * A_imag
        C = (C_real + 1j * C_imag) * dt[:, None]
        pos = (lambda x, dt: x.to(dt))(torch.arange(L), log_dt.dtype)
        P = torch.exp((A * dt[:, None])[:, :, None] * pos[None, None, :])
        K = 2.0 * torch.einsum('dn,dnl->dl', C, P).real
        L2 = 2 * L
        u_t = (lambda x, *d: x.permute(*d))(u, 0, 2, 1)
        Kf = (lambda x, *a, **k: torch.fft.rfft(x.float(), *a, **k))(K, L2)
        Uf = (lambda x, *a, **k: torch.fft.rfft(x.float(), *a, **k))(u_t, L2)
        y = (lambda x, *a, **k: torch.fft.irfft(x, *a, **k).to(torch.bfloat16))(Uf * Kf[None, :, :], L2)[:, :, :L]
        y = (lambda x, *d: x.permute(*d))(y, 0, 2, 1)
        return y + u * D_skip[None, None, :]

    def _B_ref(x, w_in, w_sp, b_sp, w_out):
        B, S, D = x.shape
        F = w_in.shape[-1]
        Fh = F // 2
        z = _gelu(torch.einsum('bsd,df->bsf', x, w_in))
        z1 = z[..., :Fh].clone()
        z2 = _layernorm(z[..., Fh:], axis=-1)
        g = torch.einsum('ts,bsf->btf', w_sp, z2) + b_sp[None, :, None]
        return torch.einsum('bsf,fd->bsd', z1 * g, w_out)
    x = A_u
    mod = (_silu(c) @ w_mod).reshape(c.shape[0], 6, 1, -1)
    sa, ca, ga, sb, cb, gb = (mod[:, 0].clone(), mod[:, 1].clone(), mod[:, 2].clone(), mod[:, 3].clone(), mod[:, 4].clone(), mod[:, 5].clone())
    h = _layernorm(x, axis=-1) * (1 + ca) + sa
    x = x + ga * _A_ref(h, A_log_A_real, A_A_imag, A_C_real, A_C_imag, A_log_dt, A_D_skip)
    h = _layernorm(x, axis=-1) * (1 + cb) + sb
    x = x + gb * _B_ref(h, B_w_in, B_w_sp, B_b_sp, B_w_out)
    return x
```

```asm
; @launch grid=(256,1,1) block=(256,1,1) lds=163840
.amdgcn_target "amdgcn-amd-amdhsa--gfx950"
.text
.globl adaLN_cond__ssm_conv_s4d__mixer_gmlp__prompt_kernel
.p2align 8
.type adaLN_cond__ssm_conv_s4d__mixer_gmlp__prompt_kernel,@function
adaLN_cond__ssm_conv_s4d__mixer_gmlp__prompt_kernel:
    s_cmp_ge_u32 s2, 256
    s_cbranch_scc1 adaLN_cond__ssm_conv_s4d__mixer_gmlp__prompt_kernel_end1
    s_nop 0
    s_load_dwordx16 s[16:31], s[0:1], 0
    s_load_dwordx16 s[32:47], s[0:1], 64
    s_load_dwordx2 s[48:49], s[0:1], 128
    s_and_b32 s3, s2, 7
    s_lshr_b32 s50, s2, 3
    s_getpc_b64 s[86:87]
adaLN_cond__ssm_conv_s4d__mixer_gmlp__prompt_kernel_pc2:
    s_lshl_b32 s57, s50, 11
    v_lshl_add_u32 v4, v0, 3, s57
    v_min_u32 v4, adaLN_cond__ssm_conv_s4d__mixer_gmlp__prompt_kernel_end1-adaLN_cond__ssm_conv_s4d__mixer_gmlp__prompt_kernel_pc2-4, v4
    v_and_b32 v4, 0xfffffffc, v4
    v_mov_b32 v185, s87
    v_add_co_u32 v184, vcc, s86, v4
    v_lshrrev_b32 v4, 6, v0
    v_and_b32 v1, 63, v0
    v_addc_co_u32 v185, vcc, 0, v185, vcc
    global_load_dwordx2 v[186:187], v[184:185], off
    v_readfirstlane_b32 s52, v4
    s_lshl_b32 s51, s3, 5
    s_or_b32 s51, s51, s50
    s_lshl_b32 s55, s51, 1
    v_and_b32_e64 v2, 15, v0
    v_bfe_u32 v3, v0, 4, 2
    v_bfe_u32 v4, v0, 7, 1
    v_bfe_u32 v5, v0, 5, 2
    v_lshl_add_u32 v4, v4, 3, v5
    v_and_b32 v5, 31, v0
    v_lshlrev_b32 v5, 4, v5
    v_lshl_add_u32 v18, v4, 10, v5
    s_lshr_b32 s57, s51, 2
    s_lshl_b32 s57, s57, 15
    s_and_b32 s58, s51, 1
    s_lshl_b32 s58, s58, 14
    s_or_b32 s57, s57, s58
    s_and_b32 s58, s51, 2
    s_lshl_b32 s58, s58, 11
    s_or_b32 s57, s57, s58
    v_lshlrev_b32 v20, 2, v0
    v_lshlrev_b32 v6, 1, v0
    v_lshlrev_b32 v26, 4, v0
    v_lshrrev_b32 v4, 3, v1
    v_and_b32 v5, 6, v4
    v_xor_b32 v5, v5, v1
    v_and_b32 v5, 7, v5
    v_lshlrev_b32_e64 v5, 4, v5
    s_movk_i32 s58, 6144
    v_mad_u32_u24 v17, v4, s58, v5
    s_lshr_b32 s78, s3, 2
    s_mul_i32 s78, s78, 24
    s_add_u32 s78, s78, s50
    s_lshl_b32 s78, s78, 2
    s_and_b32 s59, s3, 3
    s_or_b32 s78, s78, s59
    s_and_b32 s59, s78, 3
    s_lshl_b32 s84, s59, 8
    s_lshl_b32 s59, s59, 2
    s_add_u32 s59, s59, s52
    s_mul_i32 s59, s59, 196608
    s_lshr_b32 s60, s78, 2
    s_lshl_b32 s60, s60, 7
    s_add_u32 s59, s59, s60
    v_lshlrev_b32_e64 v7, 2, v1
    s_cmp_lt_u32 s50, 24
    s_cselect_b32 s59, s59, 1073741824
    s_lshl_b32 s69, s52, 12
    s_lshl_b32 s58, s55, 8
    s_waitcnt lgkmcnt(0)
    s_mov_b32 s8, s16
    s_mov_b32 s9, s17
    s_mov_b32 s10, 0x200000
    s_mov_b32 s11, 0x20000
    buffer_load_dwordx4 v[188:191], v18, s[8:11], s57 offen
    buffer_load_dwordx4 v[192:195], v18, s[8:11], s57 offen offset:512
    s_mov_b32 s12, s40
    s_mov_b32 s13, s41
    s_mov_b32 s14, 0x400
    s_mov_b32 s15, 0x20000
    buffer_load_dword v19, v7, s[12:15], s84 offen
    s_mov_b32 s12, s18
    s_mov_b32 s13, s19
    s_mov_b32 s14, 0x20000
    s_mov_b32 s15, 0x20000
    buffer_load_ushort v22, v6, s[12:15], s58 offen
    s_mov_b32 s8, s20
    s_mov_b32 s9, s21
    s_mov_b32 s10, 0x20000
    s_mov_b32 s11, 0x20000
    buffer_load_ushort v23, v6, s[8:11], s58 offen
    s_mov_b32 s12, s22
    s_mov_b32 s13, s23
    s_mov_b32 s14, 0x20000
    s_mov_b32 s15, 0x20000
    buffer_load_ushort v24, v6, s[12:15], s58 offen
    s_mov_b32 s8, s24
    s_mov_b32 s9, s25
    s_mov_b32 s10, 0x20000
    s_mov_b32 s11, 0x20000
    buffer_load_ushort v25, v6, s[8:11], s58 offen
    s_mov_b32 s8, s42
    s_mov_b32 s9, s43
    s_mov_b32 s10, 0x300000
    s_mov_b32 s11, 0x20000
    s_add_u32 m0, s69, 105536
    s_nop 0
    s_nop 0
    buffer_load_dwordx4 v17, s[8:11], s59 offen offset:0  lds
    s_add_u32 m0, s69, 106560
    s_add_u32 s59, s59, 49152
    buffer_load_dwordx4 v17, s[8:11], s59 offen offset:0  lds
    s_add_u32 m0, s69, 107584
    s_add_u32 s59, s59, 49152
    buffer_load_dwordx4 v17, s[8:11], s59 offen offset:0  lds
    s_add_u32 m0, s69, 108608
    s_add_u32 s59, s59, 49152
    buffer_load_dwordx4 v17, s[8:11], s59 offen offset:0  lds
    s_mov_b32 s4, s48
    s_mov_b32 s5, s49
    s_mov_b32 s6, 0x2000000
    s_mov_b32 s7, 0x20000
    s_sub_u32 s72, s34, 4096
    s_subb_u32 s73, s35, 0
    s_mov_b32 s74, 8392704
    s_mov_b32 s75, 0x20000
    s_mov_b32 s12, s32
    s_mov_b32 s13, s33
    s_mov_b32 s14, 0x1c0000
    s_mov_b32 s15, 0x20000
    s_lshr_b32 s57, s3, 1
    s_lshl_b32 s57, s57, 3
    s_lshr_b32 s53, s50, 2
    s_or_b32 s53, s53, s57
    s_and_b32 s57, s3, 1
    s_lshl_b32 s57, s57, 2
    s_and_b32 s54, s50, 3
    s_or_b32 s54, s54, s57
    s_lshr_b32 s76, s52, 1
    s_and_b32 s77, s52, 1
    s_add_u32 s94, s52, s53
    s_and_b32 s94, s94, 3
    s_lshr_b32 s79, s3, 2
    s_mul_i32 s79, s79, 14
    s_add_u32 s79, s79, s50
    s_sub_u32 s79, s79, 18
    s_lshl_b32 s79, s79, 2
    s_and_b32 s59, s3, 3
    s_or_b32 s79, s79, s59
    s_and_b32 s31, s79, 3
    s_lshl_b32 s31, s31, 2
    s_add_u32 s31, s31, s52
    s_mul_i32 s31, s31, 114688
    s_lshr_b32 s60, s79, 2
    s_lshl_b32 s60, s60, 7
    s_add_u32 s31, s31, s60
    s_cmp_ge_u32 s50, 18
    s_cselect_b32 s31, s31, 1073741824
    s_movk_i32 s58, 3584
    v_mad_u32_u24 v17, v4, s58, v5
    s_and_b32 s60, s78, 3
    s_mul_i32 s60, s60, 12288
    s_lshr_b32 s58, s78, 2
    s_lshl_b32 s58, s58, 8
    s_add_u32 s60, s60, s58
    s_lshl_b32 s58, s52, 6
    s_add_u32 s60, s60, s58
    s_add_u32 s60, s60, 393216
    s_cmp_lt_u32 s50, 24
    s_cselect_b32 s78, s60, 1073741824
    v_bfe_u32 v4, v1, 3, 2
    v_xor_b32 v4, s52, v4
    v_lshlrev_b32 v4, 5, v4
    v_lshrrev_b32 v5, 2, v1
    v_lshl_add_u32 v4, v5, 7, v4
    v_and_b32_e64 v5, 3, v1
    v_lshl_add_u32 v105, v5, 3, v4
    v_bfe_u32 v4, v1, 3, 2
    v_bfe_u32 v5, v1, 3, 1
    v_bfe_u32 v6, v1, 4, 1
    v_and_b32 v5, v5, v6
    v_add_u32 v4, v4, v5
    v_bfe_u32 v5, v1, 2, 1
    v_lshl_add_u32 v4, v4, 9, v5
    v_add_u32 v4, s55, v4
    v_and_b32_e64 v5, 3, v1
    s_movk_i32 s57, 3072
    v_mad_u32_u24 v4, v5, s57, v4
    v_lshlrev_b32_e64 v106, 2, v4
    v_bfe_u32 v4, v1, 2, 1
    v_sub_u32 v4, 4, v4
    v_lshlrev_b32_e64 v4, 11, v4
    s_movk_i32 s57, 12288
    v_mad_u32_u24 v4, v5, s57, v4
    v_lshrrev_b32_e64 v5, 3, v1
    v_lshl_add_u32 v4, v5, 4, v4
    s_and_b32 s57, s79, 3
    s_lshl_b32 s57, s57, 2
    s_add_u32 s57, s57, s52
    s_lshl_b32 s57, s57, 7
    v_add_u32 v107, s57, v4
    v_lshrrev_b32 v4, 5, v0
    s_movk_i32 s57, 2112
    v_and_b32 v5, 31, v0
    v_lshlrev_b32_e64 v5, 5, v5
    v_mad_u32_u24 v34, v4, s57, v5
    v_add_u32 v34, 88128, v34
    v_bfe_u32 v4, v0, 2, 2
    v_lshrrev_b32 v5, 4, v0
    v_lshlrev_b32 v5, 5, v5
    v_mad_u32_u24 v4, v4, s57, v5
    v_and_b32_e64 v5, 3, v0
    v_lshl_add_u32 v4, v5, 3, v4
    v_add_u32 v35, 88128, v4
    v_lshrrev_b32_e64 v4, 5, v1
    v_bfe_u32 v5, v1, 3, 2
    v_lshl_add_u32 v4, v4, 3, v5
    v_lshlrev_b32 v4, 12, v4
    v_xor_b32 v5, v3, v1
    v_and_b32_e64 v5, 7, v5
    v_lshl_add_u32 v4, v5, 4, v4
    v_add_u32 v8, 4096, v4
    v_add_u32 v10, 2176, v4
    v_xor_b32_e64 v4, 64, v4
    v_add_u32 v9, 68608, v4
    v_add_u32 v11, 66688, v4
    v_lshrrev_b32 v4, 1, v2
    v_xor_b32 v4, v4, v3
    v_lshlrev_b32_e64 v4, 4, v4
    v_lshl_add_u32 v12, v2, 7, v4
    v_xor_b32_e64 v13, 64, v12
    s_lshl_b32 s59, s53, 18
    s_lshl_b32 s60, s52, 10
    s_add_u32 s59, s59, s60
    s_add_u32 s57, s52, s54
    s_add_u32 s57, s57, 0
    s_and_b32 s58, s57, 2
    s_lshl_b32 s58, s58, 16
    s_and_b32 s57, s57, 1
    s_lshl_b32 s57, s57, 14
    s_add_u32 s57, s57, s58
    s_add_u32 s61, s57, s59
    s_add_u32 s57, s52, s54
    s_add_u32 s57, s57, 1
    s_and_b32 s58, s57, 2
    s_lshl_b32 s58, s58, 16
    s_and_b32 s57, s57, 1
    s_lshl_b32 s57, s57, 14
    s_add_u32 s57, s57, s58
    s_add_u32 s64, s57, s59
    s_add_u32 s57, s52, s54
    s_add_u32 s57, s57, 2
    s_and_b32 s58, s57, 2
    s_lshl_b32 s58, s58, 16
    s_and_b32 s57, s57, 1
    s_lshl_b32 s57, s57, 14
    s_add_u32 s57, s57, s58
    s_add_u32 s65, s57, s59
    s_add_u32 s57, s52, s54
    s_add_u32 s57, s57, 3
    s_and_b32 s58, s57, 2
    s_lshl_b32 s58, s58, 16
    s_and_b32 s57, s57, 1
    s_lshl_b32 s57, s57, 14
    s_add_u32 s57, s57, s58
    s_add_u32 s66, s57, s59
    s_lshl_b32 s57, s52, 13
    s_add_u32 s80, s57, 88128
    s_add_u32 s82, s57, 52224
    s_add_u32 s81, s69, 145536
    s_mul_i32 s83, s52, 10240
    s_add_u32 s83, s83, 86080
    s_lshl_b32 s57, s77, 10
    s_sub_u32 s57, 2047, s57
    v_lshlrev_b32 v4, 1, v1
    v_sub_u32 v4, s57, v4
    v_cvt_f32_u32 v128, v4
    s_mul_i32 s58, s76, 1344
    s_add_u32 s59, s58, 122952
    s_add_u32 s58, s58, 88904
    v_add_f32_e64 v129, -1.0, v128
    v_add_f32 v124, 0x80000000, v128
    v_add_f32 v125, 0x80000000, v129
    v_add_f32_e64 v126, 0xbf800000, v129
    v_cvt_pk_bf16_f32 v6, v124, v125
    v_cvt_pk_bf16_f32 v7, v126, v126
    v_mad_u32_u16 v64, v6, 2, s58
    v_mad_u32_u16 v65, v6, 2, s58 op_sel:[1,0,0,0]
    v_mad_u32_u16 v66, v7, 2, s58
    v_add_f32 v124, 0xc3000000, v128
    v_add_f32 v125, 0xc3000000, v129
    v_add_f32 v126, 0xc3010000, v129
    v_cvt_pk_bf16_f32 v6, v124, v125
    v_cvt_pk_bf16_f32 v7, v126, v126
    v_mad_u32_u16 v67, v6, 2, s58
    v_mad_u32_u16 v68, v6, 2, s58 op_sel:[1,0,0,0]
    v_mad_u32_u16 v69, v7, 2, s58
    v_add_f32 v124, 0xc3800000, v128
    v_add_f32 v125, 0xc3800000, v129
    v_add_f32 v126, 0xc3808000, v129
    v_cvt_pk_bf16_f32 v6, v124, v125
    v_cvt_pk_bf16_f32 v7, v126, v126
    v_mad_u32_u16 v70, v6, 2, s58
    v_mad_u32_u16 v71, v6, 2, s58 op_sel:[1,0,0,0]
    v_mad_u32_u16 v72, v7, 2, s58
    v_add_f32 v124, 0xc3c00000, v128
    v_add_f32 v125, 0xc3c00000, v129
    v_add_f32 v126, 0xc3c08000, v129
    v_cvt_pk_bf16_f32 v6, v124, v125
    v_cvt_pk_bf16_f32 v7, v126, v126
    v_mad_u32_u16 v73, v6, 2, s58
    v_mad_u32_u16 v74, v6, 2, s58 op_sel:[1,0,0,0]
    v_mad_u32_u16 v75, v7, 2, s58
    v_add_f32 v124, 0xc4000000, v128
    v_add_f32 v125, 0xc4000000, v129
    v_add_f32 v126, 0xc4004000, v129
    v_cvt_pk_bf16_f32 v6, v124, v125
    v_cvt_pk_bf16_f32 v7, v126, v126
    v_mad_u32_u16 v76, v6, 2, s58
    v_mad_u32_u16 v77, v6, 2, s58 op_sel:[1,0,0,0]
    v_mad_u32_u16 v78, v7, 2, s58
    v_add_f32 v124, 0xc4200000, v128
    v_add_f32 v125, 0xc4200000, v129
    v_add_f32 v126, 0xc4204000, v129
    v_cvt_pk_bf16_f32 v6, v124, v125
    v_cvt_pk_bf16_f32 v7, v126, v126
    v_mad_u32_u16 v79, v6, 2, s58
    v_mad_u32_u16 v80, v6, 2, s58 op_sel:[1,0,0,0]
    v_mad_u32_u16 v81, v7, 2, s58
    v_add_f32 v124, 0xc4400000, v128
    v_add_f32 v125, 0xc4400000, v129
    v_add_f32 v126, 0xc4404000, v129
    v_cvt_pk_bf16_f32 v6, v124, v125
    v_cvt_pk_bf16_f32 v7, v126, v126
    v_mad_u32_u16 v82, v6, 2, s58
    v_mad_u32_u16 v83, v6, 2, s58 op_sel:[1,0,0,0]
    v_mad_u32_u16 v84, v7, 2, s58
    v_add_f32 v124, 0xc4600000, v128
    v_add_f32 v125, 0xc4600000, v129
    v_add_f32 v126, 0xc4604000, v129
    v_cvt_pk_bf16_f32 v6, v124, v125
    v_cvt_pk_bf16_f32 v7, v126, v126
    v_mad_u32_u16 v85, v6, 2, s58
    v_mad_u32_u16 v86, v6, 2, s58 op_sel:[1,0,0,0]
    v_mad_u32_u16 v87, v7, 2, s58
    s_cmp_eq_u32 s77, 1
    s_cselect_b64 exec, -1, 0
    v_lshl_add_u32 v4, v4, 1, s59
    v_add_u32 v82, -1536, v4
    v_add_u32 v83, -1538, v4
    v_add_u32 v84, -1540, v4
    v_add_u32 v85, -1792, v4
    v_add_u32 v86, -1794, v4
    v_add_u32 v87, -1796, v4
    s_mov_b64 exec, -1
    s_mul_i32 s59, s76, 41472
    v_lshl_add_u32 v7, v3, 4, s59
    s_lshl_b32 s57, s77, 1
    s_add_u32 s57, s57, 0
    v_lshlrev_b32 v4, s57, v2
    v_lshrrev_b32 v5, 1, v4
    v_add_u32 v5, 8, v5
    v_lshrrev_b32 v6, 2, v4
    v_add_u32 v6, 16, v6
    v_min3_u32 v5, v4, v5, v6
    v_lshrrev_b32 v6, 3, v4
    v_add_u32 v6, 24, v6
    v_min_u32 v5, v5, v6
    v_and_b32 v6, 7, v5
    v_lshlrev_b32_e64 v6, 5, v6
    v_lshl_add_u32 v5, v5, 9, v7
    v_xor_b32 v236, v5, v6
    v_xor_b32 v237, 64, v236
    v_xor_b32 v238, 128, v236
    v_xor_b32 v239, 192, v236
    s_lshl_b32 s58, s57, 3
    s_add_u32 s58, s58, 8
    s_cmp_eq_u32 s57, 0
    s_cselect_b32 s58, 0, s58
    v_add_u32 v5, s58, v2
    v_min_u32 v5, 40, v5
    v_add_u32 v5, 40, v5
    v_and_b32 v6, 7, v5
    v_lshlrev_b32_e64 v6, 5, v6
    v_lshl_add_u32 v5, v5, 9, v7
    v_xor_b32 v244, v5, v6
    v_xor_b32 v245, 64, v244
    v_xor_b32 v246, 128, v244
    v_xor_b32 v247, 192, v244
    s_lshl_b32 s58, s58, 5
    s_mul_i32 s59, s76, 1344
    s_add_u32 s58, s58, s59
    s_add_u32 s58, s58, 122952
    v_lshlrev_b32_e64 v5, 5, v2
    v_lshl_add_u32 v5, v3, 3, v5
    v_add_u32 v32, s58, v5
    s_lshl_b32 s57, s77, 1
    s_add_u32 s57, s57, 1
    v_lshlrev_b32 v4, s57, v2
    v_lshrrev_b32 v5, 1, v4
    v_add_u32 v5, 8, v5
    v_lshrrev_b32 v6, 2, v4
    v_add_u32 v6, 16, v6
    v_min3_u32 v5, v4, v5, v6
    v_lshrrev_b32 v6, 3, v4
    v_add_u32 v6, 24, v6
    v_min_u32 v5, v5, v6
    v_and_b32 v6, 7, v5
    v_lshlrev_b32_e64 v6, 5, v6
    v_lshl_add_u32 v5, v5, 9, v7
    v_xor_b32 v240, v5, v6
    v_xor_b32 v241, 64, v240
    v_xor_b32 v242, 128, v240
    v_xor_b32 v243, 192, v240
    s_lshl_b32 s58, s57, 3
    s_add_u32 s58, s58, 8
    s_cmp_eq_u32 s57, 0
    s_cselect_b32 s58, 0, s58
    v_add_u32 v5, s58, v2
    v_min_u32 v5, 40, v5
    v_add_u32 v5, 40, v5
    v_and_b32 v6, 7, v5
    v_lshlrev_b32_e64 v6, 5, v6
    v_lshl_add_u32 v5, v5, 9, v7
    v_xor_b32 v248, v5, v6
    v_xor_b32 v249, 64, v248
    v_xor_b32 v250, 128, v248
    v_xor_b32 v251, 192, v248
    s_lshl_b32 s58, s58, 5
    s_mul_i32 s59, s76, 1344
    s_add_u32 s58, s58, s59
    s_add_u32 s58, s58, 122952
    v_lshlrev_b32_e64 v5, 5, v2
    v_lshl_add_u32 v5, v3, 3, v5
    v_add_u32 v33, s58, v5
    v_and_b32 v4, 3, v2
    v_sub_u32 v4, 3, v4
    s_movk_i32 s57, 4160
    v_mul_u32_u24 v4, s57, v4
    v_lshrrev_b32 v5, 2, v2
    v_sub_u32_e64 v5, v3, v5
    v_lshl_add_u32 v4, v5, 4, v4
    s_mul_i32 s57, s76, 16640
    s_lshl_b32 s58, s77, 8
    s_sub_u32 s57, s57, s58
    s_add_u32 s57, s57, 304
    v_add_u32 v96, s57, v4
    v_lshrrev_b32 v4, 1, v2
    v_lshlrev_b32_e64 v4, 6, v4
    v_lshl_add_u32 v4, v3, 4, v4
    v_and_b32 v5, 1, v2
    s_movk_i32 s57, 4640
    v_mad_u32_u24 v4, v5, s57, v4
    s_mul_i32 s57, s76, 9280
    s_sub_u32 s57, s57, s58
    s_add_u32 s57, s57, 33600
    v_add_u32 v97, s57, v4
    v_lshrrev_b32 v4, 2, v0
    v_and_b32 v6, 1, v0
    v_bfe_u32 v5, v0, 1, 1
    v_add_u32 v7, s55, v6
    v_and_b32 v98, 3, v0
    v_lshlrev_b32_e64 v98, 4, v98
    s_mov_b32 s57, 33024
    v_mad_u32_u24 v98, v4, s57, v98
    s_lshl_b32 s57, s51, 6
    v_add_u32 v98, s57, v98
    s_movk_i32 s57, 16512
    v_mul_u32_u24 v101, s57, v4
    v_lshl_add_u32 v101, v7, 5, v101
    v_lshl_add_u32 v101, v5, 4, v101
    v_lshrrev_b32 v99, 3, v0
    v_lshlrev_b32 v99, 6, v99
    v_lshl_add_u32 v99, v5, 5, v99
    v_and_b32_e64 v4, 1, v4
    v_lshl_add_u32 v99, v4, 3, v99
    s_movk_i32 s57, 9280
    v_mad_u32_u24 v99, v6, s57, v99
    v_add_u32 v99, 33792, v99
    v_lshrrev_b32 v100, 2, v1
    v_lshlrev_b32 v100, 4, v100
    s_movk_i32 s57, 640
    v_mad_u32_u24 v100, v5, s57, v100
    s_movk_i32 s57, 20544
    s_nop 0
    v_mad_u32_u24 v100, v6, s57, v100
    s_mul_i32 s57, s52, 1280
    s_add_u32 s57, s57, 86016
    v_add_u32_e64 v100, s57, v100
    s_movk_i32 s57, 224
    s_movk_i32 s58, 4682
    v_cmp_le_u32 vcc, 224, v0
    v_add_u32 v5, 0xffffff20, v0
    s_nop 0
    v_cndmask_b32 v4, v0, v5, vcc
    v_cndmask_b32 v5, 0, 1, vcc
    v_add_u32 v5, s55, v5
    v_mul_u32_u24 v6, s58, v4
    v_lshrrev_b32 v6, 16, v6
    v_mul_u32_u24 v7, 14, v6
    v_sub_u32 v4, v4, v7
    v_and_b32 v7, 7, v6
    v_lshrrev_b32_e64 v6, 3, v6
    v_lshl_add_u32 v6, v7, 1, v6
    v_lshl_add_u32 v6, v6, 9, v5
    v_mul_u32_u24_e64 v6, s57, v6
    v_lshl_add_u32 v102, v4, 4, v6
    v_add_u32 v4, 32, v0
    s_add_u32 s59, s55, 1
    v_mov_b32 v5, s59
    v_mul_u32_u24 v6, s58, v4
    v_lshrrev_b32 v6, 16, v6
    v_mul_u32_u24 v7, 14, v6
    v_sub_u32 v4, v4, v7
    v_and_b32 v7, 7, v6
    v_lshrrev_b32_e64 v6, 3, v6
    v_lshl_add_u32 v6, v7, 1, v6
    v_lshl_add_u32 v6, v6, 9, v5
    v_mul_u32_u24_e64 v6, s57, v6
    v_lshl_add_u32 v103, v4, 4, v6
    v_cmp_gt_u32 vcc, 192, v0
    v_mov_b32 v4, 1073741824
    s_nop 0
    v_cndmask_b32 v103, v4, v103, vcc
    s_lshl_b32 s57, s51, 5
    v_lshl_add_u32 v104, v1, 13, s57
    s_lshl_b32 s57, s3, 13
    v_lshl_add_u32 v16, v0, 5, s57
    s_lshl_b32 s58, s55, 1
    v_mov_b32_e64 v7, 0
    s_mov_b32 s8, s26
    s_mov_b32 s9, s27
    s_mov_b32 s10, 0x400
    s_mov_b32 s11, 0x20000
    s_mov_b64 exec, 1
    buffer_load_dword v28, v7, s[8:11], s58 offen
    s_mov_b32 s8, s28
    s_mov_b32 s9, s29
    s_nop 0
    s_mov_b32 s10, 0x400
    s_mov_b32 s11, 0x20000
    buffer_load_dword v29, v7, s[8:11], s58 offen
    buffer_load_dword v30, v7, s[4:7], 0 offen offset:0 sc1
    s_mov_b64 exec, -1
    s_add_u32 s30, s69, 127104
    s_waitcnt vmcnt(11)
    v_lshlrev_b32_e64 v36, 16, v19
    v_and_b32 v37, 0xffff0000, v19
    v_mul_f32 v38, 0xbfb8aa3b, v36
    v_mul_f32 v39, 0xbfb8aa3b, v37
    v_exp_f32 v38, v38
    v_exp_f32_e64 v39, v39
    s_nop 0
    v_pk_add_f32 v[38:39], v[38:39], 1.0 op_sel_hi:[1,0]
    v_rcp_f32 v38, v38
    v_rcp_f32 v39, v39
    v_add_u32 v4, 121920, v20
    v_pk_mul_f32 v[36:37], v[36:37], v[38:39]
    v_cvt_pk_bf16_f32 v36, v36, v37
    ds_write_b32 v4, v36
    s_mov_b32 s58, 0x3f803f80
    v_mov_b32 v36, 0
    v_mov_b32 v37, 0
    v_dot2c_f32_bf16 v36, s58, v188
    v_dot2c_f32_bf16 v37, v188, v188
    v_dot2c_f32_bf16 v36, s58, v189
    v_dot2c_f32_bf16 v37, v189, v189
    v_dot2c_f32_bf16 v36, s58, v190
    v_dot2c_f32_bf16 v37, v190, v190
    v_dot2c_f32_bf16 v36, s58, v191
    v_dot2c_f32_bf16 v37, v191, v191
    v_dot2c_f32_bf16 v36, s58, v192
    v_dot2c_f32_bf16 v37, v192, v192
    v_dot2c_f32_bf16 v36, s58, v193
    v_dot2c_f32_bf16 v37, v193, v193
    v_dot2c_f32_bf16 v36, s58, v194
    v_dot2c_f32_bf16 v37, v194, v194
    v_dot2c_f32_bf16 v36, s58, v195
    v_dot2c_f32_bf16 v37, v195, v195
    v_lshlrev_b32_e64 v196, 16, v188
    v_and_b32 v197, 0xffff0000, v188
    v_lshlrev_b32_e64 v198, 16, v189
    v_add_f32_dpp v36, v36, v36 quad_perm:[1,0,3,2] row_mask:0xf bank_mask:0xf
    v_add_f32_dpp v37, v37, v37 quad_perm:[1,0,3,2] row_mask:0xf bank_mask:0xf
    v_and_b32 v199, 0xffff0000, v189
    v_add_f32_dpp v36, v36, v36 quad_perm:[2,3,0,1] row_mask:0xf bank_mask:0xf
    v_add_f32_dpp v37, v37, v37 quad_perm:[2,3,0,1] row_mask:0xf bank_mask:0xf
    v_lshlrev_b32_e64 v200, 16, v190
    v_add_f32_dpp v36, v36, v36 row_half_mirror row_mask:0xf bank_mask:0xf
    v_add_f32_dpp v37, v37, v37 row_half_mirror row_mask:0xf bank_mask:0xf
    v_and_b32 v201, 0xffff0000, v190
    v_add_f32_dpp v36, v36, v36 row_mirror row_mask:0xf bank_mask:0xf
    v_add_f32_dpp v37, v37, v37 row_mirror row_mask:0xf bank_mask:0xf
    v_lshlrev_b32_e64 v202, 16, v191
    v_and_b32 v203, 0xffff0000, v191
    v_permlane16_swap_b32 v36, v37
    v_add_f32 v36, v36, v37
    v_mul_f32 v36, 0x3b000000, v36
    v_mov_b32 v37, v36
    v_lshlrev_b32 v204, 16, v192
    v_and_b32 v205, 0xffff0000, v192
    v_permlane16_swap_b32 v36, v37
    v_fma_f32 v37, -v36, v36, v37
    v_lshlrev_b32 v206, 16, v193
    v_max_f32_e64 v37, 0, v37
    v_and_b32 v207, 0xffff0000, v193
    v_cvt_pk_bf16_f32 v36, v36, v36
    v_lshlrev_b32_e64 v208, 16, v194
    v_and_b32 v36, 0xffff0000, v36
    v_and_b32 v209, 0xffff0000, v194
    v_cvt_pk_bf16_f32 v37, v37, v37
    v_lshlrev_b32_e64 v210, 16, v195
    v_and_b32 v37, 0xffff0000, v37
    v_and_b32 v211, 0xffff0000, v195
    v_add_f32 v37, 0x3727c5ac, v37
    v_mov_b32_e64 v221, v188
    v_cvt_pk_bf16_f32 v37, v37, v37
    v_mov_b32_e64 v223, v189
    v_and_b32 v37, 0xffff0000, v37
    v_mov_b32 v225, v190
    v_sqrt_f32 v37, v37
    v_mov_b32_e64 v227, v191
    v_cvt_pk_bf16_f32 v37, v37, v37
    v_mov_b32_e64 v229, v192
    v_and_b32 v37, 0xffff0000, v37
    v_mov_b32 v231, v193
    v_rcp_f32 v37, v37
    v_mov_b32 v233, v194
    v_mov_b32 v235, v195
    v_mul_f32_e64 v36, -v36, v37
    v_lshlrev_b32_e64 v7, 2, v2
    v_pk_fma_f32 v[196:197], v[196:197], v[36:37], v[36:37] op_sel:[0,1,0] op_sel_hi:[1,1,0]
    v_pk_fma_f32 v[198:199], v[198:199], v[36:37], v[36:37] op_sel:[0,1,0] op_sel_hi:[1,1,0]
    v_pk_fma_f32 v[200:201], v[200:201], v[36:37], v[36:37] op_sel:[0,1,0] op_sel_hi:[1,1,0]
    v_pk_fma_f32 v[202:203], v[202:203], v[36:37], v[36:37] op_sel:[0,1,0] op_sel_hi:[1,1,0]
    v_pk_fma_f32 v[204:205], v[204:205], v[36:37], v[36:37] op_sel:[0,1,0] op_sel_hi:[1,1,0]
    v_pk_fma_f32 v[206:207], v[206:207], v[36:37], v[36:37] op_sel:[0,1,0] op_sel_hi:[1,1,0]
    v_pk_fma_f32 v[208:209], v[208:209], v[36:37], v[36:37] op_sel:[0,1,0] op_sel_hi:[1,1,0]
    v_pk_fma_f32 v[210:211], v[210:211], v[36:37], v[36:37] op_sel:[0,1,0] op_sel_hi:[1,1,0]
    v_cvt_pk_bf16_f32 v220, v196, v197
    v_cvt_pk_bf16_f32 v222, v198, v199
    v_cvt_pk_bf16_f32 v224, v200, v201
    v_cvt_pk_bf16_f32 v226, v202, v203
    v_cvt_pk_bf16_f32 v228, v204, v205
    v_cvt_pk_bf16_f32 v230, v206, v207
    v_cvt_pk_bf16_f32 v232, v208, v209
    v_cvt_pk_bf16_f32 v234, v210, v211
    ds_write_b128 v34, v[220:223] offset:0
    ds_write_b128 v34, v[224:227] offset:16
    ds_write_b128 v34, v[228:231] offset:1024
    ds_write_b128 v34, v[232:235] offset:1040
    s_mul_i32 s57, s51, 16512
    s_add_u32 s57, s57, 1048576
    s_waitcnt vmcnt(3)
    s_waitcnt lgkmcnt(0)
    s_barrier
    s_nop 0
    ds_read_b64_tr_b16 v[196:197], v35 offset:0
    ds_read_b64_tr_b16 v[198:199], v35 offset:8448
    ds_read_b64_tr_b16 v[200:201], v35 offset:512
    ds_read_b64_tr_b16 v[202:203], v35 offset:8960
    ds_read_b64_tr_b16 v[204:205], v35 offset:1024
    ds_read_b64_tr_b16 v[206:207], v35 offset:9472
    ds_read_b64_tr_b16 v[208:209], v35 offset:1536
    ds_read_b64_tr_b16 v[210:211], v35 offset:9984
    s_waitcnt lgkmcnt(6)
    buffer_store_dwordx4 v[196:199], v26, s[4:7], s57 offen sc1
    s_add_u32 s57, s57, 4096
    s_lshl_b32 s57, s52, 8
    s_add_u32 s57, s57, 121920
    v_lshl_add_u32 v5, v3, 3, s57
    v_add_u32 v6, 105536, v105
    ds_read2_b64 v[124:127], v5 offset0:0 offset1:4
    ds_read_b64_tr_b16 v[140:141], v6 offset:0
    ds_read_b64_tr_b16 v[142:143], v6 offset:2048
    ds_read2_b64 v[128:131], v5 offset0:8 offset1:12
    ds_read_b64_tr_b16 v[144:145], v6 offset:4096
    ds_read_b64_tr_b16 v[146:147], v6 offset:6144
    ds_read2_b64 v[132:135], v5 offset0:16 offset1:20
    ds_read_b64_tr_b16 v[148:149], v6 offset:8192
    ds_read_b64_tr_b16 v[150:151], v6 offset:10240
    ds_read2_b64 v[136:139], v5 offset0:24 offset1:28
    ds_read_b64_tr_b16 v[152:153], v6 offset:12288
    ds_read_b64_tr_b16 v[154:155], v6 offset:14336
    s_mul_i32 s57, s51, 16512
    s_add_u32 s57, s57, 1052672
    s_waitcnt lgkmcnt(15)
    buffer_store_dwordx4 v[200:203], v26, s[4:7], s57 offen sc1
    s_add_u32 s57, s57, 4096
    s_waitcnt lgkmcnt(14)
    buffer_store_dwordx4 v[204:207], v26, s[4:7], s57 offen sc1
    s_add_u32 s57, s57, 4096
    s_waitcnt lgkmcnt(12)
    buffer_store_dwordx4 v[208:211], v26, s[4:7], s57 offen sc1
    s_waitcnt lgkmcnt(9)
    v_mfma_f32_16x16x32_bf16 v[108:111], v[124:127], v[140:143], 0
    s_waitcnt lgkmcnt(6)
    v_mfma_f32_16x16x32_bf16 v[108:111], v[128:131], v[144:147], v[108:111]
    s_waitcnt lgkmcnt(3)
    v_mfma_f32_16x16x32_bf16 v[108:111], v[132:135], v[148:151], v[108:111]
    s_waitcnt lgkmcnt(0)
    v_mfma_f32_16x16x32_bf16 v[108:111], v[136:139], v[152:155], v[108:111]
    s_waitcnt vmcnt(6)
    v_readfirstlane_b32 s67, v28
    s_waitcnt vmcnt(5)
    v_readfirstlane_b32 s68, v29
    s_waitcnt vmcnt(4)
    v_readfirstlane_b32 s56, v30
    s_nop 0
    s_add_u32 s56, s56, 1
    s_mov_b64 exec, 0xffff
    buffer_store_dword v108, v7, s[4:7], s78 offen sc1
    s_mov_b64 exec, -1
    s_mul_i32 s84, s55, 3584
    buffer_load_dwordx4 v[56:59], v26, s[12:15], s84 offen
    s_add_u32 s84, s84, 4096
    buffer_load_dwordx4 v[60:63], v26, s[12:15], s84 offen
    s_lshl_b32 s57, s76, 4
    s_lshr_b32 s57, s67, s57
    s_lshl_b32 s57, s57, 16
    v_mov_b32 v36, 1069066811
    v_lshlrev_b32 v22, 16, v22
    v_mul_f32_e64 v36, s57, v36
    v_mul_f32 v37, 1069066811, v22
    v_exp_f32 v36, v36
    v_exp_f32 v37, v37
    v_lshlrev_b32 v23, 16, v23
    v_lshlrev_b32 v24, 16, v24
    v_lshlrev_b32_e64 v25, 16, v25
    v_cvt_pk_bf16_f32 v36, v36, v37
    v_and_b32 v37, 0xffff0000, v36
    v_lshlrev_b32 v36, 16, v36
    v_mul_f32 v38, v23, v36
    v_mul_f32 v37, v37, v36
    v_mul_f32 v38, 1042479491, v38
    v_mul_f32 v37, 0xbfb8aa3b, v37
    v_fract_f32_e64 v5, v38
    v_mul_f32 v7, 0x41800000, v38
    v_mul_f32 v6, 0x41800000, v37
    v_fract_f32 v7, v7
    v_exp_f32 v4, v37
    v_exp_f32 v6, v6
    v_cos_f32 v124, v5
    v_sin_f32 v125, v5
    v_cos_f32 v132, v7
    v_sin_f32 v133, v7
    v_add_f32 v36, v36, v36
    v_mul_f32 v124, v124, v4
    v_mul_f32 v125, v125, v4
    v_mul_f32_e64 v132, v132, v6
    v_mul_f32_e64 v133, -v133, v6
    v_mul_f32_e64 v144, v24, v36
    v_mul_f32_e64 v145, -v25, v36
    s_mul_i32 s57, s76, 41472
    s_lshl_b32 s58, s77, 8
    s_add_u32 s84, s57, s58
    v_mov_b32 v140, 1.0
    v_mov_b32 v141, 0
    v_lshl_add_u32 v160, v1, 2, s84
    v_xor_b32 v161, 32, v160
    v_xor_b32 v162, 64, v160
    v_xor_b32 v163, 96, v160
    v_xor_b32 v164, 128, v160
    v_xor_b32 v165, 160, v160
    v_xor_b32 v166, 192, v160
    v_xor_b32 v167, 224, v160
    v_pk_mul_f32 v[148:149], v[140:141], v[124:125] op_sel_hi:[1,0]
    v_pk_mul_f32 v[150:151], v[144:145], v[132:133] op_sel_hi:[1,0]
    v_cvt_pk_bf16_f32 v152, v140, v141
    v_cvt_pk_bf16_f32 v154, v144, v145
    v_pk_fma_f32 v[142:143], v[140:141], v[124:125], v[148:149] op_sel:[1,1,0] op_sel_hi:[0,1,1] neg_lo:[0,1,0]
    v_pk_fma_f32 v[146:147], v[144:145], v[132:133], v[150:151] op_sel:[1,1,0] op_sel_hi:[0,1,1] neg_lo:[0,1,0]
    ds_write2st64_b32 v160, v152, v154 offset0:0 offset1:80
    v_pk_mul_f32 v[156:157], v[124:125], v[124:125] op_sel_hi:[1,0]
    v_pk_mul_f32 v[148:149], v[142:143], v[124:125] op_sel_hi:[1,0]
    v_pk_mul_f32 v[150:151], v[146:147], v[132:133] op_sel_hi:[1,0]
    v_cvt_pk_bf16_f32 v153, v142, v143
    v_cvt_pk_bf16_f32 v155, v146, v147
    v_pk_fma_f32 v[140:141], v[142:143], v[124:125], v[148:149] op_sel:[1,1,0] op_sel_hi:[0,1,1] neg_lo:[0,1,0]
    v_pk_fma_f32 v[144:145], v[146:147], v[132:133], v[150:151] op_sel:[1,1,0] op_sel_hi:[0,1,1] neg_lo:[0,1,0]
    ds_write2st64_b32 v161, v153, v155 offset0:2 offset1:82
    v_pk_fma_f32 v[126:127], v[124:125], v[124:125], v[156:157] op_sel:[1,1,0] op_sel_hi:[0,1,1] neg_lo:[0,1,0]
    v_pk_mul_f32 v[148:149], v[140:141], v[124:125] op_sel_hi:[1,0]
    v_pk_mul_f32 v[150:151], v[144:145], v[132:133] op_sel_hi:[1,0]
    v_cvt_pk_bf16_f32 v152, v140, v141
    v_cvt_pk_bf16_f32 v154, v144, v145
    v_pk_fma_f32 v[142:143], v[140:141], v[124:125], v[148:149] op_sel:[1,1,0] op_sel_hi:[0,1,1] neg_lo:[0,1,0]
    v_pk_fma_f32 v[146:147], v[144:145], v[132:133], v[150:151] op_sel:[1,1,0] op_sel_hi:[0,1,1] neg_lo:[0,1,0]
    ds_write2st64_b32 v162, v152, v154 offset0:4 offset1:84
    v_pk_mul_f32 v[158:159], v[132:133], v[132:133] op_sel_hi:[1,0]
    s_barrier
    s_add_u32 s88, s80, 0
    s_add_u32 s89, s80, 4096
    s_add_u32 s90, s81, 0
    s_add_u32 s91, s30, 0
    s_bitcmp1_b32 s54, 0
    s_cselect_b32 s85, s88, s91
    s_cselect_b32 s88, s89, s88
    s_cselect_b32 s89, s90, s89
    s_cselect_b32 s90, s91, s90
    s_mov_b32 s91, s85
    s_bitcmp1_b32 s54, 1
    s_cselect_b32 s85, s88, s90
    s_cselect_b32 s88, s90, s88
    s_mov_b32 s90, s85
    s_cselect_b32 s85, s89, s91
    s_cselect_b32 s89, s91, s89
    s_mov_b32 s91, s85
    s_add_u32 s93, s94, 0
    s_and_b32 s93, s93, 3
    s_lshl_b32 s93, s93, 8
    v_pk_mul_f32 v[148:149], v[142:143], v[124:125] op_sel_hi:[1,0]
    v_pk_mul_f32 v[150:151], v[146:147], v[132:133] op_sel_hi:[1,0]
    v_cvt_pk_bf16_f32 v153, v142, v143
    v_cvt_pk_bf16_f32 v155, v146, v147
    v_pk_fma_f32 v[140:141], v[142:143], v[124:125], v[148:149] op_sel:[1,1,0] op_sel_hi:[0,1,1] neg_lo:[0,1,0]
    v_pk_fma_f32 v[144:145], v[146:147], v[132:133], v[150:151] op_sel:[1,1,0] op_sel_hi:[0,1,1] neg_lo:[0,1,0]
    ds_write2st64_b32 v163, v153, v155 offset0:6 offset1:86
    v_pk_fma_f32 v[134:135], v[132:133], v[132:133], v[158:159] op_sel:[1,1,0] op_sel_hi:[0,1,1] neg_lo:[0,1,0]
    v_pk_mul_f32 v[148:149], v[140:141], v[124:125] op_sel_hi:[1,0]
    v_pk_mul_f32 v[150:151], v[144:145], v[132:133] op_sel_hi:[1,0]
    v_cvt_pk_bf16_f32 v152, v140, v141
    v_cvt_pk_bf16_f32 v154, v144, v145
    v_pk_fma_f32 v[142:143], v[140:141], v[124:125], v[148:149] op_sel:[1,1,0] op_sel_hi:[0,1,1] neg_lo:[0,1,0]
    v_pk_fma_f32 v[146:147], v[144:145], v[132:133], v[150:151] op_sel:[1,1,0] op_sel_hi:[0,1,1] neg_lo:[0,1,0]
    ds_write2st64_b32 v164, v152, v154 offset0:8 offset1:88
    v_pk_mul_f32 v[156:157], v[126:127], v[126:127] op_sel_hi:[1,0]
    s_mov_b32 m0, s88
    s_add_u32 s85, s61, s93
    buffer_load_dwordx4 v8, s[72:75], s85 offen offset:0 lds
    v_pk_mul_f32 v[148:149], v[142:143], v[124:125] op_sel_hi:[1,0]
    v_pk_mul_f32 v[150:151], v[146:147], v[132:133] op_sel_hi:[1,0]
    v_cvt_pk_bf16_f32 v153, v142, v143
    v_cvt_pk_bf16_f32 v155, v146, v147
    v_pk_fma_f32 v[140:141], v[142:143], v[124:125], v[148:149] op_sel:[1,1,0] op_sel_hi:[0,1,1] neg_lo:[0,1,0]
    v_pk_fma_f32 v[144:145], v[146:147], v[132:133], v[150:151] op_sel:[1,1,0] op_sel_hi:[0,1,1] neg_lo:[0,1,0]
    ds_write2st64_b32 v165, v153, v155 offset0:10 offset1:90
    v_pk_fma_f32 v[128:129], v[126:127], v[126:127], v[156:157] op_sel:[1,1,0] op_sel_hi:[0,1,1] neg_lo:[0,1,0]
    v_pk_mul_f32 v[148:149], v[140:141], v[124:125] op_sel_hi:[1,0]
    v_pk_mul_f32 v[150:151], v[144:145], v[132:133] op_sel_hi:[1,0]
    v_cvt_pk_bf16_f32 v152, v140, v141
    v_cvt_pk_bf16_f32 v154, v144, v145
    v_pk_fma_f32 v[142:143], v[140:141], v[124:125], v[148:149] op_sel:[1,1,0] op_sel_hi:[0,1,1] neg_lo:[0,1,0]
    v_pk_fma_f32 v[146:147], v[144:145], v[132:133], v[150:151] op_sel:[1,1,0] op_sel_hi:[0,1,1] neg_lo:[0,1,0]
    ds_write2st64_b32 v166, v152, v154 offset0:12 offset1:92
    v_pk_mul_f32 v[158:159], v[134:135], v[134:135] op_sel_hi:[1,0]
    v_pk_mul_f32 v[148:149], v[142:143], v[124:125] op_sel_hi:[1,0]
    v_pk_mul_f32 v[150:151], v[146:147], v[132:133] op_sel_hi:[1,0]
    v_cvt_pk_bf16_f32 v153, v142, v143
    v_cvt_pk_bf16_f32 v155, v146, v147
    v_pk_fma_f32 v[140:141], v[142:143], v[124:125], v[148:149] op_sel:[1,1,0] op_sel_hi:[0,1,1] neg_lo:[0,1,0]
    v_pk_fma_f32 v[144:145], v[146:147], v[132:133], v[150:151] op_sel:[1,1,0] op_sel_hi:[0,1,1] neg_lo:[0,1,0]
    ds_write2st64_b32 v167, v153, v155 offset0:14 offset1:94
    v_pk_fma_f32 v[136:137], v[134:135], v[134:135], v[158:159] op_sel:[1,1,0] op_sel_hi:[0,1,1] neg_lo:[0,1,0]
    v_pk_mul_f32 v[148:149], v[140:141], v[124:125] op_sel_hi:[1,0]
    v_pk_mul_f32 v[150:151], v[144:145], v[132:133] op_sel_hi:[1,0]
    v_cvt_pk_bf16_f32 v152, v140, v141
    v_cvt_pk_bf16_f32 v154, v144, v145
    v_pk_fma_f32 v[142:143], v[140:141], v[124:125], v[148:149] op_sel:[1,1,0] op_sel_hi:[0,1,1] neg_lo:[0,1,0]
    v_pk_fma_f32 v[146:147], v[144:145], v[132:133], v[150:151] op_sel:[1,1,0] op_sel_hi:[0,1,1] neg_lo:[0,1,0]
    ds_write2st64_b32 v160, v152, v154 offset0:16 offset1:96
    v_pk_mul_f32 v[156:157], v[128:129], v[128:129] op_sel_hi:[1,0]
    buffer_load_dwordx4 v9, s[72:75], s85 offen offset:1024 lds
    v_pk_mul_f32 v[148:149], v[142:143], v[124:125] op_sel_hi:[1,0]
    v_pk_mul_f32 v[150:151], v[146:147], v[132:133] op_sel_hi:[1,0]
    v_cvt_pk_bf16_f32 v153, v142, v143
    v_cvt_pk_bf16_f32 v155, v146, v147
    v_pk_fma_f32 v[140:141], v[142:143], v[124:125], v[148:149] op_sel:[1,1,0] op_sel_hi:[0,1,1] neg_lo:[0,1,0]
    v_pk_fma_f32 v[144:145], v[146:147], v[132:133], v[150:151] op_sel:[1,1,0] op_sel_hi:[0,1,1] neg_lo:[0,1,0]
    ds_write2st64_b32 v161, v153, v155 offset0:18 offset1:98
    v_pk_fma_f32 v[130:131], v[128:129], v[128:129], v[156:157] op_sel:[1,1,0] op_sel_hi:[0,1,1] neg_lo:[0,1,0]
    v_pk_mul_f32 v[148:149], v[140:141], v[124:125] op_sel_hi:[1,0]
    v_pk_mul_f32 v[150:151], v[144:145], v[132:133] op_sel_hi:[1,0]
    v_cvt_pk_bf16_f32 v152, v140, v141
    v_cvt_pk_bf16_f32 v154, v144, v145
    v_pk_fma_f32 v[142:143], v[140:141], v[124:125], v[148:149] op_sel:[1,1,0] op_sel_hi:[0,1,1] neg_lo:[0,1,0]
    v_pk_fma_f32 v[146:147], v[144:145], v[132:133], v[150:151] op_sel:[1,1,0] op_sel_hi:[0,1,1] neg_lo:[0,1,0]
    ds_write2st64_b32 v162, v152, v154 offset0:20 offset1:100
    v_pk_mul_f32 v[158:159], v[136:137], v[136:137] op_sel_hi:[1,0]
    v_pk_mul_f32 v[148:149], v[142:143], v[124:125] op_sel_hi:[1,0]
    v_pk_mul_f32 v[150:151], v[146:147], v[132:133] op_sel_hi:[1,0]
    v_cvt_pk_bf16_f32 v153, v142, v143
    v_cvt_pk_bf16_f32 v155, v146, v147
    v_pk_fma_f32 v[140:141], v[142:143], v[124:125], v[148:149] op_sel:[1,1,0] op_sel_hi:[0,1,1] neg_lo:[0,1,0]
    v_pk_fma_f32 v[144:145], v[146:147], v[132:133], v[150:151] op_sel:[1,1,0] op_sel_hi:[0,1,1] neg_lo:[0,1,0]
    ds_write2st64_b32 v163, v153, v155 offset0:22 offset1:102
    v_pk_fma_f32 v[138:139], v[136:137], v[136:137], v[158:159] op_sel:[1,1,0] op_sel_hi:[0,1,1] neg_lo:[0,1,0]
    v_pk_mul_f32 v[148:149], v[140:141], v[124:125] op_sel_hi:[1,0]
    v_pk_mul_f32 v[150:151], v[144:145], v[132:133] op_sel_hi:[1,0]
    v_cvt_pk_bf16_f32 v152, v140, v141
    v_cvt_pk_bf16_f32 v154, v144, v145
    v_pk_fma_f32 v[142:143], v[140:141], v[124:125], v[148:149] op_sel:[1,1,0] op_sel_hi:[0,1,1] neg_lo:[0,1,0]
    v_pk_fma_f32 v[146:147], v[144:145], v[132:133], v[150:151] op_sel:[1,1,0] op_sel_hi:[0,1,1] neg_lo:[0,1,0]
    ds_write2st64_b32 v164, v152, v154 offset0:24 offset1:104
    v_pk_mul_f32 v[148:149], v[142:143], v[124:125] op_sel_hi:[1,0]
    v_pk_mul_f32 v[150:151], v[146:147], v[132:133] op_sel_hi:[1,0]
    v_cvt_pk_bf16_f32 v153, v142, v143
    v_cvt_pk_bf16_f32 v155, v146, v147
    v_pk_fma_f32 v[140:141], v[142:143], v[124:125], v[148:149] op_sel:[1,1,0] op_sel_hi:[0,1,1] neg_lo:[0,1,0]
    v_pk_fma_f32 v[144:145], v[146:147], v[132:133], v[150:151] op_sel:[1,1,0] op_sel_hi:[0,1,1] neg_lo:[0,1,0]
    ds_write2st64_b32 v165, v153, v155 offset0:26 offset1:106
    v_pk_mul_f32 v[148:149], v[140:141], v[124:125] op_sel_hi:[1,0]
    v_pk_mul_f32 v[150:151], v[144:145], v[132:133] op_sel_hi:[1,0]
    v_cvt_pk_bf16_f32 v152, v140, v141
    v_cvt_pk_bf16_f32 v154, v144, v145
    v_pk_fma_f32 v[142:143], v[140:141], v[124:125], v[148:149] op_sel:[1,1,0] op_sel_hi:[0,1,1] neg_lo:[0,1,0]
    v_pk_fma_f32 v[146:147], v[144:145], v[132:133], v[150:151] op_sel:[1,1,0] op_sel_hi:[0,1,1] neg_lo:[0,1,0]
    ds_write2st64_b32 v166, v152, v154 offset0:28 offset1:108
    v_pk_mul_f32 v[148:149], v[142:143], v[124:125] op_sel_hi:[1,0]
    v_pk_mul_f32 v[150:151], v[146:147], v[132:133] op_sel_hi:[1,0]
    v_cvt_pk_bf16_f32 v153, v142, v143
    v_cvt_pk_bf16_f32 v155, v146, v147
    v_pk_fma_f32 v[140:141], v[142:143], v[124:125], v[148:149] op_sel:[1,1,0] op_sel_hi:[0,1,1] neg_lo:[0,1,0]
    v_pk_fma_f32 v[144:145], v[146:147], v[132:133], v[150:151] op_sel:[1,1,0] op_sel_hi:[0,1,1] neg_lo:[0,1,0]
    ds_write2st64_b32 v167, v153, v155 offset0:30 offset1:110
    v_pk_mul_f32 v[148:149], v[140:141], v[126:127] op_sel_hi:[1,0]
    v_pk_mul_f32 v[150:151], v[144:145], v[134:135] op_sel_hi:[1,0]
    v_cvt_pk_bf16_f32 v152, v140, v141
    v_cvt_pk_bf16_f32 v154, v144, v145
    v_pk_fma_f32 v[142:143], v[140:141], v[126:127], v[148:149] op_sel:[1,1,0] op_sel_hi:[0,1,1] neg_lo:[0,1,0]
    v_pk_fma_f32 v[146:147], v[144:145], v[134:135], v[150:151] op_sel:[1,1,0] op_sel_hi:[0,1,1] neg_lo:[0,1,0]
    ds_write2st64_b32 v160, v152, v154 offset0:32 offset1:112
    v_pk_mul_f32 v[148:149], v[142:143], v[126:127] op_sel_hi:[1,0]
    v_pk_mul_f32 v[150:151], v[146:147], v[134:135] op_sel_hi:[1,0]
    v_cvt_pk_bf16_f32 v153, v142, v143
    v_cvt_pk_bf16_f32 v155, v146, v147
    v_pk_fma_f32 v[140:141], v[142:143], v[126:127], v[148:149] op_sel:[1,1,0] op_sel_hi:[0,1,1] neg_lo:[0,1,0]
    v_pk_fma_f32 v[144:145], v[146:147], v[134:135], v[150:151] op_sel:[1,1,0] op_sel_hi:[0,1,1] neg_lo:[0,1,0]
    ds_write2st64_b32 v161, v153, v155 offset0:34 offset1:114
    v_pk_mul_f32 v[148:149], v[140:141], v[126:127] op_sel_hi:[1,0]
    v_pk_mul_f32 v[150:151], v[144:145], v[134:135] op_sel_hi:[1,0]
    v_cvt_pk_bf16_f32 v152, v140, v141
    v_cvt_pk_bf16_f32 v154, v144, v145
    v_pk_fma_f32 v[142:143], v[140:141], v[126:127], v[148:149] op_sel:[1,1,0] op_sel_hi:[0,1,1] neg_lo:[0,1,0]
    v_pk_fma_f32 v[146:147], v[144:145], v[134:135], v[150:151] op_sel:[1,1,0] op_sel_hi:[0,1,1] neg_lo:[0,1,0]
    ds_write2st64_b32 v162, v152, v154 offset0:36 offset1:116
    v_pk_mul_f32 v[148:149], v[142:143], v[126:127] op_sel_hi:[1,0]
    v_pk_mul_f32 v[150:151], v[146:147], v[134:135] op_sel_hi:[1,0]
    v_cvt_pk_bf16_f32 v153, v142, v143
    v_cvt_pk_bf16_f32 v155, v146, v147
    v_pk_fma_f32 v[140:141], v[142:143], v[126:127], v[148:149] op_sel:[1,1,0] op_sel_hi:[0,1,1] neg_lo:[0,1,0]
    v_pk_fma_f32 v[144:145], v[146:147], v[134:135], v[150:151] op_sel:[1,1,0] op_sel_hi:[0,1,1] neg_lo:[0,1,0]
    ds_write2st64_b32 v163, v153, v155 offset0:38 offset1:118
    v_pk_mul_f32 v[148:149], v[140:141], v[126:127] op_sel_hi:[1,0]
    v_pk_mul_f32 v[150:151], v[144:145], v[134:135] op_sel_hi:[1,0]
    v_cvt_pk_bf16_f32 v152, v140, v141
    v_cvt_pk_bf16_f32 v154, v144, v145
    v_pk_fma_f32 v[142:143], v[140:141], v[126:127], v[148:149] op_sel:[1,1,0] op_sel_hi:[0,1,1] neg_lo:[0,1,0]
    v_pk_fma_f32 v[146:147], v[144:145], v[134:135], v[150:151] op_sel:[1,1,0] op_sel_hi:[0,1,1] neg_lo:[0,1,0]
    ds_write2st64_b32 v164, v152, v154 offset0:40 offset1:120
    v_pk_mul_f32 v[148:149], v[142:143], v[126:127] op_sel_hi:[1,0]
    v_pk_mul_f32 v[150:151], v[146:147], v[134:135] op_sel_hi:[1,0]
    v_cvt_pk_bf16_f32 v153, v142, v143
    v_cvt_pk_bf16_f32 v155, v146, v147
    v_pk_fma_f32 v[140:141], v[142:143], v[126:127], v[148:149] op_sel:[1,1,0] op_sel_hi:[0,1,1] neg_lo:[0,1,0]
    v_pk_fma_f32 v[144:145], v[146:147], v[134:135], v[150:151] op_sel:[1,1,0] op_sel_hi:[0,1,1] neg_lo:[0,1,0]
    ds_write2st64_b32 v165, v153, v155 offset0:42 offset1:122
    v_pk_mul_f32 v[148:149], v[140:141], v[126:127] op_sel_hi:[1,0]
    v_pk_mul_f32 v[150:151], v[144:145], v[134:135] op_sel_hi:[1,0]
    v_cvt_pk_bf16_f32 v152, v140, v141
    v_cvt_pk_bf16_f32 v154, v144, v145
    v_pk_fma_f32 v[142:143], v[140:141], v[126:127], v[148:149] op_sel:[1,1,0] op_sel_hi:[0,1,1] neg_lo:[0,1,0]
    v_pk_fma_f32 v[146:147], v[144:145], v[134:135], v[150:151] op_sel:[1,1,0] op_sel_hi:[0,1,1] neg_lo:[0,1,0]
    ds_write2st64_b32 v166, v152, v154 offset0:44 offset1:124
    v_pk_mul_f32 v[148:149], v[142:143], v[126:127] op_sel_hi:[1,0]
    v_pk_mul_f32 v[150:151], v[146:147], v[134:135] op_sel_hi:[1,0]
    v_cvt_pk_bf16_f32 v153, v142, v143
    v_cvt_pk_bf16_f32 v155, v146, v147
    v_pk_fma_f32 v[140:141], v[142:143], v[126:127], v[148:149] op_sel:[1,1,0] op_sel_hi:[0,1,1] neg_lo:[0,1,0]
    v_pk_fma_f32 v[144:145], v[146:147], v[134:135], v[150:151] op_sel:[1,1,0] op_sel_hi:[0,1,1] neg_lo:[0,1,0]
    ds_write2st64_b32 v167, v153, v155 offset0:46 offset1:126
    v_pk_mul_f32 v[148:149], v[140:141], v[128:129] op_sel_hi:[1,0]
    v_pk_mul_f32 v[150:151], v[144:145], v[136:137] op_sel_hi:[1,0]
    v_cvt_pk_bf16_f32 v152, v140, v141
    v_cvt_pk_bf16_f32 v154, v144, v145
    v_pk_fma_f32 v[142:143], v[140:141], v[128:129], v[148:149] op_sel:[1,1,0] op_sel_hi:[0,1,1] neg_lo:[0,1,0]
    v_pk_fma_f32 v[146:147], v[144:145], v[136:137], v[150:151] op_sel:[1,1,0] op_sel_hi:[0,1,1] neg_lo:[0,1,0]
    ds_write2st64_b32 v160, v152, v154 offset0:48 offset1:128
    v_pk_mul_f32 v[148:149], v[142:143], v[128:129] op_sel_hi:[1,0]
    v_pk_mul_f32 v[150:151], v[146:147], v[136:137] op_sel_hi:[1,0]
    v_cvt_pk_bf16_f32 v153, v142, v143
    v_cvt_pk_bf16_f32 v155, v146, v147
    v_pk_fma_f32 v[140:141], v[142:143], v[128:129], v[148:149] op_sel:[1,1,0] op_sel_hi:[0,1,1] neg_lo:[0,1,0]
    v_pk_fma_f32 v[144:145], v[146:147], v[136:137], v[150:151] op_sel:[1,1,0] op_sel_hi:[0,1,1] neg_lo:[0,1,0]
    ds_write2st64_b32 v161, v153, v155 offset0:50 offset1:130
    v_pk_mul_f32 v[148:149], v[140:141], v[128:129] op_sel_hi:[1,0]
    v_pk_mul_f32 v[150:151], v[144:145], v[136:137] op_sel_hi:[1,0]
    v_cvt_pk_bf16_f32 v152, v140, v141
    v_cvt_pk_bf16_f32 v154, v144, v145
    v_pk_fma_f32 v[142:143], v[140:141], v[128:129], v[148:149] op_sel:[1,1,0] op_sel_hi:[0,1,1] neg_lo:[0,1,0]
    v_pk_fma_f32 v[146:147], v[144:145], v[136:137], v[150:151] op_sel:[1,1,0] op_sel_hi:[0,1,1] neg_lo:[0,1,0]
    ds_write2st64_b32 v162, v152, v154 offset0:52 offset1:132
    v_pk_mul_f32 v[148:149], v[142:143], v[128:129] op_sel_hi:[1,0]
    v_pk_mul_f32 v[150:151], v[146:147], v[136:137] op_sel_hi:[1,0]
    v_cvt_pk_bf16_f32 v153, v142, v143
    v_cvt_pk_bf16_f32 v155, v146, v147
    v_pk_fma_f32 v[140:141], v[142:143], v[128:129], v[148:149] op_sel:[1,1,0] op_sel_hi:[0,1,1] neg_lo:[0,1,0]
    v_pk_fma_f32 v[144:145], v[146:147], v[136:137], v[150:151] op_sel:[1,1,0] op_sel_hi:[0,1,1] neg_lo:[0,1,0]
    ds_write2st64_b32 v163, v153, v155 offset0:54 offset1:134
    v_pk_mul_f32 v[148:149], v[140:141], v[128:129] op_sel_hi:[1,0]
    v_pk_mul_f32 v[150:151], v[144:145], v[136:137] op_sel_hi:[1,0]
    v_cvt_pk_bf16_f32 v152, v140, v141
    v_cvt_pk_bf16_f32 v154, v144, v145
    v_pk_fma_f32 v[142:143], v[140:141], v[128:129], v[148:149] op_sel:[1,1,0] op_sel_hi:[0,1,1] neg_lo:[0,1,0]
    v_pk_fma_f32 v[146:147], v[144:145], v[136:137], v[150:151] op_sel:[1,1,0] op_sel_hi:[0,1,1] neg_lo:[0,1,0]
    ds_write2st64_b32 v164, v152, v154 offset0:56 offset1:136
    s_waitcnt vmcnt(4)
    s_waitcnt lgkmcnt(0)
    s_barrier
    s_cmp_lg_u32 s52, 0
    s_cbranch_scc1 adaLN_cond__ssm_conv_s4d__mixer_gmlp__prompt_kernel_pub5
    v_mov_b32 v4, s56
    s_mov_b32 s60, 131072
    s_mov_b64 exec, 0xff
    buffer_store_dword v4, v104, s[4:7], s60 offen sc1
    s_mov_b64 exec, -1
adaLN_cond__ssm_conv_s4d__mixer_gmlp__prompt_kernel_pub5:
    s_nop 0
    v_pk_mul_f32 v[148:149], v[142:143], v[128:129] op_sel_hi:[1,0]
    v_pk_mul_f32 v[150:151], v[146:147], v[136:137] op_sel_hi:[1,0]
    v_cvt_pk_bf16_f32 v153, v142, v143
    v_cvt_pk_bf16_f32 v155, v146, v147
    v_pk_fma_f32 v[140:141], v[142:143], v[128:129], v[148:149] op_sel:[1,1,0] op_sel_hi:[0,1,1] neg_lo:[0,1,0]
    v_pk_fma_f32 v[144:145], v[146:147], v[136:137], v[150:151] op_sel:[1,1,0] op_sel_hi:[0,1,1] neg_lo:[0,1,0]
    ds_write2st64_b32 v165, v153, v155 offset0:58 offset1:138
    buffer_load_dwordx4 v10, s[72:75], s85 offen offset:2048 lds
    v_pk_mul_f32 v[148:149], v[140:141], v[128:129] op_sel_hi:[1,0]
    v_pk_mul_f32 v[150:151], v[144:145], v[136:137] op_sel_hi:[1,0]
    v_cvt_pk_bf16_f32 v152, v140, v141
    v_cvt_pk_bf16_f32 v154, v144, v145
    v_pk_fma_f32 v[142:143], v[140:141], v[128:129], v[148:149] op_sel:[1,1,0] op_sel_hi:[0,1,1] neg_lo:[0,1,0]
    v_pk_fma_f32 v[146:147], v[144:145], v[136:137], v[150:151] op_sel:[1,1,0] op_sel_hi:[0,1,1] neg_lo:[0,1,0]
    ds_write2st64_b32 v166, v152, v154 offset0:60 offset1:140
    buffer_load_dwordx4 v11, s[72:75], s85 offen offset:3072 lds
    v_pk_mul_f32 v[148:149], v[142:143], v[128:129] op_sel_hi:[1,0]
    v_pk_mul_f32 v[150:151], v[146:147], v[136:137] op_sel_hi:[1,0]
    v_cvt_pk_bf16_f32 v153, v142, v143
    v_cvt_pk_bf16_f32 v155, v146, v147
    v_pk_fma_f32 v[140:141], v[142:143], v[128:129], v[148:149] op_sel:[1,1,0] op_sel_hi:[0,1,1] neg_lo:[0,1,0]
    v_pk_fma_f32 v[144:145], v[146:147], v[136:137], v[150:151] op_sel:[1,1,0] op_sel_hi:[0,1,1] neg_lo:[0,1,0]
    ds_write2st64_b32 v167, v153, v155 offset0:62 offset1:142
    s_mov_b32 m0, s89
    s_add_u32 s85, s64, s93
    buffer_load_dwordx4 v8, s[72:75], s85 offen offset:0 lds
    v_pk_mul_f32 v[148:149], v[140:141], v[130:131] op_sel_hi:[1,0]
    v_pk_mul_f32 v[150:151], v[144:145], v[138:139] op_sel_hi:[1,0]
    v_cvt_pk_bf16_f32 v152, v140, v141
    v_cvt_pk_bf16_f32 v154, v144, v145
    v_pk_fma_f32 v[142:143], v[140:141], v[130:131], v[148:149] op_sel:[1,1,0] op_sel_hi:[0,1,1] neg_lo:[0,1,0]
    v_pk_fma_f32 v[146:147], v[144:145], v[138:139], v[150:151] op_sel:[1,1,0] op_sel_hi:[0,1,1] neg_lo:[0,1,0]
    ds_write2st64_b32 v160, v152, v154 offset0:64 offset1:144
    buffer_load_dwordx4 v9, s[72:75], s85 offen offset:1024 lds
    v_pk_mul_f32 v[148:149], v[142:143], v[130:131] op_sel_hi:[1,0]
    v_pk_mul_f32 v[150:151], v[146:147], v[138:139] op_sel_hi:[1,0]
    v_cvt_pk_bf16_f32 v153, v142, v143
    v_cvt_pk_bf16_f32 v155, v146, v147
    v_pk_fma_f32 v[140:141], v[142:143], v[130:131], v[148:149] op_sel:[1,1,0] op_sel_hi:[0,1,1] neg_lo:[0,1,0]
    v_pk_fma_f32 v[144:145], v[146:147], v[138:139], v[150:151] op_sel:[1,1,0] op_sel_hi:[0,1,1] neg_lo:[0,1,0]
    ds_write2st64_b32 v161, v153, v155 offset0:66 offset1:146
    buffer_load_dwordx4 v10, s[72:75], s85 offen offset:2048 lds
    v_pk_mul_f32 v[148:149], v[140:141], v[130:131] op_sel_hi:[1,0]
    v_pk_mul_f32 v[150:151], v[144:145], v[138:139] op_sel_hi:[1,0]
    v_cvt_pk_bf16_f32 v152, v140, v141
    v_cvt_pk_bf16_f32 v154, v144, v145
    v_pk_fma_f32 v[142:143], v[140:141], v[130:131], v[148:149] op_sel:[1,1,0] op_sel_hi:[0,1,1] neg_lo:[0,1,0]
    v_pk_fma_f32 v[146:147], v[144:145], v[138:139], v[150:151] op_sel:[1,1,0] op_sel_hi:[0,1,1] neg_lo:[0,1,0]
    ds_write2st64_b32 v162, v152, v154 offset0:68 offset1:148
    buffer_load_dwordx4 v11, s[72:75], s85 offen offset:3072 lds
    v_pk_mul_f32 v[148:149], v[142:143], v[130:131] op_sel_hi:[1,0]
    v_pk_mul_f32 v[150:151], v[146:147], v[138:139] op_sel_hi:[1,0]
    v_cvt_pk_bf16_f32 v153, v142, v143
    v_cvt_pk_bf16_f32 v155, v146, v147
    v_pk_fma_f32 v[140:141], v[142:143], v[130:131], v[148:149] op_sel:[1,1,0] op_sel_hi:[0,1,1] neg_lo:[0,1,0]
    v_pk_fma_f32 v[144:145], v[146:147], v[138:139], v[150:151] op_sel:[1,1,0] op_sel_hi:[0,1,1] neg_lo:[0,1,0]
    ds_write2st64_b32 v163, v153, v155 offset0:70 offset1:150
    v_pk_mul_f32 v[148:149], v[140:141], v[130:131] op_sel_hi:[1,0]
    v_pk_mul_f32 v[150:151], v[144:145], v[138:139] op_sel_hi:[1,0]
    v_cvt_pk_bf16_f32 v152, v140, v141
    v_cvt_pk_bf16_f32 v154, v144, v145
    v_pk_fma_f32 v[142:143], v[140:141], v[130:131], v[148:149] op_sel:[1,1,0] op_sel_hi:[0,1,1] neg_lo:[0,1,0]
    v_pk_fma_f32 v[146:147], v[144:145], v[138:139], v[150:151] op_sel:[1,1,0] op_sel_hi:[0,1,1] neg_lo:[0,1,0]
    ds_write2st64_b32 v164, v152, v154 offset0:72 offset1:152
    v_pk_mul_f32 v[148:149], v[142:143], v[130:131] op_sel_hi:[1,0]
    v_pk_mul_f32 v[150:151], v[146:147], v[138:139] op_sel_hi:[1,0]
    v_cvt_pk_bf16_f32 v153, v142, v143
    v_cvt_pk_bf16_f32 v155, v146, v147
    v_pk_fma_f32 v[140:141], v[142:143], v[130:131], v[148:149] op_sel:[1,1,0] op_sel_hi:[0,1,1] neg_lo:[0,1,0]
    v_pk_fma_f32 v[144:145], v[146:147], v[138:139], v[150:151] op_sel:[1,1,0] op_sel_hi:[0,1,1] neg_lo:[0,1,0]
    ds_write2st64_b32 v165, v153, v155 offset0:74 offset1:154
    v_pk_mul_f32 v[148:149], v[140:141], v[130:131] op_sel_hi:[1,0]
    v_pk_mul_f32 v[150:151], v[144:145], v[138:139] op_sel_hi:[1,0]
    v_cvt_pk_bf16_f32 v152, v140, v141
    v_cvt_pk_bf16_f32 v154, v144, v145
    v_pk_fma_f32 v[142:143], v[140:141], v[130:131], v[148:149] op_sel:[1,1,0] op_sel_hi:[0,1,1] neg_lo:[0,1,0]
    v_pk_fma_f32 v[146:147], v[144:145], v[138:139], v[150:151] op_sel:[1,1,0] op_sel_hi:[0,1,1] neg_lo:[0,1,0]
    ds_write2st64_b32 v166, v152, v154 offset0:76 offset1:156
    v_pk_mul_f32 v[150:151], v[146:147], v[138:139] op_sel_hi:[1,0]
    v_cvt_pk_bf16_f32 v153, v142, v143
    v_cvt_pk_bf16_f32 v155, v146, v147
    v_pk_fma_f32 v[144:145], v[146:147], v[138:139], v[150:151] op_sel:[1,1,0] op_sel_hi:[0,1,1] neg_lo:[0,1,0]
    ds_write2st64_b32 v167, v153, v155 offset0:78 offset1:158
    v_cvt_pk_bf16_f32 v154, v144, v145
    ds_write_b32 v160, v154 offset:40960
    s_waitcnt lgkmcnt(0)
    s_barrier
    ds_read_b128 v[124:127], v236 offset:0
    ds_read_b128 v[188:191], v244 offset:0
    ds_read_b128 v[156:159], v240 offset:0
    ds_read_b128 v[220:223], v248 offset:0
    ds_read_b128 v[128:131], v237 offset:0
    ds_read_b128 v[192:195], v245 offset:0
    ds_read_b128 v[160:163], v241 offset:0
    ds_read_b128 v[224:227], v249 offset:0
    ds_read_b128 v[132:135], v238 offset:0
    ds_read_b128 v[196:199], v246 offset:0
    ds_read_b128 v[164:167], v242 offset:0
    ds_read_b128 v[228:231], v250 offset:0
    s_waitcnt lgkmcnt(10)
    v_mfma_f32_16x16x32_bf16 v[88:91], v[124:127], v[188:191], 0
    ds_read_b128 v[136:139], v239 offset:0
    s_waitcnt lgkmcnt(9)
    v_mfma_f32_16x16x32_bf16 v[92:95], v[156:159], v[220:223], 0
    ds_read_b128 v[200:203], v247 offset:0
    s_waitcnt lgkmcnt(8)
    v_mfma_f32_16x16x32_bf16 v[88:91], v[128:131], v[192:195], v[88:91]
    ds_read_b128 v[168:171], v243 offset:0
    ds_read_b128 v[232:235], v251 offset:0
    s_waitcnt lgkmcnt(8)
    v_mfma_f32_16x16x32_bf16 v[92:95], v[160:163], v[224:227], v[92:95]
    ds_read_b128 v[140:143], v236 offset:256
    ds_read_b128 v[204:207], v244 offset:256
    s_waitcnt lgkmcnt(8)
    v_mfma_f32_16x16x32_bf16 v[88:91], v[132:135], v[196:199], v[88:91]
    s_nop 0
    ds_read_b128 v[172:175], v240 offset:256
    ds_read_b128 v[40:43], v248 offset:256
    s_mov_b32 s60, 131072
    buffer_load_dword v7, v16, s[4:7], s60 offen sc1
    s_waitcnt lgkmcnt(8)
    v_mfma_f32_16x16x32_bf16 v[92:95], v[164:167], v[228:231], v[92:95]
    ds_read_b128 v[144:147], v237 offset:256
    s_waitcnt lgkmcnt(7)
    v_mfma_f32_16x16x32_bf16 v[88:91], v[136:139], v[200:203], v[88:91]
    ds_read_b128 v[208:211], v245 offset:256
    ds_read_b128 v[176:179], v241 offset:256
    s_waitcnt lgkmcnt(7)
    v_mfma_f32_16x16x32_bf16 v[92:95], v[168:171], v[232:235], v[92:95]
    ds_read_b128 v[44:47], v249 offset:256
    ds_read_b128 v[148:151], v238 offset:256
    s_mov_b32 m0, s90
    s_add_u32 s85, s65, s93
    buffer_load_dwordx4 v8, s[72:75], s85 offen offset:0 lds
    s_waitcnt lgkmcnt(7)
    v_mfma_f32_16x16x32_bf16 v[88:91], v[140:143], v[204:207], v[88:91]
    ds_read_b128 v[212:215], v246 offset:256
    ds_read_b128 v[180:183], v242 offset:256
    s_waitcnt lgkmcnt(7)
    v_mfma_f32_16x16x32_bf16 v[92:95], v[172:175], v[40:43], v[92:95]
    s_nop 0
    ds_read_b128 v[48:51], v250 offset:256
    buffer_load_dwordx4 v9, s[72:75], s85 offen offset:1024 lds
    ds_read_b128 v[152:155], v239 offset:256
    s_waitcnt lgkmcnt(7)
    v_mfma_f32_16x16x32_bf16 v[88:91], v[144:147], v[208:211], v[88:91]
    s_nop 0
    ds_read_b128 v[216:219], v247 offset:256
    buffer_load_dwordx4 v10, s[72:75], s85 offen offset:2048 lds
    ds_read_b128 v[184:187], v243 offset:256
    ds_read_b128 v[52:55], v251 offset:256
    s_waitcnt lgkmcnt(8)
    v_mfma_f32_16x16x32_bf16 v[92:95], v[176:179], v[44:47], v[92:95]
    buffer_load_dwordx4 v11, s[72:75], s85 offen offset:3072 lds
    s_waitcnt lgkmcnt(6)
    v_mfma_f32_16x16x32_bf16 v[88:91], v[148:151], v[212:215], v[88:91]
    s_mov_b32 m0, s91
    s_add_u32 s85, s66, s93
    buffer_load_dwordx4 v8, s[72:75], s85 offen offset:0 lds
    s_waitcnt lgkmcnt(4)
    v_mfma_f32_16x16x32_bf16 v[92:95], v[180:183], v[48:51], v[92:95]
    buffer_load_dwordx4 v9, s[72:75], s85 offen offset:1024 lds
    s_waitcnt lgkmcnt(2)
    v_mfma_f32_16x16x32_bf16 v[88:91], v[152:155], v[216:219], v[88:91]
    buffer_load_dwordx4 v10, s[72:75], s85 offen offset:2048 lds
    s_waitcnt lgkmcnt(0)
    v_mfma_f32_16x16x32_bf16 v[92:95], v[184:187], v[52:55], v[92:95]
    buffer_load_dwordx4 v11, s[72:75], s85 offen offset:3072 lds
    v_mov_b32 v4, 0
    v_mov_b32_e64 v5, 0
    s_mul_i32 s57, s76, 1344
    s_add_u32 s57, s57, 122944
    v_mov_b32_e64 v6, s57
    ds_write_b64 v6, v[4:5]
    s_cmp_eq_u32 s77, 0
    s_nop 0
    s_cselect_b32 s62, -1, 0x00ff00ff
    s_cselect_b32 s57, 0, 0x01000100
    s_or_b32 s57, s57, 0x00ff00ff
    s_mov_b32 s63, s62
    s_nop 0
    v_cvt_pk_bf16_f32 v88, v88, v89
    v_cvt_pk_bf16_f32 v89, v90, v91
    v_cvt_pk_bf16_f32 v92, v92, v93
    v_cvt_pk_bf16_f32 v93, v94, v95
    s_mov_b64 exec, s[62:63]
    ds_write_b64 v32, v[88:89]
    s_mov_b32 exec_lo, s57
    s_mov_b32 exec_hi, s57
    ds_write_b64 v33, v[92:93]
    s_mov_b64 exec, -1
    s_waitcnt vmcnt(8)
    v_cmp_ne_u32_e64 vcc, s56, v7
    s_mov_b32 s59, 0
    s_cbranch_vccz adaLN_cond__ssm_conv_s4d__mixer_gmlp__prompt_kernel_polld7
adaLN_cond__ssm_conv_s4d__mixer_gmlp__prompt_kernel_poll6:
    s_sleep 2
    s_mov_b32 s60, 131072
    buffer_load_dword v7, v16, s[4:7], s60 offen sc1
    s_add_u32 s59, s59, 1
    s_waitcnt vmcnt(0)
    v_cmp_ne_u32_e64 vcc, s56, v7
    s_nop 0
    s_cbranch_vccz adaLN_cond__ssm_conv_s4d__mixer_gmlp__prompt_kernel_polld7
    s_cmp_lt_u32 s59, 524288
    s_cbranch_scc1 adaLN_cond__ssm_conv_s4d__mixer_gmlp__prompt_kernel_poll6
adaLN_cond__ssm_conv_s4d__mixer_gmlp__prompt_kernel_polld7:
    s_waitcnt lgkmcnt(0)
    s_barrier
    s_nop 0
    s_mov_b32 s57, 1048576
    buffer_load_dwordx4 v[236:239], v98, s[4:7], s57 offen sc1
    s_mov_b32 s57, 1065088
    buffer_load_dwordx4 v[244:247], v98, s[4:7], s57 offen sc1
    s_mov_b32 s58, 393216
    s_mov_b32 exec_hi, 0
    buffer_load_dword v53, v106, s[4:7], s58 offen sc1
    s_mov_b32 exec_hi, -1
    s_mov_b32 s57, 3162112
    buffer_load_dwordx4 v[240:243], v98, s[4:7], s57 offen sc1
    s_mov_b32 s57, 3178624
    buffer_load_dwordx4 v[248:251], v98, s[4:7], s57 offen sc1
    buffer_load_dwordx4 v[108:111], v107, s[4:7], s58 offen sc1
    v_mov_b32 v6, s56
    v_mov_b32 v7, 0
    s_or_b32 s57, s2, s52
    s_cmp_eq_u32 s57, 0
    s_cselect_b32 s57, 0, 1073741824
    s_mov_b64 exec, 1
    buffer_store_dword v6, v7, s[4:7], s57 offen sc1
    s_mov_b64 exec, -1
    s_nop 0
    ds_read_u16 v124, v64
    ds_read_u16 v125, v65
    ds_read_u16 v126, v66
    ds_read_u16 v127, v67
    ds_read_u16 v128, v68
    ds_read_u16 v129, v69
    ds_read_u16 v130, v70
    ds_read_u16 v131, v71
    ds_read_u16 v132, v72
    ds_read_u16 v133, v73
    ds_read_u16 v134, v74
    ds_read_u16 v135, v75
    ds_read_u16 v136, v76
    ds_read_u16 v137, v77
    ds_read_u16 v138, v78
    ds_read_u16 v139, v79
    ds_read_u16 v140, v80
    ds_read_u16 v141, v81
    ds_read_u16 v142, v82
    ds_read_u16 v143, v83
    ds_read_u16 v144, v84
    ds_read_u16 v145, v85
    ds_read_u16 v146, v86
    ds_read_u16 v147, v87
    s_mul_i32 s57, s76, 9280
    s_lshl_b32 s58, s77, 8
    s_add_u32 m0, s57, s58
    s_mul_i32 s57, s76, 16640
    s_lshl_b32 s58, s77, 11
    s_nop 0
    ds_write_addtid_b32 v4 offset:33280
    ds_write_addtid_b32 v4 offset:33288
    ds_write_addtid_b32 v4 offset:37920
    s_add_u32 m0, s57, s58
    s_cmp_eq_u32 s77, 1
    s_cselect_b64 exec, 0xffff, 0
    ds_write_addtid_b32 v4 offset:2048
    ds_write_addtid_b32 v4 offset:6208
    ds_write_addtid_b32 v4 offset:10364
    ds_write_addtid_b32 v4 offset:14524
    s_mov_b64 exec, -1
    s_waitcnt lgkmcnt(15)
    v_lshl_or_b32 v188, v125, 16, v124
    v_lshl_or_b32 v189, v126, 16, v125
    ds_write_addtid_b32 v188 offset:0
    ds_write_addtid_b32 v189 offset:4160
    ds_write_addtid_b32 v188 offset:8316
    ds_write_addtid_b32 v189 offset:12476
    v_lshl_or_b32 v190, v128, 16, v127
    v_lshl_or_b32 v191, v129, 16, v128
    ds_write_addtid_b32 v190 offset:256
    ds_write_addtid_b32 v191 offset:4416
    ds_write_addtid_b32 v190 offset:8572
    ds_write_addtid_b32 v191 offset:12732
    v_lshl_or_b32 v192, v131, 16, v130
    v_lshl_or_b32 v193, v132, 16, v131
    ds_write_addtid_b32 v192 offset:512
    ds_write_addtid_b32 v193 offset:4672
    ds_write_addtid_b32 v192 offset:8828
    ds_write_addtid_b32 v193 offset:12988
    v_lshl_or_b32 v194, v134, 16, v133
    v_lshl_or_b32 v195, v135, 16, v134
    ds_write_addtid_b32 v194 offset:768
    ds_write_addtid_b32 v195 offset:4928
    ds_write_addtid_b32 v194 offset:9084
    ds_write_addtid_b32 v195 offset:13244
    v_lshl_or_b32 v196, v137, 16, v136
    v_lshl_or_b32 v197, v138, 16, v137
    ds_write_addtid_b32 v196 offset:1024
    ds_write_addtid_b32 v197 offset:5184
    ds_write_addtid_b32 v196 offset:9340
    ds_write_addtid_b32 v197 offset:13500
    s_waitcnt lgkmcnt(15)
    s_nop 0
    v_lshl_or_b32 v198, v140, 16, v139
    v_lshl_or_b32 v199, v141, 16, v140
    ds_write_addtid_b32 v198 offset:1280
    ds_write_addtid_b32 v199 offset:5440
    ds_write_addtid_b32 v198 offset:9596
    ds_write_addtid_b32 v199 offset:13756
    v_lshl_or_b32 v200, v143, 16, v142
    v_lshl_or_b32 v201, v144, 16, v143
    ds_write_addtid_b32 v200 offset:1536
    ds_write_addtid_b32 v201 offset:5696
    ds_write_addtid_b32 v200 offset:9852
    ds_write_addtid_b32 v201 offset:14012
    v_lshl_or_b32 v202, v146, 16, v145
    v_lshl_or_b32 v203, v147, 16, v146
    ds_write_addtid_b32 v202 offset:1792
    ds_write_addtid_b32 v203 offset:5952
    ds_write_addtid_b32 v202 offset:10108
    ds_write_addtid_b32 v203 offset:14268
    s_waitcnt lgkmcnt(0)
    s_barrier
    v_add_u32 v14, s80, v12
    v_add_u32_e64 v15, s80, v13
    s_waitcnt vmcnt(7)
    ds_read_b128 a[0:3], v14 offset:0
    ds_read_b128 a[4:7], v15 offset:0
    ds_read_b128 a[8:11], v14 offset:2048
    ds_read_b128 a[12:15], v15 offset:2048
    ds_read_b128 a[64:67], v14 offset:4096
    ds_read_b128 a[68:71], v15 offset:4096
    ds_read_b128 a[72:75], v14 offset:6144
    ds_read_b128 a[76:79], v15 offset:6144
    v_add_u32 v14, s81, v12
    v_add_u32 v15, s81, v13
    ds_read_b128 a[128:131], v14 offset:0
    ds_read_b128 a[132:135], v15 offset:0
    ds_read_b128 a[136:139], v14 offset:2048
    ds_read_b128 a[140:143], v15 offset:2048
    v_add_u32 v14, s30, v12
    v_add_u32 v15, s30, v13
    ds_read_b128 a[192:195], v14 offset:0
    ds_read_b128 a[196:199], v15 offset:0
    ds_read_b128 a[200:203], v14 offset:2048
    ds_read_b128 a[204:207], v15 offset:2048
    s_waitcnt lgkmcnt(0)
    s_add_u32 m0, s69, 127104
    s_nop 0
    buffer_load_dwordx4 v17, s[12:15], s31 offen offset:0  lds
    s_add_u32 m0, s69, 128128
    s_add_u32 s31, s31, 28672
    buffer_load_dwordx4 v17, s[12:15], s31 offen offset:0  lds
    s_add_u32 m0, s69, 129152
    s_add_u32 s31, s31, 28672
    buffer_load_dwordx4 v17, s[12:15], s31 offen offset:0  lds
    s_add_u32 m0, s69, 130176
    s_add_u32 s31, s31, 28672
    buffer_load_dwordx4 v17, s[12:15], s31 offen offset:0  lds
    s_add_u32 s88, s82, 0
    s_add_u32 s89, s82, 4096
    s_add_u32 s90, s81, 0
    s_add_u32 s91, s83, 0
    s_bitcmp1_b32 s54, 0
    s_cselect_b32 s85, s88, s91
    s_cselect_b32 s88, s89, s88
    s_cselect_b32 s89, s90, s89
    s_cselect_b32 s90, s91, s90
    s_mov_b32 s91, s85
    s_bitcmp1_b32 s54, 1
    s_cselect_b32 s85, s88, s90
    s_cselect_b32 s88, s90, s88
    s_mov_b32 s90, s85
    s_cselect_b32 s85, s89, s91
    s_cselect_b32 s89, s91, s89
    s_mov_b32 s91, s85
    s_add_u32 s93, s94, 1
    s_and_b32 s93, s93, 3
    s_lshl_b32 s93, s93, 8
    s_mov_b32 m0, s88
    s_add_u32 s85, s61, s93
    s_nop 0
    buffer_load_dwordx4 v8, s[72:75], s85 offen offset:0 lds
    buffer_load_dwordx4 v9, s[72:75], s85 offen offset:1024 lds
    buffer_load_dwordx4 v10, s[72:75], s85 offen offset:2048 lds
    buffer_load_dwordx4 v11, s[72:75], s85 offen offset:3072 lds
    ds_read_b128 v[124:127], v96 offset:3776
    ds_read_b128 v[128:131], v96 offset:3264
    ds_read_b128 v[132:135], v96 offset:2752
    ds_read_b128 v[136:139], v96 offset:2240
    ds_read_b128 v[140:143], v96 offset:1728
    ds_read_b128 v[144:147], v96 offset:1216
    ds_read_b128 v[148:151], v96 offset:704
    ds_read_b128 v[152:155], v96 offset:192
    s_waitcnt vmcnt(12)
    s_nop 0
    v_add_f32_dpp v4, v53, v53 quad_perm:[1,0,3,2] row_mask:0xf bank_mask:0xf
    s_mov_b32 vcc_lo, 0x33333333
    s_mov_b32 vcc_hi, 0x33333333
    v_add_f32_dpp v4, v4, v4 quad_perm:[2,3,0,1] row_mask:0xf bank_mask:0xf
    v_cndmask_b32_dpp v34, v244, v236, vcc quad_perm:[2,3,0,1] row_mask:0xf bank_mask:0xf
    v_cndmask_b32_dpp v35, v245, v237, vcc quad_perm:[2,3,0,1] row_mask:0xf bank_mask:0xf
    v_cndmask_b32_dpp v36, v246, v238, vcc quad_perm:[2,3,0,1] row_mask:0xf bank_mask:0xf
    v_cndmask_b32_dpp v37, v247, v239, vcc quad_perm:[2,3,0,1] row_mask:0xf bank_mask:0xf
    v_cvt_pk_bf16_f32 v4, v4, v4
    v_and_b32 v4, 0xffff0000, v4
    s_waitcnt vmcnt(10)
    s_nop 0
    v_cndmask_b32_dpp v38, v248, v240, vcc quad_perm:[2,3,0,1] row_mask:0xf bank_mask:0xf
    v_cndmask_b32_dpp v39, v249, v241, vcc quad_perm:[2,3,0,1] row_mask:0xf bank_mask:0xf
    v_cndmask_b32_dpp v40, v250, v242, vcc quad_perm:[2,3,0,1] row_mask:0xf bank_mask:0xf
    v_cndmask_b32_dpp v41, v251, v243, vcc quad_perm:[2,3,0,1] row_mask:0xf bank_mask:0xf
    v_readlane_b32 s16, v4, 0
    v_readlane_b32 s17, v4, 4
    v_readlane_b32 s18, v4, 8
    v_readlane_b32 s19, v4, 12
    v_readlane_b32 s20, v4, 16
    v_readlane_b32 s21, v4, 20
    v_readlane_b32 s22, v4, 24
    v_readlane_b32 s23, v4, 28
    v_cmp_gt_u32 vcc, 224, v0
    v_mov_b32 v50, s16
    v_mov_b32 v51, s18
    v_mov_b32 v52, s20
    v_mov_b32 v55, s23
    v_mov_b32 v7, s22
    v_cndmask_b32 v54, v55, v7, vcc
    s_mov_b32 exec_lo, 0xaaaaaaaa
    s_mov_b32 exec_hi, 0xaaaaaaaa
    v_mov_b32 v50, s17
    v_mov_b32 v51, s19
    v_mov_b32 v52, s21
    s_mov_b64 exec, -1
    v_add_f32_e64 v51, 1.0, v51
    v_add_u32 v6, 2048, v99
    v_add_u32 v7, 4640, v99
    v_add_u32 v4, 6688, v99
    v_cvt_pk_bf16_f32 v51, v51, v51
    v_and_b32 v51, 0xffff0000, v51
    v_lshlrev_b32_e64 v18, 16, v34
    v_and_b32 v19, 0xffff0000, v34
    v_lshlrev_b32_e64 v20, 16, v35
    v_and_b32 v21, 0xffff0000, v35
    v_lshlrev_b32_e64 v22, 16, v36
    v_and_b32 v23, 0xffff0000, v36
    v_lshlrev_b32_e64 v24, 16, v37
    v_and_b32 v25, 0xffff0000, v37
    v_pk_fma_f32 v[18:19], v[18:19], v[50:51], v[50:51] op_sel:[0,1,0] op_sel_hi:[1,1,0]
    v_pk_fma_f32 v[20:21], v[20:21], v[50:51], v[50:51] op_sel:[0,1,0] op_sel_hi:[1,1,0]
    v_pk_fma_f32 v[22:23], v[22:23], v[50:51], v[50:51] op_sel:[0,1,0] op_sel_hi:[1,1,0]
    v_pk_fma_f32 v[24:25], v[24:25], v[50:51], v[50:51] op_sel:[0,1,0] op_sel_hi:[1,1,0]
    v_cvt_pk_bf16_f32 v34, v18, v19
    v_cvt_pk_bf16_f32 v35, v20, v21
    v_cvt_pk_bf16_f32 v36, v22, v23
    v_cvt_pk_bf16_f32 v37, v24, v25
    ds_write2_b64 v99, v[34:35], v[36:37] offset0:1 offset1:3
    ds_write2_b64 v7, v[34:35], v[36:37] offset0:0 offset1:2
    v_lshlrev_b32_e64 v26, 16, v38
    v_and_b32 v27, 0xffff0000, v38
    v_lshlrev_b32_e64 v28, 16, v39
    v_and_b32 v29, 0xffff0000, v39
    v_lshlrev_b32_e64 v30, 16, v40
    v_and_b32 v31, 0xffff0000, v40
    v_lshlrev_b32_e64 v32, 16, v41
    v_and_b32 v33, 0xffff0000, v41
    v_pk_fma_f32 v[26:27], v[26:27], v[50:51], v[50:51] op_sel:[0,1,0] op_sel_hi:[1,1,0]
    v_pk_fma_f32 v[28:29], v[28:29], v[50:51], v[50:51] op_sel:[0,1,0] op_sel_hi:[1,1,0]
    v_pk_fma_f32 v[30:31], v[30:31], v[50:51], v[50:51] op_sel:[0,1,0] op_sel_hi:[1,1,0]
    v_pk_fma_f32 v[32:33], v[32:33], v[50:51], v[50:51] op_sel:[0,1,0] op_sel_hi:[1,1,0]
    v_cvt_pk_bf16_f32 v38, v26, v27
    v_cvt_pk_bf16_f32 v39, v28, v29
    v_cvt_pk_bf16_f32 v40, v30, v31
    v_cvt_pk_bf16_f32 v41, v32, v33
    ds_write2_b64 v6, v[38:39], v[40:41] offset0:1 offset1:3
    ds_write2_b64 v4, v[38:39], v[40:41] offset0:0 offset1:2
    s_waitcnt lgkmcnt(0)
    s_barrier
    ds_read_b128 v[156:159], v97 offset:192
    ds_read_b128 v[160:163], v97 offset:704
    ds_read_b128 v[164:167], v97 offset:1216
    ds_read_b128 v[168:171], v97 offset:1728
    ds_read_b128 v[172:175], v97 offset:2240
    ds_read_b128 v[176:179], v97 offset:2752
    ds_read_b128 v[180:183], v97 offset:3264
    ds_read_b128 v[184:187], v97 offset:3776
    s_waitcnt lgkmcnt(7)
    v_mfma_f32_16x16x32_bf16 v[64:67], v[124:127], v[156:159], 0
    s_mov_b32 vcc_lo, 0xcccccccc
    s_mov_b32 vcc_hi, 0xcccccccc
    v_mfma_f32_16x16x32_bf16 v[68:71], v[128:131], v[156:159], 0
    v_cndmask_b32_dpp v42, v236, v244, vcc quad_perm:[2,3,0,1] row_mask:0xf bank_mask:0xf
    v_cndmask_b32_dpp v43, v237, v245, vcc quad_perm:[2,3,0,1] row_mask:0xf bank_mask:0xf
    v_mfma_f32_16x16x32_bf16 v[72:75], v[132:135], v[156:159], 0
    s_mov_b32 m0, s89
    s_add_u32 s85, s64, s93
    buffer_load_dwordx4 v8, s[72:75], s85 offen offset:0 lds
    v_mfma_f32_16x16x32_bf16 v[76:79], v[136:139], v[156:159], 0
    ds_read_b128 v[220:223], v97 offset:128
    v_cndmask_b32_dpp v44, v238, v246, vcc quad_perm:[2,3,0,1] row_mask:0xf bank_mask:0xf
    v_mfma_f32_16x16x32_bf16 v[80:83], v[140:143], v[156:159], 0
    buffer_load_dwordx4 v9, s[72:75], s85 offen offset:1024 lds
    v_cndmask_b32_dpp v45, v239, v247, vcc quad_perm:[2,3,0,1] row_mask:0xf bank_mask:0xf
    v_cndmask_b32_dpp v46, v240, v248, vcc quad_perm:[2,3,0,1] row_mask:0xf bank_mask:0xf
    v_mfma_f32_16x16x32_bf16 v[84:87], v[144:147], v[156:159], 0
    ds_read_b128 v[188:191], v96 offset:3712
    v_cndmask_b32_dpp v47, v241, v249, vcc quad_perm:[2,3,0,1] row_mask:0xf bank_mask:0xf
    v_cndmask_b32_dpp v48, v242, v250, vcc quad_perm:[2,3,0,1] row_mask:0xf bank_mask:0xf
    v_mfma_f32_16x16x32_bf16 v[88:91], v[148:151], v[156:159], 0
    ds_read_b128 v[224:227], v97 offset:640
    v_cndmask_b32_dpp v49, v243, v251, vcc quad_perm:[2,3,0,1] row_mask:0xf bank_mask:0xf
    v_mfma_f32_16x16x32_bf16 v[92:95], v[152:155], v[156:159], 0
    buffer_load_dwordx4 v10, s[72:75], s85 offen offset:2048 lds
    v_add_f32 v54, 1.0, v54
    v_cvt_pk_bf16_f32 v54, v54, v54
    s_waitcnt lgkmcnt(9)
    v_mfma_f32_16x16x32_bf16 v[68:71], v[124:127], v[160:163], v[68:71]
    ds_read_b128 v[192:195], v96 offset:3200
    v_and_b32 v54, 0xffff0000, v54
    v_add_f32 v55, 1.0, v55
    v_mfma_f32_16x16x32_bf16 v[72:75], v[128:131], v[160:163], v[72:75]
    buffer_load_dwordx4 v11, s[72:75], s85 offen offset:3072 lds
    v_cvt_pk_bf16_f32 v55, v55, v55
    v_mfma_f32_16x16x32_bf16 v[76:79], v[132:135], v[160:163], v[76:79]
    ds_read_b128 v[228:231], v97 offset:1152
    v_and_b32 v55, 0xffff0000, v55
    v_lshlrev_b32_e64 v6, 16, v56
    v_mfma_f32_16x16x32_bf16 v[80:83], v[136:139], v[160:163], v[80:83]
    v_and_b32 v7, 0xffff0000, v56
    v_mul_f32_e64 v6, v6, v54
    v_mfma_f32_16x16x32_bf16 v[84:87], v[140:143], v[160:163], v[84:87]
    ds_read_b128 v[196:199], v96 offset:2688
    v_mul_f32_e64 v7, v7, v54
    v_mfma_f32_16x16x32_bf16 v[88:91], v[144:147], v[160:163], v[88:91]
    v_cvt_pk_bf16_f32 v56, v6, v7
    v_lshlrev_b32_e64 v6, 16, v57
    v_mfma_f32_16x16x32_bf16 v[92:95], v[148:151], v[160:163], v[92:95]
    s_mov_b32 m0, s90
    s_add_u32 s85, s65, s93
    buffer_load_dwordx4 v8, s[72:75], s85 offen offset:0 lds
    v_and_b32 v7, 0xffff0000, v57
    v_mul_f32 v6, v6, v54
    s_waitcnt lgkmcnt(11)
    v_mfma_f32_16x16x32_bf16 v[72:75], v[124:127], v[164:167], v[72:75]
    ds_read_b128 v[232:235], v97 offset:1664
    v_mul_f32_e64 v7, v7, v54
    v_mfma_f32_16x16x32_bf16 v[76:79], v[128:131], v[164:167], v[76:79]
    buffer_load_dwordx4 v9, s[72:75], s85 offen offset:1024 lds
    v_cvt_pk_bf16_f32 v57, v6, v7
    v_lshlrev_b32_e64 v6, 16, v58
    v_mfma_f32_16x16x32_bf16 v[80:83], v[132:135], v[164:167], v[80:83]
    ds_read_b128 v[200:203], v96 offset:2176
    v_and_b32 v7, 0xffff0000, v58
    v_mul_f32_e64 v6, v6, v54
    v_mfma_f32_16x16x32_bf16 v[84:87], v[136:139], v[164:167], v[84:87]
    buffer_load_dwordx4 v10, s[72:75], s85 offen offset:2048 lds
    v_mul_f32_e64 v7, v7, v54
    v_mfma_f32_16x16x32_bf16 v[88:91], v[140:143], v[164:167], v[88:91]
    ds_read_b128 v[236:239], v97 offset:2176
    v_cvt_pk_bf16_f32 v58, v6, v7
    v_lshlrev_b32_e64 v6, 16, v59
    v_mfma_f32_16x16x32_bf16 v[92:95], v[144:147], v[164:167], v[92:95]
    ds_read_b128 v[204:207], v96 offset:1664
    v_and_b32 v7, 0xffff0000, v59
    v_mul_f32 v6, v6, v54
    s_waitcnt lgkmcnt(14)
    v_mfma_f32_16x16x32_bf16 v[76:79], v[124:127], v[168:171], v[76:79]
    buffer_load_dwordx4 v11, s[72:75], s85 offen offset:3072 lds
    v_mul_f32_e64 v7, v7, v54
    v_mfma_f32_16x16x32_bf16 v[80:83], v[128:131], v[168:171], v[80:83]
    ds_read_b128 v[240:243], v97 offset:2688
    v_cvt_pk_bf16_f32 v59, v6, v7
    s_mov_b32 s57, 7602176
    v_mfma_f32_16x16x32_bf16 v[84:87], v[132:135], v[168:171], v[84:87]
    buffer_store_dwordx4 v[56:59], v102, s[4:7], s57 offen sc1
    v_lshlrev_b32_e64 v6, 16, v60
    v_mfma_f32_16x16x32_bf16 v[88:91], v[136:139], v[168:171], v[88:91]
    ds_read_b128 v[208:211], v96 offset:1152
    v_and_b32 v7, 0xffff0000, v60
    v_mfma_f32_16x16x32_bf16 v[92:95], v[140:143], v[168:171], v[92:95]
    v_mul_f32 v6, v6, v55
    v_mul_f32_e64 v7, v7, v55
    s_waitcnt lgkmcnt(15)
    v_mfma_f32_16x16x32_bf16 v[80:83], v[124:127], v[172:175], v[80:83]
    s_mov_b32 m0, s91
    s_add_u32 s85, s66, s93
    buffer_load_dwordx4 v8, s[72:75], s85 offen offset:0 lds
    v_cvt_pk_bf16_f32 v60, v6, v7
    v_lshlrev_b32_e64 v6, 16, v61
    v_mfma_f32_16x16x32_bf16 v[84:87], v[128:131], v[172:175], v[84:87]
    ds_read_b128 v[244:247], v97 offset:3200
    v_and_b32 v7, 0xffff0000, v61
    v_mfma_f32_16x16x32_bf16 v[88:91], v[132:135], v[172:175], v[88:91]
    buffer_load_dwordx4 v9, s[72:75], s85 offen offset:1024 lds
    v_mul_f32 v6, v6, v55
    v_mul_f32 v7, v7, v55
    v_mfma_f32_16x16x32_bf16 v[92:95], v[136:139], v[172:175], v[92:95]
    ds_read_b128 v[212:215], v96 offset:640
    v_cvt_pk_bf16_f32 v61, v6, v7
    v_lshlrev_b32 v6, 16, v62
    s_waitcnt lgkmcnt(15)
    v_mfma_f32_16x16x32_bf16 v[84:87], v[124:127], v[176:179], v[84:87]
    buffer_load_dwordx4 v10, s[72:75], s85 offen offset:2048 lds
    v_and_b32 v7, 0xffff0000, v62
    v_mfma_f32_16x16x32_bf16 v[88:91], v[128:131], v[176:179], v[88:91]
    ds_read_b128 v[248:251], v97 offset:3712
    v_mul_f32 v6, v6, v55
    v_mul_f32 v7, v7, v55
    v_mfma_f32_16x16x32_bf16 v[92:95], v[132:135], v[176:179], v[92:95]
    ds_read_b128 v[216:219], v96 offset:128
    v_cvt_pk_bf16_f32 v62, v6, v7
    v_lshlrev_b32_e64 v6, 16, v63
    v_mfma_f32_16x16x32_bf16 v[88:91], v[124:127], v[180:183], v[88:91]
    buffer_load_dwordx4 v11, s[72:75], s85 offen offset:3072 lds
    v_and_b32 v7, 0xffff0000, v63
    v_mfma_f32_16x16x32_bf16 v[92:95], v[128:131], v[180:183], v[92:95]
    v_mul_f32 v6, v6, v55
    v_mul_f32_e64 v7, v7, v55
    s_waitcnt lgkmcnt(15)
    v_mfma_f32_16x16x32_bf16 v[92:95], v[124:127], v[184:187], v[92:95]
    v_cvt_pk_bf16_f32 v63, v6, v7
    s_mov_b32 s57, 7602176
    buffer_store_dwordx4 v[60:63], v103, s[4:7], s57 offen sc1
    s_waitcnt lgkmcnt(14)
    v_mfma_f32_16x16x32_bf16 v[64:67], v[188:191], v[220:223], v[64:67]
    ds_read_b128 v[156:159], v97 offset:64
    s_waitcnt vmcnt(23)
    v_add_f32_dpp v108, v108, v108 quad_perm:[1,0,3,2] row_mask:0xf bank_mask:0xf
    s_waitcnt lgkmcnt(14)
    v_mfma_f32_16x16x32_bf16 v[68:71], v[188:191], v[224:227], v[68:71]
    v_add_f32_dpp v109, v109, v109 quad_perm:[1,0,3,2] row_mask:0xf bank_mask:0xf
    s_waitcnt lgkmcnt(13)
    v_mfma_f32_16x16x32_bf16 v[68:71], v[192:195], v[220:223], v[68:71]
    ds_read_b128 v[124:127], v96 offset:3648
    v_add_f32_dpp v110, v110, v110 quad_perm:[1,0,3,2] row_mask:0xf bank_mask:0xf
    v_mfma_f32_16x16x32_bf16 v[72:75], v[192:195], v[224:227], v[72:75]
    v_add_f32_dpp v111, v111, v111 quad_perm:[1,0,3,2] row_mask:0xf bank_mask:0xf
    s_waitcnt lgkmcnt(13)
    v_mfma_f32_16x16x32_bf16 v[72:75], v[188:191], v[228:231], v[72:75]
    ds_read_b128 v[160:163], v97 offset:576
    v_add_f32_dpp v108, v108, v108 quad_perm:[2,3,0,1] row_mask:0xf bank_mask:0xf
    v_mfma_f32_16x16x32_bf16 v[76:79], v[192:195], v[228:231], v[76:79]
    s_waitcnt lgkmcnt(13)
    v_mfma_f32_16x16x32_bf16 v[72:75], v[196:199], v[220:223], v[72:75]
    ds_read_b128 v[128:131], v96 offset:3136
    v_add_f32_dpp v109, v109, v109 quad_perm:[2,3,0,1] row_mask:0xf bank_mask:0xf
    v_mfma_f32_16x16x32_bf16 v[76:79], v[196:199], v[224:227], v[76:79]
    v_add_f32_dpp v110, v110, v110 quad_perm:[2,3,0,1] row_mask:0xf bank_mask:0xf
    v_mfma_f32_16x16x32_bf16 v[80:83], v[196:199], v[228:231], v[80:83]
    ds_read_b128 v[164:167], v97 offset:1088
    v_add_f32_dpp v111, v111, v111 quad_perm:[2,3,0,1] row_mask:0xf bank_mask:0xf
    s_waitcnt lgkmcnt(14)
    v_mfma_f32_16x16x32_bf16 v[76:79], v[188:191], v[232:235], v[76:79]
    v_bfe_u32 v5, v1, 2, 1
    v_mfma_f32_16x16x32_bf16 v[80:83], v[192:195], v[232:235], v[80:83]
    ds_read_b128 v[132:135], v96 offset:2624
    v_mfma_f32_16x16x32_bf16 v[84:87], v[196:199], v[232:235], v[84:87]
    v_cvt_pk_bf16_f32 v108, v108, v109
    s_waitcnt lgkmcnt(14)
    v_mfma_f32_16x16x32_bf16 v[76:79], v[200:203], v[220:223], v[76:79]
    ds_read_b128 v[168:171], v97 offset:1600
    v_cvt_pk_bf16_f32 v109, v110, v111
    v_mfma_f32_16x16x32_bf16 v[80:83], v[200:203], v[224:227], v[80:83]
    v_cvt_f32_u32_e64 v110, v5
    v_mfma_f32_16x16x32_bf16 v[84:87], v[200:203], v[228:231], v[84:87]
    ds_read_b128 v[136:139], v96 offset:2112
    v_sub_f32_e64 v110, 1.0, v110
    v_mfma_f32_16x16x32_bf16 v[88:91], v[200:203], v[232:235], v[88:91]
    s_waitcnt lgkmcnt(15)
    v_mfma_f32_16x16x32_bf16 v[80:83], v[188:191], v[236:239], v[80:83]
    ds_read_b128 v[172:175], v97 offset:2112
    v_lshlrev_b32 v6, 16, v108
    v_mfma_f32_16x16x32_bf16 v[84:87], v[192:195], v[236:239], v[84:87]
    v_and_b32 v7, 0xffff0000, v108
    v_mfma_f32_16x16x32_bf16 v[88:91], v[196:199], v[236:239], v[88:91]
    s_mov_b32 s8, s38
    v_add_f32_e64 v6, v6, v110
    s_mov_b32 s9, s39
    v_mfma_f32_16x16x32_bf16 v[92:95], v[200:203], v[236:239], v[92:95]
    ds_read_b128 v[140:143], v96 offset:1600
    s_mov_b32 s10, 0xe0000
    s_waitcnt lgkmcnt(15)
    v_mfma_f32_16x16x32_bf16 v[80:83], v[204:207], v[220:223], v[80:83]
    ds_read_b128 v[176:179], v97 offset:2624
    v_add_f32 v7, v7, v110
    v_mfma_f32_16x16x32_bf16 v[84:87], v[204:207], v[224:227], v[84:87]
    s_mov_b32 s11, 0x20000
    v_cvt_pk_bf16_f32 v108, v6, v7
    s_lshl_b32 s31, s50, 2
    v_mfma_f32_16x16x32_bf16 v[88:91], v[204:207], v[228:231], v[88:91]
    s_add_u32 s31, s31, s52
    v_lshlrev_b32_e64 v6, 16, v109
    v_mfma_f32_16x16x32_bf16 v[92:95], v[204:207], v[232:235], v[92:95]
    ds_read_b128 v[144:147], v96 offset:1088
    v_and_b32 v7, 0xffff0000, v109
    v_mfma_f32_16x16x32_bf16 v[84:87], v[188:191], v[240:243], v[84:87]
    s_cmp_ge_u32 s31, 56
    s_cselect_b32 s84, 229376, 0
    s_mul_i32 s31, s31, 4096
    v_mfma_f32_16x16x32_bf16 v[88:91], v[192:195], v[240:243], v[88:91]
    ds_read_b128 v[180:183], v97 offset:3136
    v_add_f32 v6, v6, v110
    v_mfma_f32_16x16x32_bf16 v[92:95], v[196:199], v[240:243], v[92:95]
    s_add_u32 s31, s31, s84
    v_add_f32 v7, v7, v110
    s_add_u32 s31, s31, 0
    s_waitcnt lgkmcnt(15)
    v_mfma_f32_16x16x32_bf16 v[84:87], v[208:211], v[220:223], v[84:87]
    ds_read_b128 v[148:151], v96 offset:576
    v_cvt_pk_bf16_f32 v109, v6, v7
    v_mfma_f32_16x16x32_bf16 v[88:91], v[208:211], v[224:227], v[88:91]
    s_cmp_ge_u32 s50, 28
    s_cselect_b32 s31, 1073741824, s31
    s_and_b32 s84, s3, 1
    v_mfma_f32_16x16x32_bf16 v[92:95], v[208:211], v[228:231], v[92:95]
    s_lshl_b32 s57, s52, 6
    s_lshl_b32 s84, s84, 9
    s_add_u32 s57, s57, 143488
    v_mfma_f32_16x16x32_bf16 v[88:91], v[188:191], v[244:247], v[88:91]
    ds_read_b128 v[184:187], v97 offset:3648
    s_add_u32 s31, s31, s84
    v_mfma_f32_16x16x32_bf16 v[92:95], v[192:195], v[244:247], v[92:95]
    ds_read_b128 v[152:155], v96 offset:64
    v_and_b32_e64 v6, 56, v1
    v_mfma_f32_16x16x32_bf16 v[88:91], v[212:215], v[220:223], v[88:91]
    v_lshrrev_b32 v14, 2, v1
    v_and_b32 v15, 3, v1
    v_mfma_f32_16x16x32_bf16 v[92:95], v[212:215], v[224:227], v[92:95]
    v_lshl_add_u32 v6, v5, 8, v6
    v_lshlrev_b32 v15, 7, v15
    s_waitcnt lgkmcnt(15)
    v_mfma_f32_16x16x32_bf16 v[92:95], v[188:191], v[248:251], v[92:95]
    v_add_u32_e64 v6, s57, v6
    v_lshl_add_u32 v14, v14, 10, v15
    v_mfma_f32_16x16x32_bf16 v[92:95], v[216:219], v[220:223], v[92:95]
    ds_write_b64 v6, v[108:109]
    s_mov_b64 exec, 0xffff
    buffer_load_dword v254, v14, s[8:11], s31 offen
    s_mov_b64 exec, -1
    s_lshl_b32 s59, s50, 2
    s_add_u32 s59, s59, s52
    s_nop 0
    s_mul_i32 s59, s59, 256
    s_add_u32 s59, s59, adaLN_cond__ssm_conv_s4d__mixer_gmlp__prompt_kernel_g1c3-adaLN_cond__ssm_conv_s4d__mixer_gmlp__prompt_kernel_pc2
    v_lshl_add_u32 v6, v1, 7, s59
    v_min_u32 v6, adaLN_cond__ssm_conv_s4d__mixer_gmlp__prompt_kernel_end1-adaLN_cond__ssm_conv_s4d__mixer_gmlp__prompt_kernel_pc2-4, v6
    v_mov_b32 v7, s87
    v_add_co_u32 v6, vcc, s86, v6
    s_nop 1
    v_addc_co_u32_e64 v7, vcc, 0, v7, vcc
    s_mov_b64 exec, 3
    global_load_dword v254, v[6:7], off
    s_mov_b64 exec, -1
    s_waitcnt lgkmcnt(15)
    v_mfma_f32_16x16x32_bf16 v[64:67], v[124:127], v[156:159], v[64:67]
    ds_read_b128 v[220:223], v97 offset:0
    v_and_b32 v14, 1, v0
    s_waitcnt lgkmcnt(15)
    v_mfma_f32_16x16x32_bf16 v[68:71], v[124:127], v[160:163], v[68:71]
    s_and_b32 s30, s79, 3
    v_lshlrev_b32_e64 v14, 4, v14
    s_waitcnt lgkmcnt(14)
    v_mfma_f32_16x16x32_bf16 v[68:71], v[128:131], v[156:159], v[68:71]
    ds_read_b128 v[188:191], v96 offset:3584
    v_lshrrev_b32 v14, v14, s68
    v_mfma_f32_16x16x32_bf16 v[72:75], v[128:131], v[160:163], v[72:75]
    s_mul_i32 s30, s30, 14336
    v_lshlrev_b32 v14, 16, v14
    s_waitcnt lgkmcnt(14)
    v_mfma_f32_16x16x32_bf16 v[72:75], v[124:127], v[164:167], v[72:75]
    ds_read_b128 v[224:227], v97 offset:512
    v_mul_f32_e64 v53, v52, v14
    v_mfma_f32_16x16x32_bf16 v[76:79], v[128:131], v[164:167], v[76:79]
    s_lshr_b32 s58, s79, 2
    v_lshlrev_b32_e64 v18, 16, v34
    s_waitcnt lgkmcnt(14)
    v_mfma_f32_16x16x32_bf16 v[72:75], v[132:135], v[156:159], v[72:75]
    ds_read_b128 v[192:195], v96 offset:3072
    v_and_b32 v19, 0xffff0000, v34
    v_mfma_f32_16x16x32_bf16 v[76:79], v[132:135], v[160:163], v[76:79]
    s_lshl_b32 s58, s58, 9
    v_lshlrev_b32 v14, 16, v42
    v_mfma_f32_16x16x32_bf16 v[80:83], v[132:135], v[164:167], v[80:83]
    ds_read_b128 v[228:231], v97 offset:1024
    v_and_b32 v15, 0xffff0000, v42
    s_waitcnt lgkmcnt(15)
    v_mfma_f32_16x16x32_bf16 v[76:79], v[124:127], v[168:171], v[76:79]
    s_add_u32 s30, s30, s58
    v_fma_f32 v18, v18, v53, v14
    v_mfma_f32_16x16x32_bf16 v[80:83], v[128:131], v[168:171], v[80:83]
    ds_read_b128 v[196:199], v96 offset:2560
    v_fma_f32 v19, v19, v53, v15
    v_mfma_f32_16x16x32_bf16 v[84:87], v[132:135], v[168:171], v[84:87]
    s_lshl_b32 s58, s52, 7
    v_lshlrev_b32_e64 v20, 16, v35
    s_waitcnt lgkmcnt(15)
    v_mfma_f32_16x16x32_bf16 v[76:79], v[136:139], v[156:159], v[76:79]
    ds_read_b128 v[232:235], v97 offset:1536
    v_and_b32 v21, 0xffff0000, v35
    v_mfma_f32_16x16x32_bf16 v[80:83], v[136:139], v[160:163], v[80:83]
    s_add_u32 s30, s30, s58
    v_lshlrev_b32 v14, 16, v43
    v_mfma_f32_16x16x32_bf16 v[84:87], v[136:139], v[164:167], v[84:87]
    ds_read_b128 v[200:203], v96 offset:2048
    v_and_b32 v15, 0xffff0000, v43
    v_mfma_f32_16x16x32_bf16 v[88:91], v[136:139], v[168:171], v[88:91]
    s_add_u32 s30, s30, 720896
    v_fma_f32 v20, v20, v53, v14
    s_waitcnt lgkmcnt(15)
    v_mfma_f32_16x16x32_bf16 v[80:83], v[124:127], v[172:175], v[80:83]
    ds_read_b128 v[236:239], v97 offset:2048
    v_fma_f32 v21, v21, v53, v15
    v_mfma_f32_16x16x32_bf16 v[84:87], v[128:131], v[172:175], v[84:87]
    v_lshlrev_b32 v22, 16, v36
    v_mfma_f32_16x16x32_bf16 v[88:91], v[132:135], v[172:175], v[88:91]
    s_mul_i32 s57, s52, 10240
    v_and_b32 v23, 0xffff0000, v36
    v_mfma_f32_16x16x32_bf16 v[92:95], v[136:139], v[172:175], v[92:95]
    ds_read_b128 v[204:207], v96 offset:1536
    v_lshlrev_b32_e64 v14, 16, v44
    v_mfma_f32_16x16x32_bf16 v[80:83], v[140:143], v[156:159], v[80:83]
    s_lshl_b32 s58, s76, 6
    v_and_b32 v15, 0xffff0000, v44
    v_mfma_f32_16x16x32_bf16 v[84:87], v[140:143], v[160:163], v[84:87]
    ds_read_b128 v[240:243], v97 offset:2560
    v_fma_f32 v22, v22, v53, v14
    v_mfma_f32_16x16x32_bf16 v[88:91], v[140:143], v[164:167], v[88:91]
    s_add_u32 s57, s57, s58
    v_fma_f32 v23, v23, v53, v15
    v_mfma_f32_16x16x32_bf16 v[92:95], v[140:143], v[168:171], v[92:95]
    ds_read_b128 v[208:211], v96 offset:1024
    v_lshlrev_b32 v24, 16, v37
    s_waitcnt lgkmcnt(15)
    v_mfma_f32_16x16x32_bf16 v[84:87], v[124:127], v[176:179], v[84:87]
    ds_read_b128 v[244:247], v97 offset:3072
    v_and_b32 v25, 0xffff0000, v37
    v_mfma_f32_16x16x32_bf16 v[88:91], v[128:131], v[176:179], v[88:91]
    s_add_u32 s57, s57, 86016
    v_mfma_f32_16x16x32_bf16 v[92:95], v[132:135], v[176:179], v[92:95]
    ds_read_b128 v[212:215], v96 offset:512
    v_mfma_f32_16x16x32_bf16 v[84:87], v[144:147], v[156:159], v[84:87]
    v_lshl_add_u32 v4, v2, 4, s57
    v_mfma_f32_16x16x32_bf16 v[88:91], v[144:147], v[160:163], v[88:91]
    ds_read_b128 v[248:251], v97 offset:3584
    v_mfma_f32_16x16x32_bf16 v[92:95], v[144:147], v[164:167], v[92:95]
    s_movk_i32 s57, 320
    v_mfma_f32_16x16x32_bf16 v[88:91], v[124:127], v[180:183], v[88:91]
    ds_read_b128 v[216:219], v96 offset:0
    v_mfma_f32_16x16x32_bf16 v[92:95], v[128:131], v[180:183], v[92:95]
    v_add_u32 v6, s83, v12
    v_add_u32 v7, s83, v13
    s_waitcnt vmcnt(3)
    ds_read_b128 a[208:211], v6 offset:0
    v_mfma_f32_16x16x32_bf16 v[88:91], v[148:151], v[156:159], v[88:91]
    ds_read_b128 a[212:215], v7 offset:0
    v_mad_u32_u24 v4, v3, s57, v4
    v_mfma_f32_16x16x32_bf16 v[92:95], v[148:151], v[160:163], v[92:95]
    ds_read_b128 a[216:219], v6 offset:2048
    s_waitcnt lgkmcnt(15)
    v_mfma_f32_16x16x32_bf16 v[92:95], v[124:127], v[184:187], v[92:95]
    s_waitcnt vmcnt(2)
    s_barrier
    s_cmp_lg_u32 s52, 0
    s_cbranch_scc1 adaLN_cond__ssm_conv_s4d__mixer_gmlp__prompt_kernel_pub8
    v_mov_b32 v5, s56
    s_mov_b32 s60, 262144
    s_mov_b64 exec, 0xff
    buffer_store_dword v5, v104, s[4:7], s60 offen sc1
    s_mov_b64 exec, -1
adaLN_cond__ssm_conv_s4d__mixer_gmlp__prompt_kernel_pub8:
    v_mfma_f32_16x16x32_bf16 v[92:95], v[152:155], v[156:159], v[92:95]
    ds_read_b128 a[220:223], v7 offset:2048
    s_cmp_ge_u32 s50, 18
    s_cselect_b32 s30, s30, 1073741824
    s_waitcnt lgkmcnt(0)
    s_barrier
    v_mfma_f32_16x16x32_bf16 v[64:67], v[188:191], v[220:223], v[64:67]
    v_lshlrev_b32 v5, 3, v3
    v_add_u32 v5, 143488, v5
    v_mfma_f32_16x16x32_bf16 v[68:71], v[188:191], v[224:227], v[68:71]
    v_and_b32_e64 v6, 1, v2
    v_mfma_f32_16x16x32_bf16 v[68:71], v[192:195], v[220:223], v[68:71]
    v_lshl_add_u32 v5, v6, 8, v5
    v_mfma_f32_16x16x32_bf16 v[72:75], v[188:191], v[228:231], v[72:75]
    v_add_u32 v6, 127104, v105
    v_mfma_f32_16x16x32_bf16 v[72:75], v[192:195], v[224:227], v[72:75]
    ds_write_b128 v4, v[64:67] offset:0
    ds_read2_b64 v[124:127], v5 offset0:0 offset1:4
    v_mfma_f32_16x16x32_bf16 v[72:75], v[196:199], v[220:223], v[72:75]
    ds_read_b64_tr_b16 v[140:141], v6 offset:0
    v_mfma_f32_16x16x32_bf16 v[76:79], v[188:191], v[232:235], v[76:79]
    ds_write_b128 v4, v[68:71] offset:1280
    ds_read_b64_tr_b16 v[142:143], v6 offset:2048
    v_mfma_f32_16x16x32_bf16 v[76:79], v[192:195], v[228:231], v[76:79]
    ds_read2_b64 v[128:131], v5 offset0:8 offset1:12
    v_mfma_f32_16x16x32_bf16 v[76:79], v[196:199], v[224:227], v[76:79]
    ds_read_b64_tr_b16 v[144:145], v6 offset:4096
    v_mfma_f32_16x16x32_bf16 v[76:79], v[200:203], v[220:223], v[76:79]
    ds_write_b128 v4, v[72:75] offset:2560
    ds_read_b64_tr_b16 v[146:147], v6 offset:6144
    v_mfma_f32_16x16x32_bf16 v[80:83], v[188:191], v[236:239], v[80:83]
    ds_read2_b64 v[132:135], v5 offset0:16 offset1:20
    v_lshlrev_b32_e64 v14, 16, v45
    v_mfma_f32_16x16x32_bf16 v[80:83], v[192:195], v[232:235], v[80:83]
    ds_read_b64_tr_b16 v[148:149], v6 offset:8192
    v_and_b32 v15, 0xffff0000, v45
    v_mfma_f32_16x16x32_bf16 v[80:83], v[196:199], v[228:231], v[80:83]
    ds_read_b64_tr_b16 v[150:151], v6 offset:10240
    v_fma_f32 v24, v24, v53, v14
    v_mfma_f32_16x16x32_bf16 v[80:83], v[200:203], v[224:227], v[80:83]
    ds_write_b128 v4, v[76:79] offset:3840
    ds_read2_b64 v[136:139], v5 offset0:24 offset1:28
    v_fma_f32 v25, v25, v53, v15
    v_lshlrev_b32_e64 v26, 16, v38
    v_mfma_f32_16x16x32_bf16 v[80:83], v[204:207], v[220:223], v[80:83]
    ds_read_b64_tr_b16 v[152:153], v6 offset:12288
    v_and_b32 v27, 0xffff0000, v38
    ds_read_b64_tr_b16 v[154:155], v6 offset:14336
    v_mfma_f32_16x16x32_bf16 v[84:87], v[188:191], v[240:243], v[84:87]
    v_lshlrev_b32_e64 v14, 16, v46
    v_and_b32 v15, 0xffff0000, v46
    v_mfma_f32_16x16x32_bf16 v[84:87], v[192:195], v[236:239], v[84:87]
    v_fma_f32 v26, v26, v53, v14
    v_fma_f32 v27, v27, v53, v15
    v_mfma_f32_16x16x32_bf16 v[84:87], v[196:199], v[232:235], v[84:87]
    v_lshlrev_b32_e64 v28, 16, v39
    v_and_b32 v29, 0xffff0000, v39
    v_mfma_f32_16x16x32_bf16 v[84:87], v[200:203], v[228:231], v[84:87]
    ds_write_b128 v4, v[80:83] offset:5120
    v_lshlrev_b32_e64 v14, 16, v47
    v_and_b32 v15, 0xffff0000, v47
    v_mfma_f32_16x16x32_bf16 v[84:87], v[204:207], v[224:227], v[84:87]
    v_fma_f32 v28, v28, v53, v14
    v_fma_f32 v29, v29, v53, v15
    v_mfma_f32_16x16x32_bf16 v[84:87], v[208:211], v[220:223], v[84:87]
    v_lshlrev_b32_e64 v30, 16, v40
    v_and_b32 v31, 0xffff0000, v40
    v_mfma_f32_16x16x32_bf16 v[88:91], v[188:191], v[244:247], v[88:91]
    v_lshlrev_b32_e64 v14, 16, v48
    v_mfma_f32_16x16x32_bf16 v[88:91], v[192:195], v[240:243], v[88:91]
    v_and_b32 v15, 0xffff0000, v48
    v_fma_f32 v30, v30, v53, v14
    v_mfma_f32_16x16x32_bf16 v[88:91], v[196:199], v[236:239], v[88:91]
    v_fma_f32 v31, v31, v53, v15
    v_mfma_f32_16x16x32_bf16 v[88:91], v[200:203], v[232:235], v[88:91]
    ds_write_b128 v4, v[84:87] offset:6400
    v_lshlrev_b32_e64 v32, 16, v41
    v_and_b32 v33, 0xffff0000, v41
    v_mfma_f32_16x16x32_bf16 v[88:91], v[204:207], v[228:231], v[88:91]
    v_lshlrev_b32_e64 v14, 16, v49
    v_mfma_f32_16x16x32_bf16 v[88:91], v[208:211], v[224:227], v[88:91]
    v_and_b32 v15, 0xffff0000, v49
    v_fma_f32 v32, v32, v53, v14
    v_mfma_f32_16x16x32_bf16 v[88:91], v[212:215], v[220:223], v[88:91]
    v_fma_f32 v33, v33, v53, v15
    s_waitcnt lgkmcnt(13)
    v_mfma_f32_16x16x32_bf16 v[108:111], v[124:127], v[140:143], 0
    s_waitcnt lgkmcnt(9)
    v_mfma_f32_16x16x32_bf16 v[108:111], v[128:131], v[144:147], v[108:111]
    s_waitcnt lgkmcnt(6)
    v_mfma_f32_16x16x32_bf16 v[108:111], v[132:135], v[148:151], v[108:111]
    s_waitcnt lgkmcnt(2)
    v_mfma_f32_16x16x32_bf16 v[108:111], v[136:139], v[152:155], v[108:111]
    v_mfma_f32_16x16x32_bf16 v[92:95], v[188:191], v[248:251], v[92:95]
    v_mfma_f32_16x16x32_bf16 v[92:95], v[192:195], v[244:247], v[92:95]
    v_mfma_f32_16x16x32_bf16 v[92:95], v[196:199], v[240:243], v[92:95]
    ds_write_b128 v4, v[88:91] offset:7680
    v_mfma_f32_16x16x32_bf16 v[92:95], v[200:203], v[236:239], v[92:95]
    v_mfma_f32_16x16x32_bf16 v[92:95], v[204:207], v[232:235], v[92:95]
    v_lshlrev_b32_e64 v5, 3, v2
    s_mov_b64 exec, 0xffff
    v_mfma_f32_16x16x32_bf16 v[92:95], v[208:211], v[228:231], v[92:95]
    buffer_store_dwordx2 v[108:109], v5, s[4:7], s30 offen sc1
    s_mov_b64 exec, -1
    v_mfma_f32_16x16x32_bf16 v[92:95], v[212:215], v[224:227], v[92:95]
    v_mfma_f32_16x16x32_bf16 v[92:95], v[216:219], v[220:223], v[92:95]
    s_nop 7
    ds_write_b128 v4, v[92:95] offset:8960
    s_waitcnt lgkmcnt(0)
    s_barrier
    ds_read_b128 v[124:127], v100 offset:0
    ds_read_b128 v[128:131], v100 offset:320
    ds_read_b128 v[132:135], v100 offset:10240
    ds_read_b128 v[136:139], v100 offset:10560
    ds_read_b128 v[140:143], v100 offset:5120
    ds_read_b128 v[144:147], v100 offset:5440
    ds_read_b128 v[148:151], v100 offset:15360
    ds_read_b128 v[152:155], v100 offset:15680
    s_waitcnt lgkmcnt(5)
    v_pk_add_f32 v[124:125], v[124:125], v[132:133]
    v_pk_add_f32 v[126:127], v[126:127], v[134:135]
    s_waitcnt lgkmcnt(4)
    v_pk_add_f32 v[128:129], v[128:129], v[136:137]
    v_pk_add_f32 v[130:131], v[130:131], v[138:139]
    v_pk_fma_f32 v[124:125], v[124:125], v[52:53], v[18:19] op_sel_hi:[1,0,1]
    v_pk_fma_f32 v[126:127], v[126:127], v[52:53], v[20:21] op_sel_hi:[1,0,1]
    v_pk_fma_f32 v[128:129], v[128:129], v[52:53], v[22:23] op_sel_hi:[1,0,1]
    v_pk_fma_f32 v[130:131], v[130:131], v[52:53], v[24:25] op_sel_hi:[1,0,1]
    v_cvt_pk_bf16_f32 v42, v124, v125
    v_cvt_pk_bf16_f32 v43, v126, v127
    v_cvt_pk_bf16_f32 v44, v128, v129
    v_cvt_pk_bf16_f32 v45, v130, v131
    s_mov_b32 s57, 5373952
    buffer_store_dwordx4 v[42:45], v101, s[4:7], s57 offen sc1
    s_waitcnt lgkmcnt(1)
    v_pk_add_f32 v[140:141], v[140:141], v[148:149]
    v_pk_add_f32 v[142:143], v[142:143], v[150:151]
    s_waitcnt lgkmcnt(0)
    v_pk_add_f32 v[144:145], v[144:145], v[152:153]
    v_pk_add_f32 v[146:147], v[146:147], v[154:155]
    v_pk_fma_f32 v[140:141], v[140:141], v[52:53], v[26:27] op_sel_hi:[1,0,1]
    v_pk_fma_f32 v[142:143], v[142:143], v[52:53], v[28:29] op_sel_hi:[1,0,1]
    v_pk_fma_f32 v[144:145], v[144:145], v[52:53], v[30:31] op_sel_hi:[1,0,1]
    v_pk_fma_f32 v[146:147], v[146:147], v[52:53], v[32:33] op_sel_hi:[1,0,1]
    v_cvt_pk_bf16_f32 v46, v140, v141
    v_cvt_pk_bf16_f32 v47, v142, v143
    v_cvt_pk_bf16_f32 v48, v144, v145
    v_cvt_pk_bf16_f32 v49, v146, v147
    s_mov_b32 s57, 6430720
    buffer_store_dwordx4 v[46:49], v101, s[4:7], s57 offen sc1
    s_mov_b32 s60, 262144
    buffer_load_dword v7, v16, s[4:7], s60 offen sc1
    v_add_u32 v14, s82, v12
    v_add_u32 v15, s82, v13
    ds_read_b128 a[16:19], v14 offset:0
    ds_read_b128 a[20:23], v15 offset:0
    ds_read_b128 a[24:27], v14 offset:2048
    ds_read_b128 a[28:31], v15 offset:2048
    ds_read_b128 a[80:83], v14 offset:4096
    ds_read_b128 a[84:87], v15 offset:4096
    ds_read_b128 a[88:91], v14 offset:6144
    ds_read_b128 a[92:95], v15 offset:6144
    v_add_u32 v14, s81, v12
    v_add_u32 v15, s81, v13
    ds_read_b128 a[144:147], v14 offset:0
    ds_read_b128 a[148:151], v15 offset:0
    ds_read_b128 a[152:155], v14 offset:2048
    ds_read_b128 a[156:159], v15 offset:2048
    v_lshlrev_b32_e64 v252, 4, v1
    s_lshl_b32 s17, s54, 1
    s_add_u32 s17, s17, 1
    s_lshl_b32 s17, s17, 4
    s_add_u32 s17, s17, s52
    s_mul_i32 s17, s17, 7168
    s_add_u32 s17, s17, 7602176
    s_mul_i32 s19, s52, 7168
    s_waitcnt vmcnt(0)
    v_cmp_ne_u32_e64 vcc, s56, v7
    s_mov_b32 s59, 0
    s_cbranch_vccz adaLN_cond__ssm_conv_s4d__mixer_gmlp__prompt_kernel_polld10
adaLN_cond__ssm_conv_s4d__mixer_gmlp__prompt_kernel_poll9:
    s_sleep 2
    s_mov_b32 s60, 262144
    buffer_load_dword v7, v16, s[4:7], s60 offen sc1
    s_add_u32 s59, s59, 1
    s_waitcnt vmcnt(0)
    v_cmp_ne_u32_e64 vcc, s56, v7
    s_nop 0
    s_cbranch_vccz adaLN_cond__ssm_conv_s4d__mixer_gmlp__prompt_kernel_polld10
    s_cmp_lt_u32 s59, 524288
    s_cbranch_scc1 adaLN_cond__ssm_conv_s4d__mixer_gmlp__prompt_kernel_poll9
adaLN_cond__ssm_conv_s4d__mixer_gmlp__prompt_kernel_polld10:
    s_waitcnt lgkmcnt(0)
    s_barrier
    s_cmp_lg_u32 s52, 0
    s_cbranch_scc1 adaLN_cond__ssm_conv_s4d__mixer_gmlp__prompt_kernel_pub11
    v_mov_b32 v4, s56
    s_mov_b32 s60, 196608
    s_mov_b64 exec, 0xff
    buffer_store_dword v4, v104, s[4:7], s60 offen sc1
    s_mov_b64 exec, -1
adaLN_cond__ssm_conv_s4d__mixer_gmlp__prompt_kernel_pub11:
adaLN_cond__ssm_conv_s4d__mixer_gmlp__prompt_kernel_g1c3:
    s_lshl_b32 s18, s52, 14
    s_add_u32 s18, s18, 86016
    s_add_u32 m0, s19, 0
    s_nop 0
    buffer_load_dwordx4 v252, s[4:7], s17 offen offset:0 sc1 lds
    buffer_load_dwordx4 v252, s[4:7], s17 offen offset:1024 sc1 lds
    buffer_load_dwordx4 v252, s[4:7], s17 offen offset:2048 sc1 lds
    buffer_load_dwordx4 v252, s[4:7], s17 offen offset:3072 sc1 lds
    s_add_u32 m0, s19, 4096
    s_add_u32 s17, s17, 4096
    buffer_load_dwordx4 v252, s[4:7], s17 offen offset:0 sc1 lds
    buffer_load_dwordx4 v252, s[4:7], s17 offen offset:1024 sc1 lds
    buffer_load_dwordx4 v252, s[4:7], s17 offen offset:2048 sc1 lds
    s_add_u32 s17, s17, 24576
    s_add_u32 m0, s19, 28672
    s_nop 0
    s_nop 0
    buffer_load_dwordx4 v252, s[4:7], s17 offen offset:0 sc1 lds
    buffer_load_dwordx4 v252, s[4:7], s17 offen offset:1024 sc1 lds
    buffer_load_dwordx4 v252, s[4:7], s17 offen offset:2048 sc1 lds
    buffer_load_dwordx4 v252, s[4:7], s17 offen offset:3072 sc1 lds
    s_add_u32 m0, s19, 32768
    s_add_u32 s17, s17, 4096
    buffer_load_dwordx4 v252, s[4:7], s17 offen offset:0 sc1 lds
    buffer_load_dwordx4 v252, s[4:7], s17 offen offset:1024 sc1 lds
    buffer_load_dwordx4 v252, s[4:7], s17 offen offset:2048 sc1 lds
    s_add_u32 s17, s17, 24576
    s_add_u32 m0, s19, 57344
    s_nop 0
    s_nop 0
    buffer_load_dwordx4 v252, s[4:7], s17 offen offset:0 sc1 lds
    buffer_load_dwordx4 v252, s[4:7], s17 offen offset:1024 sc1 lds
    buffer_load_dwordx4 v252, s[4:7], s17 offen offset:2048 sc1 lds
    v_lshlrev_b32 v17, 3, v1
    s_lshl_b32 s57, s76, 15
    s_add_u32 s57, s57, 86016
    v_add_u32 v19, s57, v17
    v_lshrrev_b32 v4, 2, v1
    s_movk_i32 s57, 224
    v_and_b32 v5, 3, v1
    v_lshlrev_b32_e64 v5, 3, v5
    v_mad_u32_u24 v224, v4, s57, v5
    v_add_u32 v225, 57344, v224
    s_lshl_b32 s16, s53, 2
    s_add_u32 s16, s16, s52
    s_mul_i32 s16, s16, 16512
    s_add_u32 s16, s16, 5373952
    s_mov_b32 s22, 0xbdd2d3e8
    s_mov_b32 s23, 0xc0135761
    v_mov_b32 v204, 0x3f803f80
    v_mov_b32 v205, 0x3f803f80
    v_mov_b32 v206, 0x3f803f80
    v_mov_b32 v207, 0x3f803f80
    s_mul_i32 s57, s76, 7168
    s_add_u32 s57, s57, 139264
    v_add_u32 v226, s57, v17
    v_lshrrev_b32 v4, 3, v1
    v_and_b32 v5, 6, v4
    v_xor_b32 v5, v5, v1
    v_and_b32 v5, 7, v5
    v_lshlrev_b32 v5, 4, v5
    v_lshl_add_u32 v18, v4, 10, v5
    s_mul_i32 s26, s52, 57344
    s_lshl_b32 s57, s54, 7
    s_add_u32 s26, s26, s57
    s_mov_b32 s8, s38
    s_mov_b32 s9, s39
    s_mov_b32 s10, 0xe0000
    s_mov_b32 s11, 0x20000
    s_lshl_b32 s29, s53, 2
    s_add_u32 s29, s29, s52
    s_mul_i32 s29, s29, 28672
    s_add_u32 s29, s29, 13631488
    s_mul_i32 s28, s54, 3584
    s_add_u32 s28, s28, s29
    s_waitcnt vmcnt(10)
    s_mov_b32 s60, 196608
    buffer_load_dword v253, v16, s[4:7], s60 offen sc1
    buffer_load_dwordx4 v252, s[4:7], s17 offen offset:3072 sc1 lds
    s_add_u32 m0, s19, 61440
    s_add_u32 s17, s17, 4096
    buffer_load_dwordx4 v252, s[4:7], s17 offen offset:0 sc1 lds
    buffer_load_dwordx4 v252, s[4:7], s17 offen offset:1024 sc1 lds
    buffer_load_dwordx4 v252, s[4:7], s17 offen offset:2048 sc1 lds
    s_add_u32 s17, s17, 24576
    s_waitcnt vmcnt(4)
    v_cmp_ne_u32_e64 vcc, s56, v253
    s_mov_b32 s59, 0
    s_cbranch_vccz adaLN_cond__ssm_conv_s4d__mixer_gmlp__prompt_kernel_polld13
adaLN_cond__ssm_conv_s4d__mixer_gmlp__prompt_kernel_poll12:
    s_sleep 2
    s_mov_b32 s60, 196608
    buffer_load_dword v253, v16, s[4:7], s60 offen sc1
    s_add_u32 s59, s59, 1
    s_waitcnt vmcnt(0)
    v_cmp_ne_u32_e64 vcc, s56, v253
    s_nop 0
    s_cbranch_vccz adaLN_cond__ssm_conv_s4d__mixer_gmlp__prompt_kernel_polld13
    s_cmp_lt_u32 s59, 524288
    s_cbranch_scc1 adaLN_cond__ssm_conv_s4d__mixer_gmlp__prompt_kernel_poll12
adaLN_cond__ssm_conv_s4d__mixer_gmlp__prompt_kernel_polld13:
    s_waitcnt lgkmcnt(0)
    s_barrier
    s_add_u32 m0, s18, 0
    s_nop 0
    s_nop 0
    buffer_load_dwordx4 v252, s[4:7], s16 offen offset:0 sc1 lds
    buffer_load_dwordx4 v252, s[4:7], s16 offen offset:1024 sc1 lds
    buffer_load_dwordx4 v252, s[4:7], s16 offen offset:2048 sc1 lds
    buffer_load_dwordx4 v252, s[4:7], s16 offen offset:3072 sc1 lds
    s_add_u32 m0, s18, 4096
    s_add_u32 s16, s16, 4096
    buffer_load_dwordx4 v252, s[4:7], s16 offen offset:0 sc1 lds
    buffer_load_dwordx4 v252, s[4:7], s16 offen offset:1024 sc1 lds
    buffer_load_dwordx4 v252, s[4:7], s16 offen offset:2048 sc1 lds
    buffer_load_dwordx4 v252, s[4:7], s16 offen offset:3072 sc1 lds
    s_add_u32 m0, s18, 8192
    s_add_u32 s16, s16, 4096
    buffer_load_dwordx4 v252, s[4:7], s16 offen offset:0 sc1 lds
    buffer_load_dwordx4 v252, s[4:7], s16 offen offset:1024 sc1 lds
    buffer_load_dwordx4 v252, s[4:7], s16 offen offset:2048 sc1 lds
    buffer_load_dwordx4 v252, s[4:7], s16 offen offset:3072 sc1 lds
    s_add_u32 m0, s18, 12288
    s_add_u32 s16, s16, 4096
    buffer_load_dwordx4 v252, s[4:7], s16 offen offset:0 sc1 lds
    buffer_load_dwordx4 v252, s[4:7], s16 offen offset:1024 sc1 lds
    buffer_load_dwordx4 v252, s[4:7], s16 offen offset:2048 sc1 lds
    buffer_load_dwordx4 v252, s[4:7], s16 offen offset:3072 sc1 lds
    s_cmp_eq_u32 s77, 1
    s_cbranch_scc1 adaLN_cond__ssm_conv_s4d__mixer_gmlp__prompt_kernel_role114
    s_waitcnt vmcnt(12)
    s_barrier
    ds_read_b64_tr_b16 a[32:33], v19 offset:0
    ds_read_b64_tr_b16 a[34:35], v19 offset:512
    ds_read_b64_tr_b16 a[36:37], v19 offset:16384
    ds_read_b64_tr_b16 a[38:39], v19 offset:16896
    ds_read_b64_tr_b16 v[84:85], v224 offset:0
    ds_read_b64_tr_b16 v[86:87], v224 offset:3584
    ds_read_b64_tr_b16 v[88:89], v224 offset:32
    ds_read_b64_tr_b16 v[90:91], v224 offset:3616
    ds_read_b64_tr_b16 v[92:93], v224 offset:64
    ds_read_b64_tr_b16 v[94:95], v224 offset:3648
    ds_read_b64_tr_b16 v[96:97], v224 offset:96
    ds_read_b64_tr_b16 v[98:99], v224 offset:3680
    s_waitcnt lgkmcnt(6)
    v_mfma_f32_16x16x32_bf16 v[28:31], a[32:35], v[84:87], 0
    s_nop 0
    ds_read_b64_tr_b16 a[40:41], v19 offset:1024
    s_mul_i32 s24, s54, 896
    s_add_u32 s24, s24, 720896
    v_cmp_le_u32 vcc, 112, v0
    v_lshlrev_b32_e64 v4, 3, v0
    v_mfma_f32_16x16x32_bf16 v[32:35], a[36:39], v[84:87], 0
    ds_read_b64_tr_b16 a[42:43], v19 offset:1536
    ds_read_b64_tr_b16 a[44:45], v19 offset:17408
    v_mfma_f32_16x16x32_bf16 v[184:187], a[32:35], v[204:207], 0
    ds_read_b64_tr_b16 a[46:47], v19 offset:17920
    s_waitcnt lgkmcnt(8)
    v_mfma_f32_16x16x32_bf16 v[36:39], a[32:35], v[88:91], 0
    ds_read_b64_tr_b16 v[100:101], v224 offset:7168
    ds_read_b64_tr_b16 v[102:103], v224 offset:10752
    v_mfma_f32_16x16x32_bf16 v[40:43], a[36:39], v[88:91], 0
    ds_read_b64_tr_b16 v[104:105], v224 offset:7200
    v_add_u32 v5, 6272, v4
    v_cndmask_b32_e64 v5, v4, v5, vcc
    s_waitcnt lgkmcnt(9)
    v_mfma_f32_16x16x32_bf16 v[44:47], a[32:35], v[92:95], 0
    ds_read_b64_tr_b16 v[106:107], v224 offset:10784
    ds_read_b64_tr_b16 v[108:109], v224 offset:7232
    v_mfma_f32_16x16x32_bf16 v[48:51], a[36:39], v[92:95], 0
    ds_read_b64_tr_b16 v[110:111], v224 offset:10816
    s_waitcnt lgkmcnt(10)
    v_mfma_f32_16x16x32_bf16 v[52:55], a[32:35], v[96:99], 0
    ds_read_b64_tr_b16 v[112:113], v224 offset:7264
    v_mfma_f32_16x16x32_bf16 v[56:59], a[36:39], v[96:99], 0
    s_nop 0
    ds_read_b64_tr_b16 v[114:115], v224 offset:10848
    buffer_load_dwordx2 v[196:197], v5, s[4:7], s24 offen sc1
    s_add_u32 s24, s24, 14336
    s_waitcnt lgkmcnt(6)
    v_mfma_f32_16x16x32_bf16 v[28:31], a[40:43], v[100:103], v[28:31]
    ds_read_b64_tr_b16 a[48:49], v19 offset:2048
    buffer_load_dwordx2 v[198:199], v5, s[4:7], s24 offen sc1
    s_add_u32 s24, s24, 14336
    v_mfma_f32_16x16x32_bf16 v[32:35], a[44:47], v[100:103], v[32:35]
    ds_read_b64_tr_b16 a[50:51], v19 offset:2560
    ds_read_b64_tr_b16 a[52:53], v19 offset:18432
    v_mfma_f32_16x16x32_bf16 v[184:187], a[40:43], v[204:207], v[184:187]
    ds_read_b64_tr_b16 a[54:55], v19 offset:18944
    s_waitcnt lgkmcnt(8)
    v_mfma_f32_16x16x32_bf16 v[36:39], a[40:43], v[104:107], v[36:39]
    ds_read_b64_tr_b16 v[84:85], v224 offset:14336
    ds_read_b64_tr_b16 v[86:87], v224 offset:17920
    v_mfma_f32_16x16x32_bf16 v[40:43], a[44:47], v[104:107], v[40:43]
    ds_read_b64_tr_b16 v[88:89], v224 offset:14368
    buffer_load_dwordx2 v[200:201], v5, s[4:7], s24 offen sc1
    s_add_u32 s24, s24, 14336
    s_waitcnt lgkmcnt(9)
    v_mfma_f32_16x16x32_bf16 v[44:47], a[40:43], v[108:111], v[44:47]
    ds_read_b64_tr_b16 v[90:91], v224 offset:17952
    ds_read_b64_tr_b16 v[92:93], v224 offset:14400
    v_mfma_f32_16x16x32_bf16 v[48:51], a[44:47], v[108:111], v[48:51]
    ds_read_b64_tr_b16 v[94:95], v224 offset:17984
    s_waitcnt lgkmcnt(10)
    v_mfma_f32_16x16x32_bf16 v[52:55], a[40:43], v[112:115], v[52:55]
    ds_read_b64_tr_b16 v[96:97], v224 offset:14432
    v_mfma_f32_16x16x32_bf16 v[56:59], a[44:47], v[112:115], v[56:59]
    ds_read_b64_tr_b16 v[98:99], v224 offset:18016
    buffer_load_dwordx2 v[202:203], v5, s[4:7], s24 offen sc1
    s_add_u32 s24, s24, 14336
    s_waitcnt lgkmcnt(6)
    v_mfma_f32_16x16x32_bf16 v[28:31], a[48:51], v[84:87], v[28:31]
    ds_read_b64_tr_b16 a[56:57], v19 offset:3072
    ds_read_b64_tr_b16 a[58:59], v19 offset:3584
    v_mfma_f32_16x16x32_bf16 v[32:35], a[52:55], v[84:87], v[32:35]
    ds_read_b64_tr_b16 a[60:61], v19 offset:19456
    ds_read_b64_tr_b16 a[62:63], v19 offset:19968
    v_mfma_f32_16x16x32_bf16 v[184:187], a[48:51], v[204:207], v[184:187]
    ds_read_b64_tr_b16 v[100:101], v224 offset:21504
    ds_read_b64_tr_b16 v[102:103], v224 offset:25088
    s_waitcnt lgkmcnt(10)
    v_mfma_f32_16x16x32_bf16 v[36:39], a[48:51], v[88:91], v[36:39]
    ds_read_b64_tr_b16 v[104:105], v224 offset:21536
    ds_read_b64_tr_b16 v[106:107], v224 offset:25120
    v_mfma_f32_16x16x32_bf16 v[40:43], a[52:55], v[88:91], v[40:43]
    ds_read_b64_tr_b16 v[108:109], v224 offset:21568
    ds_read_b64_tr_b16 v[110:111], v224 offset:25152
    s_waitcnt lgkmcnt(12)
    v_mfma_f32_16x16x32_bf16 v[44:47], a[48:51], v[92:95], v[44:47]
    ds_read_b64_tr_b16 v[112:113], v224 offset:21600
    ds_read_b64_tr_b16 v[114:115], v224 offset:25184
    v_mfma_f32_16x16x32_bf16 v[48:51], a[52:55], v[92:95], v[48:51]
    s_waitcnt lgkmcnt(12)
    v_mfma_f32_16x16x32_bf16 v[52:55], a[48:51], v[96:99], v[52:55]
    v_mfma_f32_16x16x32_bf16 v[56:59], a[52:55], v[96:99], v[56:59]
    s_waitcnt vmcnt(12)
    s_waitcnt lgkmcnt(0)
    s_barrier
    v_mfma_f32_16x16x32_bf16 v[28:31], a[56:59], v[100:103], v[28:31]
    ds_read_b64_tr_b16 a[96:97], v19 offset:4096
    s_add_u32 m0, s19, 0
    s_nop 0
    buffer_load_dwordx4 v252, s[4:7], s17 offen offset:0 sc1 lds
    v_mfma_f32_16x16x32_bf16 v[32:35], a[60:63], v[100:103], v[32:35]
    ds_read_b64_tr_b16 a[98:99], v19 offset:4608
    ds_read_b64_tr_b16 a[100:101], v19 offset:20480
    v_mfma_f32_16x16x32_bf16 v[184:187], a[56:59], v[204:207], v[184:187]
    ds_read_b64_tr_b16 a[102:103], v19 offset:20992
    v_mfma_f32_16x16x32_bf16 v[36:39], a[56:59], v[104:107], v[36:39]
    ds_read_b64_tr_b16 v[84:85], v224 offset:28672
    ds_read_b64_tr_b16 v[86:87], v224 offset:32256
    v_mfma_f32_16x16x32_bf16 v[40:43], a[60:63], v[104:107], v[40:43]
    ds_read_b64_tr_b16 v[88:89], v224 offset:28704
    buffer_load_dwordx4 v252, s[4:7], s17 offen offset:1024 sc1 lds
    v_mfma_f32_16x16x32_bf16 v[44:47], a[56:59], v[108:111], v[44:47]
    ds_read_b64_tr_b16 v[90:91], v224 offset:32288
    ds_read_b64_tr_b16 v[92:93], v224 offset:28736
    v_mfma_f32_16x16x32_bf16 v[48:51], a[60:63], v[108:111], v[48:51]
    ds_read_b64_tr_b16 v[94:95], v224 offset:32320
    v_mfma_f32_16x16x32_bf16 v[52:55], a[56:59], v[112:115], v[52:55]
    ds_read_b64_tr_b16 v[96:97], v224 offset:28768
    v_mfma_f32_16x16x32_bf16 v[56:59], a[60:63], v[112:115], v[56:59]
    ds_read_b64_tr_b16 v[98:99], v224 offset:32352
    buffer_load_dwordx4 v252, s[4:7], s17 offen offset:2048 sc1 lds
    s_waitcnt lgkmcnt(6)
    v_mfma_f32_16x16x32_bf16 v[28:31], a[96:99], v[84:87], v[28:31]
    ds_read_b64_tr_b16 a[104:105], v19 offset:5120
    buffer_load_dwordx4 v252, s[4:7], s17 offen offset:3072 sc1 lds
    v_mfma_f32_16x16x32_bf16 v[32:35], a[100:103], v[84:87], v[32:35]
    ds_read_b64_tr_b16 a[106:107], v19 offset:5632
    ds_read_b64_tr_b16 a[108:109], v19 offset:21504
    v_mfma_f32_16x16x32_bf16 v[184:187], a[96:99], v[204:207], v[184:187]
    ds_read_b64_tr_b16 a[110:111], v19 offset:22016
    s_waitcnt lgkmcnt(8)
    v_mfma_f32_16x16x32_bf16 v[36:39], a[96:99], v[88:91], v[36:39]
    ds_read_b64_tr_b16 v[100:101], v224 offset:35840
    ds_read_b64_tr_b16 v[102:103], v224 offset:39424
    v_mfma_f32_16x16x32_bf16 v[40:43], a[100:103], v[88:91], v[40:43]
    s_nop 0
    ds_read_b64_tr_b16 v[104:105], v224 offset:35872
    s_add_u32 m0, s19, 4096
    s_add_u32 s17, s17, 4096
    buffer_load_dwordx4 v252, s[4:7], s17 offen offset:0 sc1 lds
    s_waitcnt lgkmcnt(9)
    v_mfma_f32_16x16x32_bf16 v[44:47], a[96:99], v[92:95], v[44:47]
    ds_read_b64_tr_b16 v[106:107], v224 offset:39456
    ds_read_b64_tr_b16 v[108:109], v224 offset:35904
    v_mfma_f32_16x16x32_bf16 v[48:51], a[100:103], v[92:95], v[48:51]
    ds_read_b64_tr_b16 v[110:111], v224 offset:39488
    s_waitcnt lgkmcnt(10)
    v_mfma_f32_16x16x32_bf16 v[52:55], a[96:99], v[96:99], v[52:55]
    ds_read_b64_tr_b16 v[112:113], v224 offset:35936
    v_mfma_f32_16x16x32_bf16 v[56:59], a[100:103], v[96:99], v[56:59]
    ds_read_b64_tr_b16 v[114:115], v224 offset:39520
    buffer_load_dwordx4 v252, s[4:7], s17 offen offset:1024 sc1 lds
    s_waitcnt lgkmcnt(6)
    v_mfma_f32_16x16x32_bf16 v[28:31], a[104:107], v[100:103], v[28:31]
    ds_read_b64_tr_b16 a[112:113], v19 offset:6144
    buffer_load_dwordx4 v252, s[4:7], s17 offen offset:2048 sc1 lds
    s_add_u32 s17, s17, 4294762496
    v_mfma_f32_16x16x32_bf16 v[32:35], a[108:111], v[100:103], v[32:35]
    ds_read_b64_tr_b16 a[114:115], v19 offset:6656
    ds_read_b64_tr_b16 a[116:117], v19 offset:22528
    v_mfma_f32_16x16x32_bf16 v[184:187], a[104:107], v[204:207], v[184:187]
    ds_read_b64_tr_b16 a[118:119], v19 offset:23040
    s_waitcnt lgkmcnt(8)
    v_mfma_f32_16x16x32_bf16 v[36:39], a[104:107], v[104:107], v[36:39]
    ds_read_b64_tr_b16 v[84:85], v224 offset:43008
    ds_read_b64_tr_b16 v[86:87], v224 offset:46592
    v_mfma_f32_16x16x32_bf16 v[40:43], a[108:111], v[104:107], v[40:43]
    ds_read_b64_tr_b16 v[88:89], v224 offset:43040
    v_mov_b32 v168, -1
    v_mov_b32 v169, -1
    v_mov_b32 v170, -1
    v_mov_b32_e64 v171, -1
    s_waitcnt lgkmcnt(9)
    v_mfma_f32_16x16x32_bf16 v[44:47], a[104:107], v[108:111], v[44:47]
    ds_read_b64_tr_b16 v[90:91], v224 offset:46624
    ds_read_b64_tr_b16 v[92:93], v224 offset:43072
    v_mfma_f32_16x16x32_bf16 v[48:51], a[108:111], v[108:111], v[48:51]
    ds_read_b64_tr_b16 v[94:95], v224 offset:46656
    s_waitcnt lgkmcnt(10)
    v_mfma_f32_16x16x32_bf16 v[52:55], a[104:107], v[112:115], v[52:55]
    ds_read_b64_tr_b16 v[96:97], v224 offset:43104
    v_mfma_f32_16x16x32_bf16 v[56:59], a[108:111], v[112:115], v[56:59]
    ds_read_b64_tr_b16 v[98:99], v224 offset:46688
    buffer_store_dwordx4 v[168:171], v252, s[4:7], s28 offen offset:0 sc1
    s_waitcnt lgkmcnt(6)
    v_mfma_f32_16x16x32_bf16 v[28:31], a[112:115], v[84:87], v[28:31]
    ds_read_b64_tr_b16 a[120:121], v19 offset:7168
    ds_read_b64_tr_b16 a[122:123], v19 offset:7680
    v_mfma_f32_16x16x32_bf16 v[32:35], a[116:119], v[84:87], v[32:35]
    ds_read_b64_tr_b16 a[124:125], v19 offset:23552
    ds_read_b64_tr_b16 a[126:127], v19 offset:24064
    v_mfma_f32_16x16x32_bf16 v[184:187], a[112:115], v[204:207], v[184:187]
    ds_read_b64_tr_b16 v[100:101], v224 offset:50176
    ds_read_b64_tr_b16 v[102:103], v224 offset:53760
    s_waitcnt lgkmcnt(10)
    v_mfma_f32_16x16x32_bf16 v[36:39], a[112:115], v[88:91], v[36:39]
    ds_read_b64_tr_b16 v[104:105], v224 offset:50208
    ds_read_b64_tr_b16 v[106:107], v224 offset:53792
    v_mfma_f32_16x16x32_bf16 v[40:43], a[116:119], v[88:91], v[40:43]
    ds_read_b64_tr_b16 v[108:109], v224 offset:50240
    ds_read_b64_tr_b16 v[110:111], v224 offset:53824
    s_waitcnt lgkmcnt(12)
    v_mfma_f32_16x16x32_bf16 v[44:47], a[112:115], v[92:95], v[44:47]
    ds_read_b64_tr_b16 v[112:113], v224 offset:50272
    ds_read_b64_tr_b16 v[114:115], v224 offset:53856
    buffer_store_dwordx4 v[168:171], v252, s[4:7], s28 offen offset:1024 sc1
    v_mfma_f32_16x16x32_bf16 v[48:51], a[116:119], v[92:95], v[48:51]
    s_waitcnt lgkmcnt(12)
    v_mfma_f32_16x16x32_bf16 v[52:55], a[112:115], v[96:99], v[52:55]
    buffer_store_dwordx4 v[168:171], v252, s[4:7], s28 offen offset:2048 sc1
    v_mfma_f32_16x16x32_bf16 v[56:59], a[116:119], v[96:99], v[56:59]
    buffer_store_dwordx2 v[168:169], v17, s[4:7], s28 offen offset:3072 sc1
    s_waitcnt vmcnt(19)
    s_waitcnt lgkmcnt(0)
    s_barrier
    v_mfma_f32_16x16x32_bf16 v[28:31], a[120:123], v[100:103], v[28:31]
    ds_read_b64_tr_b16 a[160:161], v19 offset:8192
    s_add_u32 m0, s19, 28672
    s_nop 0
    buffer_load_dwordx4 v252, s[4:7], s17 offen offset:0 sc1 lds
    v_mfma_f32_16x16x32_bf16 v[32:35], a[124:127], v[100:103], v[32:35]
    ds_read_b64_tr_b16 a[162:163], v19 offset:8704
    ds_read_b64_tr_b16 a[164:165], v19 offset:24576
    v_mfma_f32_16x16x32_bf16 v[184:187], a[120:123], v[204:207], v[184:187]
    ds_read_b64_tr_b16 a[166:167], v19 offset:25088
    v_mfma_f32_16x16x32_bf16 v[36:39], a[120:123], v[104:107], v[36:39]
    ds_read_b64_tr_b16 v[84:85], v225 offset:0
    ds_read_b64_tr_b16 v[86:87], v225 offset:3584
    v_mfma_f32_16x16x32_bf16 v[40:43], a[124:127], v[104:107], v[40:43]
    ds_read_b64_tr_b16 v[88:89], v225 offset:32
    buffer_load_dwordx4 v252, s[4:7], s17 offen offset:1024 sc1 lds
    v_mfma_f32_16x16x32_bf16 v[44:47], a[120:123], v[108:111], v[44:47]
    ds_read_b64_tr_b16 v[90:91], v225 offset:3616
    ds_read_b64_tr_b16 v[92:93], v225 offset:64
    v_mfma_f32_16x16x32_bf16 v[48:51], a[124:127], v[108:111], v[48:51]
    ds_read_b64_tr_b16 v[94:95], v225 offset:3648
    v_mfma_f32_16x16x32_bf16 v[52:55], a[120:123], v[112:115], v[52:55]
    ds_read_b64_tr_b16 v[96:97], v225 offset:96
    v_mfma_f32_16x16x32_bf16 v[56:59], a[124:127], v[112:115], v[56:59]
    ds_read_b64_tr_b16 v[98:99], v225 offset:3680
    buffer_load_dwordx4 v252, s[4:7], s17 offen offset:2048 sc1 lds
    s_waitcnt lgkmcnt(6)
    v_mfma_f32_16x16x32_bf16 v[28:31], a[160:163], v[84:87], v[28:31]
    ds_read_b64_tr_b16 a[168:169], v19 offset:9216
    buffer_load_dwordx4 v252, s[4:7], s17 offen offset:3072 sc1 lds
    v_mfma_f32_16x16x32_bf16 v[32:35], a[164:167], v[84:87], v[32:35]
    ds_read_b64_tr_b16 a[170:171], v19 offset:9728
    ds_read_b64_tr_b16 a[172:173], v19 offset:25600
    v_mfma_f32_16x16x32_bf16 v[184:187], a[160:163], v[204:207], v[184:187]
    ds_read_b64_tr_b16 a[174:175], v19 offset:26112
    s_waitcnt lgkmcnt(8)
    v_mfma_f32_16x16x32_bf16 v[36:39], a[160:163], v[88:91], v[36:39]
    ds_read_b64_tr_b16 v[100:101], v225 offset:7168
    ds_read_b64_tr_b16 v[102:103], v225 offset:10752
    v_mfma_f32_16x16x32_bf16 v[40:43], a[164:167], v[88:91], v[40:43]
    s_nop 0
    ds_read_b64_tr_b16 v[104:105], v225 offset:7200
    s_add_u32 m0, s19, 32768
    s_add_u32 s17, s17, 4096
    buffer_load_dwordx4 v252, s[4:7], s17 offen offset:0 sc1 lds
    s_waitcnt lgkmcnt(9)
    v_mfma_f32_16x16x32_bf16 v[44:47], a[160:163], v[92:95], v[44:47]
    ds_read_b64_tr_b16 v[106:107], v225 offset:10784
    ds_read_b64_tr_b16 v[108:109], v225 offset:7232
    v_mfma_f32_16x16x32_bf16 v[48:51], a[164:167], v[92:95], v[48:51]
    ds_read_b64_tr_b16 v[110:111], v225 offset:10816
    s_waitcnt lgkmcnt(10)
    v_mfma_f32_16x16x32_bf16 v[52:55], a[160:163], v[96:99], v[52:55]
    ds_read_b64_tr_b16 v[112:113], v225 offset:7264
    v_mfma_f32_16x16x32_bf16 v[56:59], a[164:167], v[96:99], v[56:59]
    ds_read_b64_tr_b16 v[114:115], v225 offset:10848
    buffer_load_dwordx4 v252, s[4:7], s17 offen offset:1024 sc1 lds
    s_waitcnt lgkmcnt(6)
    v_mfma_f32_16x16x32_bf16 v[28:31], a[168:171], v[100:103], v[28:31]
    ds_read_b64_tr_b16 a[176:177], v19 offset:10240
    buffer_load_dwordx4 v252, s[4:7], s17 offen offset:2048 sc1 lds
    s_add_u32 s17, s17, 24576
    v_mfma_f32_16x16x32_bf16 v[32:35], a[172:175], v[100:103], v[32:35]
    ds_read_b64_tr_b16 a[178:179], v19 offset:10752
    ds_read_b64_tr_b16 a[180:181], v19 offset:26624
    v_mfma_f32_16x16x32_bf16 v[184:187], a[168:171], v[204:207], v[184:187]
    ds_read_b64_tr_b16 a[182:183], v19 offset:27136
    s_waitcnt lgkmcnt(8)
    v_mfma_f32_16x16x32_bf16 v[36:39], a[168:171], v[104:107], v[36:39]
    ds_read_b64_tr_b16 v[84:85], v225 offset:14336
    ds_read_b64_tr_b16 v[86:87], v225 offset:17920
    v_mfma_f32_16x16x32_bf16 v[40:43], a[172:175], v[104:107], v[40:43]
    ds_read_b64_tr_b16 v[88:89], v225 offset:14368
    s_waitcnt vmcnt(20)
    v_add_f32 v196, v196, v198
    s_waitcnt vmcnt(18)
    v_add_f32_e64 v200, v200, v202
    s_waitcnt lgkmcnt(9)
    v_mfma_f32_16x16x32_bf16 v[44:47], a[168:171], v[108:111], v[44:47]
    ds_read_b64_tr_b16 v[90:91], v225 offset:17952
    ds_read_b64_tr_b16 v[92:93], v225 offset:14400
    v_mfma_f32_16x16x32_bf16 v[48:51], a[172:175], v[108:111], v[48:51]
    ds_read_b64_tr_b16 v[94:95], v225 offset:17984
    s_waitcnt lgkmcnt(10)
    v_mfma_f32_16x16x32_bf16 v[52:55], a[168:171], v[112:115], v[52:55]
    ds_read_b64_tr_b16 v[96:97], v225 offset:14432
    v_mfma_f32_16x16x32_bf16 v[56:59], a[172:175], v[112:115], v[56:59]
    ds_read_b64_tr_b16 v[98:99], v225 offset:18016
    v_add_f32 v197, v197, v199
    v_add_f32 v201, v201, v203
    s_waitcnt lgkmcnt(6)
    v_mfma_f32_16x16x32_bf16 v[28:31], a[176:179], v[84:87], v[28:31]
    ds_read_b64_tr_b16 a[184:185], v19 offset:11264
    ds_read_b64_tr_b16 a[186:187], v19 offset:11776
    v_mfma_f32_16x16x32_bf16 v[32:35], a[180:183], v[84:87], v[32:35]
    ds_read_b64_tr_b16 a[188:189], v19 offset:27648
    ds_read_b64_tr_b16 a[190:191], v19 offset:28160
    v_mfma_f32_16x16x32_bf16 v[184:187], a[176:179], v[204:207], v[184:187]
    ds_read_b64_tr_b16 v[100:101], v225 offset:21504
    ds_read_b64_tr_b16 v[102:103], v225 offset:25088
    s_waitcnt lgkmcnt(10)
    v_mfma_f32_16x16x32_bf16 v[36:39], a[176:179], v[88:91], v[36:39]
    ds_read_b64_tr_b16 v[104:105], v225 offset:21536
    ds_read_b64_tr_b16 v[106:107], v225 offset:25120
    v_mfma_f32_16x16x32_bf16 v[40:43], a[180:183], v[88:91], v[40:43]
    ds_read_b64_tr_b16 v[108:109], v225 offset:21568
    ds_read_b64_tr_b16 v[110:111], v225 offset:25152
    s_waitcnt lgkmcnt(12)
    v_mfma_f32_16x16x32_bf16 v[44:47], a[176:179], v[92:95], v[44:47]
    ds_read_b64_tr_b16 v[112:113], v225 offset:21600
    ds_read_b64_tr_b16 v[114:115], v225 offset:25184
    v_mfma_f32_16x16x32_bf16 v[48:51], a[180:183], v[92:95], v[48:51]
    s_waitcnt lgkmcnt(12)
    v_mfma_f32_16x16x32_bf16 v[52:55], a[176:179], v[96:99], v[52:55]
    v_mfma_f32_16x16x32_bf16 v[56:59], a[180:183], v[96:99], v[56:59]
    v_add_f32 v196, v196, v200
    v_add_f32 v197, v197, v201
    s_waitcnt vmcnt(11)
    s_waitcnt lgkmcnt(0)
    s_barrier
    v_mfma_f32_16x16x32_bf16 v[28:31], a[184:187], v[100:103], v[28:31]
    ds_read_b64_tr_b16 a[224:225], v19 offset:12288
    v_add_u32 v4, 156672, v4
    v_lshlrev_b32_e64 v5, 2, v0
    v_mfma_f32_16x16x32_bf16 v[32:35], a[188:191], v[100:103], v[32:35]
    ds_read_b64_tr_b16 a[226:227], v19 offset:12800
    ds_read_b64_tr_b16 a[228:229], v19 offset:28672
    v_mfma_f32_16x16x32_bf16 v[184:187], a[184:187], v[204:207], v[184:187]
    ds_read_b64_tr_b16 a[230:231], v19 offset:29184
    v_mfma_f32_16x16x32_bf16 v[36:39], a[184:187], v[104:107], v[36:39]
    ds_read_b64_tr_b16 v[84:85], v224 offset:0
    ds_read_b64_tr_b16 v[86:87], v224 offset:3584
    v_mfma_f32_16x16x32_bf16 v[40:43], a[188:191], v[104:107], v[40:43]
    ds_read_b64_tr_b16 v[88:89], v224 offset:32
    v_add_u32 v5, 158720, v5
    v_mfma_f32_16x16x32_bf16 v[44:47], a[184:187], v[108:111], v[44:47]
    ds_read_b64_tr_b16 v[90:91], v224 offset:3616
    ds_read_b64_tr_b16 v[92:93], v224 offset:64
    v_mfma_f32_16x16x32_bf16 v[48:51], a[188:191], v[108:111], v[48:51]
    ds_read_b64_tr_b16 v[94:95], v224 offset:3648
    v_mfma_f32_16x16x32_bf16 v[52:55], a[184:187], v[112:115], v[52:55]
    ds_read_b64_tr_b16 v[96:97], v224 offset:96
    v_mfma_f32_16x16x32_bf16 v[56:59], a[188:191], v[112:115], v[56:59]
    ds_read_b64_tr_b16 v[98:99], v224 offset:3680
    ds_write_b64 v4, v[196:197]
    s_waitcnt lgkmcnt(7)
    v_mfma_f32_16x16x32_bf16 v[28:31], a[224:227], v[84:87], v[28:31]
    ds_read_b64_tr_b16 a[232:233], v19 offset:13312
    ds_write2st64_b32 v5, v196, v197 offset0:0 offset1:4
    v_mfma_f32_16x16x32_bf16 v[32:35], a[228:231], v[84:87], v[32:35]
    ds_read_b64_tr_b16 a[234:235], v19 offset:13824
    ds_read_b64_tr_b16 a[236:237], v19 offset:29696
    v_mfma_f32_16x16x32_bf16 v[184:187], a[224:227], v[204:207], v[184:187]
    ds_read_b64_tr_b16 a[238:239], v19 offset:30208
    s_waitcnt lgkmcnt(10)
    v_mfma_f32_16x16x32_bf16 v[36:39], a[224:227], v[88:91], v[36:39]
    ds_read_b64_tr_b16 v[100:101], v224 offset:7168
    ds_read_b64_tr_b16 v[102:103], v224 offset:10752
    v_mfma_f32_16x16x32_bf16 v[40:43], a[228:231], v[88:91], v[40:43]
    ds_read_b64_tr_b16 v[104:105], v224 offset:7200
    s_add_u32 m0, s19, 57344
    s_nop 0
    buffer_load_dwordx4 v252, s[4:7], s17 offen offset:0 sc1 lds
    s_waitcnt lgkmcnt(11)
    v_mfma_f32_16x16x32_bf16 v[44:47], a[224:227], v[92:95], v[44:47]
    ds_read_b64_tr_b16 v[106:107], v224 offset:10784
    ds_read_b64_tr_b16 v[108:109], v224 offset:7232
    v_mfma_f32_16x16x32_bf16 v[48:51], a[228:231], v[92:95], v[48:51]
    ds_read_b64_tr_b16 v[110:111], v224 offset:10816
    s_waitcnt lgkmcnt(12)
    v_mfma_f32_16x16x32_bf16 v[52:55], a[224:227], v[96:99], v[52:55]
    ds_read_b64_tr_b16 v[112:113], v224 offset:7264
    v_mfma_f32_16x16x32_bf16 v[56:59], a[228:231], v[96:99], v[56:59]
    ds_read_b64_tr_b16 v[114:115], v224 offset:10848
    buffer_load_dwordx4 v252, s[4:7], s17 offen offset:1024 sc1 lds
    s_waitcnt lgkmcnt(6)
    v_mfma_f32_16x16x32_bf16 v[28:31], a[232:235], v[100:103], v[28:31]
    ds_read_b64_tr_b16 a[240:241], v19 offset:14336
    buffer_load_dwordx4 v252, s[4:7], s17 offen offset:2048 sc1 lds
    v_mfma_f32_16x16x32_bf16 v[32:35], a[236:239], v[100:103], v[32:35]
    ds_read_b64_tr_b16 a[242:243], v19 offset:14848
    ds_read_b64_tr_b16 a[244:245], v19 offset:30720
    v_mfma_f32_16x16x32_bf16 v[184:187], a[232:235], v[204:207], v[184:187]
    ds_read_b64_tr_b16 a[246:247], v19 offset:31232
    s_waitcnt lgkmcnt(8)
    v_mfma_f32_16x16x32_bf16 v[36:39], a[232:235], v[104:107], v[36:39]
    ds_read_b64_tr_b16 v[84:85], v224 offset:14336
    ds_read_b64_tr_b16 v[86:87], v224 offset:17920
    v_mfma_f32_16x16x32_bf16 v[40:43], a[236:239], v[104:107], v[40:43]
    ds_read_b64_tr_b16 v[88:89], v224 offset:14368
    buffer_load_dwordx4 v252, s[4:7], s17 offen offset:3072 sc1 lds
    s_waitcnt lgkmcnt(9)
    v_mfma_f32_16x16x32_bf16 v[44:47], a[232:235], v[108:111], v[44:47]
    ds_read_b64_tr_b16 v[90:91], v224 offset:17952
    ds_read_b64_tr_b16 v[92:93], v224 offset:14400
    v_mfma_f32_16x16x32_bf16 v[48:51], a[236:239], v[108:111], v[48:51]
    ds_read_b64_tr_b16 v[94:95], v224 offset:17984
    s_waitcnt lgkmcnt(10)
    v_mfma_f32_16x16x32_bf16 v[52:55], a[232:235], v[112:115], v[52:55]
    ds_read_b64_tr_b16 v[96:97], v224 offset:14432
    v_mfma_f32_16x16x32_bf16 v[56:59], a[236:239], v[112:115], v[56:59]
    s_nop 0
    ds_read_b64_tr_b16 v[98:99], v224 offset:18016
    s_add_u32 m0, s19, 61440
    s_add_u32 s17, s17, 4096
    buffer_load_dwordx4 v252, s[4:7], s17 offen offset:0 sc1 lds
    s_waitcnt lgkmcnt(6)
    v_mfma_f32_16x16x32_bf16 v[28:31], a[240:243], v[84:87], v[28:31]
    ds_read_b64_tr_b16 a[248:249], v19 offset:15360
    v_mfma_f32_16x16x32_bf16 v[32:35], a[244:247], v[84:87], v[32:35]
    ds_read_b64_tr_b16 a[250:251], v19 offset:15872
    ds_read_b64_tr_b16 a[252:253], v19 offset:31744
    v_mfma_f32_16x16x32_bf16 v[184:187], a[240:243], v[204:207], v[184:187]
    ds_read_b64_tr_b16 a[254:255], v19 offset:32256
    s_waitcnt lgkmcnt(8)
    v_mfma_f32_16x16x32_bf16 v[36:39], a[240:243], v[88:91], v[36:39]
    ds_read_b64_tr_b16 v[100:101], v224 offset:21504
    ds_read_b64_tr_b16 v[102:103], v224 offset:25088
    v_mfma_f32_16x16x32_bf16 v[40:43], a[244:247], v[88:91], v[40:43]
    ds_read_b64_tr_b16 v[104:105], v224 offset:21536
    buffer_load_dwordx4 v252, s[4:7], s17 offen offset:1024 sc1 lds
    s_waitcnt lgkmcnt(9)
    v_mfma_f32_16x16x32_bf16 v[44:47], a[240:243], v[92:95], v[44:47]
    ds_read_b64_tr_b16 v[106:107], v224 offset:25120
    ds_read_b64_tr_b16 v[108:109], v224 offset:21568
    v_mfma_f32_16x16x32_bf16 v[48:51], a[244:247], v[92:95], v[48:51]
    ds_read_b64_tr_b16 v[110:111], v224 offset:25152
    s_waitcnt lgkmcnt(10)
    v_mfma_f32_16x16x32_bf16 v[52:55], a[240:243], v[96:99], v[52:55]
    ds_read_b64_tr_b16 v[112:113], v224 offset:21600
    v_mfma_f32_16x16x32_bf16 v[56:59], a[244:247], v[96:99], v[56:59]
    ds_read_b64_tr_b16 v[114:115], v224 offset:25184
    buffer_load_dwordx4 v252, s[4:7], s17 offen offset:2048 sc1 lds
    s_add_u32 s17, s17, 24576
    s_waitcnt lgkmcnt(6)
    v_mfma_f32_16x16x32_bf16 v[28:31], a[248:251], v[100:103], v[28:31]
    v_mfma_f32_16x16x32_bf16 v[32:35], a[252:255], v[100:103], v[32:35]
    v_mfma_f32_16x16x32_bf16 v[184:187], a[248:251], v[204:207], v[184:187]
    s_waitcnt lgkmcnt(4)
    v_mfma_f32_16x16x32_bf16 v[36:39], a[248:251], v[104:107], v[36:39]
    v_mfma_f32_16x16x32_bf16 v[40:43], a[252:255], v[104:107], v[40:43]
    s_waitcnt lgkmcnt(2)
    v_mfma_f32_16x16x32_bf16 v[44:47], a[248:251], v[108:111], v[44:47]
    s_lshl_b32 s57, s54, 11
    s_add_u32 s57, s57, s18
    v_add_u32 v4, s57, v17
    v_mfma_f32_16x16x32_bf16 v[48:51], a[252:255], v[108:111], v[48:51]
    s_waitcnt lgkmcnt(0)
    v_mfma_f32_16x16x32_bf16 v[52:55], a[248:251], v[112:115], v[52:55]
    ds_read_b64_tr_b16 v[20:21], v4 offset:0
    ds_read_b64_tr_b16 v[22:23], v4 offset:512
    v_mfma_f32_16x16x32_bf16 v[56:59], a[252:255], v[112:115], v[56:59]
    ds_read_b64_tr_b16 v[24:25], v4 offset:1024
    ds_read_b64_tr_b16 v[26:27], v4 offset:1536
    s_lshl_b32 s57, s76, 7
    s_add_u32 s57, s57, 153600
    v_lshl_add_u32 v6, v3, 4, s57
    v_lshl_add_u32 v7, v2, 2, s57
    s_mov_b32 exec_lo, 0x00010001
    s_mov_b32 exec_hi, 0x00010001
    ds_write_b128 v6, v[184:187] offset:0
    s_mov_b64 exec, -1
    v_and_b32 v6, 31, v1
    v_lshl_add_u32 v7, v6, 2, s57
    s_waitcnt lgkmcnt(0)
    s_barrier
    ds_read2st64_b32 v[184:185], v7 offset0:0 offset1:1
    v_lshlrev_b32_e64 v4, 3, v2
    v_add_u32 v4, 157568, v4
    ds_read_b64 v[196:197], v4 offset:0
    ds_read_b64 v[198:199], v4 offset:128
    ds_read_b64 v[200:201], v4 offset:256
    ds_read_b64 v[202:203], v4 offset:384
    s_add_u32 m0, s19, 0
    s_nop 0
    buffer_load_dwordx4 v252, s[4:7], s17 offen offset:0 sc1 lds
    buffer_load_dwordx4 v252, s[4:7], s17 offen offset:1024 sc1 lds
    buffer_load_dwordx4 v252, s[4:7], s17 offen offset:2048 sc1 lds
    s_lshl_b32 s57, s52, 8
    s_nop 0
    s_add_u32 s57, s57, 154112
    v_lshl_add_u32 v6, v6, 2, s57
    v_lshl_add_u32 v7, v3, 4, s57
    v_lshl_add_u32 v5, v2, 2, s57
    s_waitcnt lgkmcnt(4)
    s_nop 0
    v_mul_f32 v184, 0x3b000000, v184
    v_mul_f32 v185, 0x3b000000, v185
    v_fma_f32 v185, -v184, v184, v185
    v_max_f32_e64 v185, 0, v185
    v_cvt_pk_bf16_f32 v184, v184, v184
    v_and_b32 v184, 0xffff0000, v184
    v_cvt_pk_bf16_f32 v185, v185, v185
    v_and_b32 v185, 0xffff0000, v185
    v_add_f32 v185, 0x3727c5ac, v185
    v_cvt_pk_bf16_f32 v185, v185, v185
    v_and_b32 v185, 0xffff0000, v185
    v_sqrt_f32 v185, v185
    s_nop 0
    v_cvt_pk_bf16_f32 v185, v185, v185
    v_and_b32 v185, 0xffff0000, v185
    v_rcp_f32_e64 v185, v185
    ds_write2_b32 v6, v185, v184 offset0:0 offset1:32
    ds_read_b128 v[148:151], v7 offset:0
    ds_read_b128 v[156:159], v7 offset:128
    ds_read_b128 v[152:155], v7 offset:64
    ds_read_b128 v[160:163], v7 offset:192
    ds_read2_b32 v[164:165], v5 offset0:0 offset1:32
    ds_read2_b32 v[166:167], v5 offset0:16 offset1:48
    buffer_load_dwordx4 v252, s[4:7], s17 offen offset:3072 sc1 lds
    s_add_u32 m0, s19, 4096
    s_add_u32 s17, s17, 4096
    buffer_load_dwordx4 v252, s[4:7], s17 offen offset:0 sc1 lds
    buffer_load_dwordx4 v252, s[4:7], s17 offen offset:1024 sc1 lds
    buffer_load_dwordx4 v252, s[4:7], s17 offen offset:2048 sc1 lds
    s_add_u32 s17, s17, 24576
    s_add_u32 s93, s94, 2
    s_and_b32 s93, s93, 3
    s_lshl_b32 s93, s93, 8
    s_add_u32 m0, s18, 0
    s_add_u32 s85, s61, s93
    buffer_load_dwordx4 v8, s[72:75], s85 offen offset:0 lds
    s_lshl_b32 s57, s50, 2
    s_add_u32 s57, s57, s52
    s_mul_i32 s57, s57, 8192
    s_and_b32 s58, s3, 1
    s_lshl_b32 s58, s58, 9
    s_add_u32 s57, s57, s58
    v_lshrrev_b32 v4, 2, v1
    v_and_b32 v5, 3, v1
    v_lshlrev_b32_e64 v5, 7, v5
    v_lshl_add_u32 v4, v4, 10, v5
    s_mov_b64 exec, 0xffffffff
    buffer_load_dword v254, v4, s[8:11], s57 offen
    s_mov_b64 exec, -1
    s_lshl_b32 s59, s50, 2
    s_add_u32 s59, s59, s52
    s_nop 0
    s_mul_i32 s59, s59, 128
    s_add_u32 s59, s59, adaLN_cond__ssm_conv_s4d__mixer_gmlp__prompt_kernel_g2c4-adaLN_cond__ssm_conv_s4d__mixer_gmlp__prompt_kernel_pc2
    v_lshl_add_u32 v4, v1, 7, s59
    v_min_u32 v4, adaLN_cond__ssm_conv_s4d__mixer_gmlp__prompt_kernel_end1-adaLN_cond__ssm_conv_s4d__mixer_gmlp__prompt_kernel_pc2-4, v4
    v_mov_b32 v5, s87
    v_add_co_u32 v4, vcc, s86, v4
    s_nop 1
    v_addc_co_u32_e64 v5, vcc, 0, v5, vcc
    s_mov_b64 exec, 1
    global_load_dword v254, v[4:5], off
    s_mov_b64 exec, -1
    s_waitcnt lgkmcnt(4)
    v_pk_fma_f32 v[28:29], v[156:157], v[196:197], v[28:29] op_sel_hi:[1,0,1] neg_lo:[1,0,0] neg_hi:[1,0,0]
    v_pk_fma_f32 v[30:31], v[158:159], v[196:197], v[30:31] op_sel_hi:[1,0,1] neg_lo:[1,0,0] neg_hi:[1,0,0]
    s_waitcnt lgkmcnt(2)
    s_nop 0
    v_pk_fma_f32 v[32:33], v[160:161], v[196:197], v[32:33] op_sel_hi:[1,0,1] neg_lo:[1,0,0] neg_hi:[1,0,0]
    buffer_load_dwordx4 v9, s[72:75], s85 offen offset:1024 lds
    v_pk_fma_f32 v[34:35], v[162:163], v[196:197], v[34:35] op_sel_hi:[1,0,1] neg_lo:[1,0,0] neg_hi:[1,0,0]
    v_pk_fma_f32 v[28:29], v[28:29], v[148:149], v[196:197] op_sel:[0,0,1] op_sel_hi:[1,1,1]
    v_pk_fma_f32 v[30:31], v[30:31], v[150:151], v[196:197] op_sel:[0,0,1] op_sel_hi:[1,1,1]
    v_pk_fma_f32 v[32:33], v[32:33], v[152:153], v[196:197] op_sel:[0,0,1] op_sel_hi:[1,1,1]
    v_pk_fma_f32 v[34:35], v[34:35], v[154:155], v[196:197] op_sel:[0,0,1] op_sel_hi:[1,1,1]
    v_pk_mul_f32 v[208:209], v[28:29], v[28:29]
    v_pk_mul_f32 v[210:211], v[30:31], v[30:31]
    v_pk_mul_f32 v[212:213], v[32:33], v[32:33]
    v_pk_mul_f32 v[214:215], v[34:35], v[34:35]
    v_pk_fma_f32 v[208:209], v[208:209], s[22:23], s[22:23] op_sel:[0,0,1] op_sel_hi:[1,0,1]
    v_pk_fma_f32 v[210:211], v[210:211], s[22:23], s[22:23] op_sel:[0,0,1] op_sel_hi:[1,0,1]
    v_pk_fma_f32 v[212:213], v[212:213], s[22:23], s[22:23] op_sel:[0,0,1] op_sel_hi:[1,0,1]
    v_pk_fma_f32 v[214:215], v[214:215], s[22:23], s[22:23] op_sel:[0,0,1] op_sel_hi:[1,0,1]
    v_pk_mul_f32 v[208:209], v[208:209], v[28:29]
    v_pk_mul_f32 v[210:211], v[210:211], v[30:31]
    v_pk_mul_f32 v[212:213], v[212:213], v[32:33]
    v_pk_mul_f32 v[214:215], v[214:215], v[34:35]
    v_exp_f32 v208, v208
    v_exp_f32 v209, v209
    v_exp_f32 v210, v210
    v_exp_f32 v211, v211
    v_exp_f32 v212, v212
    v_exp_f32 v213, v213
    v_exp_f32 v214, v214
    v_exp_f32 v215, v215
    v_pk_add_f32 v[208:209], v[208:209], 1.0 op_sel_hi:[1,0]
    v_pk_add_f32 v[210:211], v[210:211], 1.0 op_sel_hi:[1,0]
    v_pk_add_f32 v[212:213], v[212:213], 1.0 op_sel_hi:[1,0]
    v_pk_add_f32 v[214:215], v[214:215], 1.0 op_sel_hi:[1,0]
    v_rcp_f32 v208, v208
    v_rcp_f32 v209, v209
    v_rcp_f32 v210, v210
    v_rcp_f32 v211, v211
    v_rcp_f32 v212, v212
    v_rcp_f32 v213, v213
    v_rcp_f32 v214, v214
    v_rcp_f32 v215, v215
    v_pk_mul_f32 v[28:29], v[28:29], v[208:209]
    v_pk_mul_f32 v[30:31], v[30:31], v[210:211]
    v_pk_mul_f32 v[32:33], v[32:33], v[212:213]
    v_pk_mul_f32 v[34:35], v[34:35], v[214:215]
    v_pk_mul_f32 v[176:177], v[28:29], v[28:29]
    v_pk_mul_f32 v[178:179], v[30:31], v[30:31]
    v_pk_mul_f32 v[180:181], v[32:33], v[32:33]
    v_pk_mul_f32 v[182:183], v[34:35], v[34:35]
    v_pk_fma_f32 v[36:37], v[156:157], v[198:199], v[36:37] op_sel_hi:[1,0,1] neg_lo:[1,0,0] neg_hi:[1,0,0]
    v_pk_fma_f32 v[38:39], v[158:159], v[198:199], v[38:39] op_sel_hi:[1,0,1] neg_lo:[1,0,0] neg_hi:[1,0,0]
    v_pk_fma_f32 v[40:41], v[160:161], v[198:199], v[40:41] op_sel_hi:[1,0,1] neg_lo:[1,0,0] neg_hi:[1,0,0]
    v_pk_fma_f32 v[42:43], v[162:163], v[198:199], v[42:43] op_sel_hi:[1,0,1] neg_lo:[1,0,0] neg_hi:[1,0,0]
    v_pk_fma_f32 v[36:37], v[36:37], v[148:149], v[198:199] op_sel:[0,0,1] op_sel_hi:[1,1,1]
    v_pk_fma_f32 v[38:39], v[38:39], v[150:151], v[198:199] op_sel:[0,0,1] op_sel_hi:[1,1,1]
    buffer_load_dwordx4 v10, s[72:75], s85 offen offset:2048 lds
    v_pk_fma_f32 v[40:41], v[40:41], v[152:153], v[198:199] op_sel:[0,0,1] op_sel_hi:[1,1,1]
    v_pk_fma_f32 v[42:43], v[42:43], v[154:155], v[198:199] op_sel:[0,0,1] op_sel_hi:[1,1,1]
    v_pk_mul_f32 v[208:209], v[36:37], v[36:37]
    v_pk_mul_f32 v[210:211], v[38:39], v[38:39]
    v_pk_mul_f32 v[212:213], v[40:41], v[40:41]
    v_pk_mul_f32 v[214:215], v[42:43], v[42:43]
    v_pk_fma_f32 v[208:209], v[208:209], s[22:23], s[22:23] op_sel:[0,0,1] op_sel_hi:[1,0,1]
    v_pk_fma_f32 v[210:211], v[210:211], s[22:23], s[22:23] op_sel:[0,0,1] op_sel_hi:[1,0,1]
    v_pk_fma_f32 v[212:213], v[212:213], s[22:23], s[22:23] op_sel:[0,0,1] op_sel_hi:[1,0,1]
    v_pk_fma_f32 v[214:215], v[214:215], s[22:23], s[22:23] op_sel:[0,0,1] op_sel_hi:[1,0,1]
    v_pk_mul_f32 v[208:209], v[208:209], v[36:37]
    v_pk_mul_f32 v[210:211], v[210:211], v[38:39]
    v_pk_mul_f32 v[212:213], v[212:213], v[40:41]
    v_pk_mul_f32 v[214:215], v[214:215], v[42:43]
    v_exp_f32 v208, v208
    v_exp_f32 v209, v209
    v_exp_f32 v210, v210
    v_exp_f32 v211, v211
    v_exp_f32 v212, v212
    v_exp_f32 v213, v213
    v_exp_f32 v214, v214
    v_exp_f32 v215, v215
    v_pk_add_f32 v[208:209], v[208:209], 1.0 op_sel_hi:[1,0]
    v_pk_add_f32 v[210:211], v[210:211], 1.0 op_sel_hi:[1,0]
    v_pk_add_f32 v[212:213], v[212:213], 1.0 op_sel_hi:[1,0]
    v_pk_add_f32 v[214:215], v[214:215], 1.0 op_sel_hi:[1,0]
    v_rcp_f32 v208, v208
    v_rcp_f32 v209, v209
    v_rcp_f32 v210, v210
    v_rcp_f32 v211, v211
    v_rcp_f32 v212, v212
    v_rcp_f32 v213, v213
    v_rcp_f32 v214, v214
    v_rcp_f32 v215, v215
    v_pk_mul_f32 v[36:37], v[36:37], v[208:209]
    v_pk_mul_f32 v[38:39], v[38:39], v[210:211]
    v_pk_mul_f32 v[40:41], v[40:41], v[212:213]
    v_pk_mul_f32 v[42:43], v[42:43], v[214:215]
    v_pk_add_f32 v[168:169], v[28:29], v[36:37]
    v_pk_fma_f32 v[176:177], v[36:37], v[36:37], v[176:177]
    v_pk_add_f32 v[170:171], v[30:31], v[38:39]
    v_pk_fma_f32 v[178:179], v[38:39], v[38:39], v[178:179]
    v_pk_add_f32 v[172:173], v[32:33], v[40:41]
    v_pk_fma_f32 v[180:181], v[40:41], v[40:41], v[180:181]
    v_pk_add_f32 v[174:175], v[34:35], v[42:43]
    v_pk_fma_f32 v[182:183], v[42:43], v[42:43], v[182:183]
    v_pk_fma_f32 v[44:45], v[156:157], v[200:201], v[44:45] op_sel_hi:[1,0,1] neg_lo:[1,0,0] neg_hi:[1,0,0]
    v_pk_fma_f32 v[46:47], v[158:159], v[200:201], v[46:47] op_sel_hi:[1,0,1] neg_lo:[1,0,0] neg_hi:[1,0,0]
    v_pk_fma_f32 v[48:49], v[160:161], v[200:201], v[48:49] op_sel_hi:[1,0,1] neg_lo:[1,0,0] neg_hi:[1,0,0]
    v_pk_fma_f32 v[50:51], v[162:163], v[200:201], v[50:51] op_sel_hi:[1,0,1] neg_lo:[1,0,0] neg_hi:[1,0,0]
    v_pk_fma_f32 v[44:45], v[44:45], v[148:149], v[200:201] op_sel:[0,0,1] op_sel_hi:[1,1,1]
    buffer_load_dwordx4 v11, s[72:75], s85 offen offset:3072 lds
    v_pk_fma_f32 v[46:47], v[46:47], v[150:151], v[200:201] op_sel:[0,0,1] op_sel_hi:[1,1,1]
    v_pk_fma_f32 v[48:49], v[48:49], v[152:153], v[200:201] op_sel:[0,0,1] op_sel_hi:[1,1,1]
    v_pk_fma_f32 v[50:51], v[50:51], v[154:155], v[200:201] op_sel:[0,0,1] op_sel_hi:[1,1,1]
    v_pk_mul_f32 v[208:209], v[44:45], v[44:45]
    v_pk_mul_f32 v[210:211], v[46:47], v[46:47]
    v_pk_mul_f32 v[212:213], v[48:49], v[48:49]
    v_pk_mul_f32 v[214:215], v[50:51], v[50:51]
    v_pk_fma_f32 v[208:209], v[208:209], s[22:23], s[22:23] op_sel:[0,0,1] op_sel_hi:[1,0,1]
    v_pk_fma_f32 v[210:211], v[210:211], s[22:23], s[22:23] op_sel:[0,0,1] op_sel_hi:[1,0,1]
    v_pk_fma_f32 v[212:213], v[212:213], s[22:23], s[22:23] op_sel:[0,0,1] op_sel_hi:[1,0,1]
    v_pk_fma_f32 v[214:215], v[214:215], s[22:23], s[22:23] op_sel:[0,0,1] op_sel_hi:[1,0,1]
    v_pk_mul_f32 v[208:209], v[208:209], v[44:45]
    v_pk_mul_f32 v[210:211], v[210:211], v[46:47]
    v_pk_mul_f32 v[212:213], v[212:213], v[48:49]
    v_pk_mul_f32 v[214:215], v[214:215], v[50:51]
    v_exp_f32 v208, v208
    v_exp_f32 v209, v209
    v_exp_f32 v210, v210
    v_exp_f32 v211, v211
    v_exp_f32 v212, v212
    v_exp_f32 v213, v213
    v_exp_f32 v214, v214
    v_exp_f32 v215, v215
    v_pk_add_f32 v[208:209], v[208:209], 1.0 op_sel_hi:[1,0]
    v_pk_add_f32 v[210:211], v[210:211], 1.0 op_sel_hi:[1,0]
    v_pk_add_f32 v[212:213], v[212:213], 1.0 op_sel_hi:[1,0]
    v_pk_add_f32 v[214:215], v[214:215], 1.0 op_sel_hi:[1,0]
    v_rcp_f32 v208, v208
    v_rcp_f32 v209, v209
    v_rcp_f32 v210, v210
    v_rcp_f32 v211, v211
    v_rcp_f32 v212, v212
    v_rcp_f32 v213, v213
    v_rcp_f32 v214, v214
    v_rcp_f32 v215, v215
    v_pk_mul_f32 v[44:45], v[44:45], v[208:209]
    v_pk_mul_f32 v[46:47], v[46:47], v[210:211]
    v_pk_mul_f32 v[48:49], v[48:49], v[212:213]
    v_pk_mul_f32 v[50:51], v[50:51], v[214:215]
    v_pk_add_f32 v[168:169], v[168:169], v[44:45]
    v_pk_fma_f32 v[176:177], v[44:45], v[44:45], v[176:177]
    v_pk_add_f32 v[170:171], v[170:171], v[46:47]
    v_pk_fma_f32 v[178:179], v[46:47], v[46:47], v[178:179]
    v_pk_add_f32 v[172:173], v[172:173], v[48:49]
    v_pk_fma_f32 v[180:181], v[48:49], v[48:49], v[180:181]
    v_pk_add_f32 v[174:175], v[174:175], v[50:51]
    v_pk_fma_f32 v[182:183], v[50:51], v[50:51], v[182:183]
    v_pk_fma_f32 v[52:53], v[156:157], v[202:203], v[52:53] op_sel_hi:[1,0,1] neg_lo:[1,0,0] neg_hi:[1,0,0]
    v_pk_fma_f32 v[54:55], v[158:159], v[202:203], v[54:55] op_sel_hi:[1,0,1] neg_lo:[1,0,0] neg_hi:[1,0,0]
    v_pk_fma_f32 v[56:57], v[160:161], v[202:203], v[56:57] op_sel_hi:[1,0,1] neg_lo:[1,0,0] neg_hi:[1,0,0]
    v_pk_fma_f32 v[58:59], v[162:163], v[202:203], v[58:59] op_sel_hi:[1,0,1] neg_lo:[1,0,0] neg_hi:[1,0,0]
    v_pk_fma_f32 v[52:53], v[52:53], v[148:149], v[202:203] op_sel:[0,0,1] op_sel_hi:[1,1,1]
    v_pk_fma_f32 v[54:55], v[54:55], v[150:151], v[202:203] op_sel:[0,0,1] op_sel_hi:[1,1,1]
    v_pk_fma_f32 v[56:57], v[56:57], v[152:153], v[202:203] op_sel:[0,0,1] op_sel_hi:[1,1,1]
    v_pk_fma_f32 v[58:59], v[58:59], v[154:155], v[202:203] op_sel:[0,0,1] op_sel_hi:[1,1,1]
    v_pk_mul_f32 v[208:209], v[52:53], v[52:53]
    v_pk_mul_f32 v[210:211], v[54:55], v[54:55]
    v_pk_mul_f32 v[212:213], v[56:57], v[56:57]
    v_pk_mul_f32 v[214:215], v[58:59], v[58:59]
    v_pk_fma_f32 v[208:209], v[208:209], s[22:23], s[22:23] op_sel:[0,0,1] op_sel_hi:[1,0,1]
    v_pk_fma_f32 v[210:211], v[210:211], s[22:23], s[22:23] op_sel:[0,0,1] op_sel_hi:[1,0,1]
    v_pk_fma_f32 v[212:213], v[212:213], s[22:23], s[22:23] op_sel:[0,0,1] op_sel_hi:[1,0,1]
    v_pk_fma_f32 v[214:215], v[214:215], s[22:23], s[22:23] op_sel:[0,0,1] op_sel_hi:[1,0,1]
    v_pk_mul_f32 v[208:209], v[208:209], v[52:53]
    v_pk_mul_f32 v[210:211], v[210:211], v[54:55]
    v_pk_mul_f32 v[212:213], v[212:213], v[56:57]
    v_pk_mul_f32 v[214:215], v[214:215], v[58:59]
    v_exp_f32 v208, v208
    v_exp_f32 v209, v209
    v_exp_f32 v210, v210
    v_exp_f32 v211, v211
    v_exp_f32 v212, v212
    v_exp_f32 v213, v213
    v_exp_f32 v214, v214
    v_exp_f32 v215, v215
    v_pk_add_f32 v[208:209], v[208:209], 1.0 op_sel_hi:[1,0]
    v_pk_add_f32 v[210:211], v[210:211], 1.0 op_sel_hi:[1,0]
    v_pk_add_f32 v[212:213], v[212:213], 1.0 op_sel_hi:[1,0]
    v_pk_add_f32 v[214:215], v[214:215], 1.0 op_sel_hi:[1,0]
    v_rcp_f32 v208, v208
    v_rcp_f32 v209, v209
    v_rcp_f32 v210, v210
    v_rcp_f32 v211, v211
    v_rcp_f32 v212, v212
    v_rcp_f32 v213, v213
    v_rcp_f32 v214, v214
    v_rcp_f32 v215, v215
    v_pk_mul_f32 v[52:53], v[52:53], v[208:209]
    v_pk_mul_f32 v[54:55], v[54:55], v[210:211]
    v_pk_mul_f32 v[56:57], v[56:57], v[212:213]
    v_pk_mul_f32 v[58:59], v[58:59], v[214:215]
    v_pk_add_f32 v[168:169], v[168:169], v[52:53]
    v_pk_fma_f32 v[176:177], v[52:53], v[52:53], v[176:177]
    v_pk_add_f32 v[170:171], v[170:171], v[54:55]
    v_pk_fma_f32 v[178:179], v[54:55], v[54:55], v[178:179]
    v_pk_add_f32 v[172:173], v[172:173], v[56:57]
    v_pk_fma_f32 v[180:181], v[56:57], v[56:57], v[180:181]
    v_pk_add_f32 v[174:175], v[174:175], v[58:59]
    v_pk_fma_f32 v[182:183], v[58:59], v[58:59], v[182:183]
    v_add_f32_dpp v208, v168, v168 row_ror:8 row_mask:0xf bank_mask:0x3
    v_add_f32_dpp v209, v169, v169 row_ror:8 row_mask:0xf bank_mask:0x3
    v_add_f32_dpp v210, v170, v170 row_ror:8 row_mask:0xf bank_mask:0x3
    v_add_f32_dpp v211, v171, v171 row_ror:8 row_mask:0xf bank_mask:0x3
    v_add_f32_dpp v212, v176, v176 row_ror:8 row_mask:0xf bank_mask:0x3
    v_add_f32_dpp v213, v177, v177 row_ror:8 row_mask:0xf bank_mask:0x3
    v_add_f32_dpp v214, v178, v178 row_ror:8 row_mask:0xf bank_mask:0x3
    v_add_f32_dpp v215, v179, v179 row_ror:8 row_mask:0xf bank_mask:0x3
    v_add_f32_dpp v208, v172, v172 row_ror:8 row_mask:0xf bank_mask:0xc
    v_add_f32_dpp v209, v173, v173 row_ror:8 row_mask:0xf bank_mask:0xc
    v_add_f32_dpp v210, v174, v174 row_ror:8 row_mask:0xf bank_mask:0xc
    v_add_f32_dpp v211, v175, v175 row_ror:8 row_mask:0xf bank_mask:0xc
    v_add_f32_dpp v212, v180, v180 row_ror:8 row_mask:0xf bank_mask:0xc
    v_add_f32_dpp v213, v181, v181 row_ror:8 row_mask:0xf bank_mask:0xc
    v_add_f32_dpp v214, v182, v182 row_ror:8 row_mask:0xf bank_mask:0xc
    v_add_f32_dpp v215, v183, v183 row_ror:8 row_mask:0xf bank_mask:0xc
    v_add_f32_dpp v216, v208, v208 row_shl:4 row_mask:0xf bank_mask:0x5
    v_add_f32_dpp v217, v209, v209 row_shl:4 row_mask:0xf bank_mask:0x5
    v_add_f32_dpp v218, v212, v212 row_shl:4 row_mask:0xf bank_mask:0x5
    v_add_f32_dpp v219, v213, v213 row_shl:4 row_mask:0xf bank_mask:0x5
    v_add_f32_dpp v216, v210, v210 row_shr:4 row_mask:0xf bank_mask:0xa
    v_add_f32_dpp v217, v211, v211 row_shr:4 row_mask:0xf bank_mask:0xa
    v_add_f32_dpp v218, v214, v214 row_shr:4 row_mask:0xf bank_mask:0xa
    v_add_f32_dpp v219, v215, v215 row_shr:4 row_mask:0xf bank_mask:0xa
    v_add_f32_dpp v216, v216, v216 quad_perm:[1,0,3,2] row_mask:0xf bank_mask:0xf
    v_add_f32_dpp v217, v217, v217 quad_perm:[1,0,3,2] row_mask:0xf bank_mask:0xf
    v_add_f32_dpp v218, v218, v218 quad_perm:[1,0,3,2] row_mask:0xf bank_mask:0xf
    v_add_f32_dpp v219, v219, v219 quad_perm:[1,0,3,2] row_mask:0xf bank_mask:0xf
    v_add_f32_dpp v216, v216, v216 quad_perm:[2,3,0,1] row_mask:0xf bank_mask:0xf
    v_add_f32_dpp v217, v217, v217 quad_perm:[2,3,0,1] row_mask:0xf bank_mask:0xf
    v_add_f32_dpp v218, v218, v218 quad_perm:[2,3,0,1] row_mask:0xf bank_mask:0xf
    v_add_f32_dpp v219, v219, v219 quad_perm:[2,3,0,1] row_mask:0xf bank_mask:0xf
    s_mov_b32 vcc_lo, 0xaaaaaaaa
    s_mov_b32 vcc_hi, 0xaaaaaaaa
    v_bfe_u32 v6, v2, 3, 1
    v_lshlrev_b32_e64 v6, 4, v6
    v_lshl_add_u32 v6, v3, 2, v6
    v_bfe_u32 v7, v2, 2, 1
    v_lshl_add_u32 v6, v7, 1, v6
    v_and_b32 v7, 1, v2
    v_add_u32_e64 v6, v6, v7
    s_lshl_b32 s57, s76, 8
    s_add_u32 s57, s57, 155136
    v_lshl_add_u32 v7, v6, 3, s57
    v_cndmask_b32 v220, v216, v217, vcc
    v_cndmask_b32_e64 v221, v218, v219, vcc
    s_waitcnt vmcnt(20)
    s_waitcnt lgkmcnt(0)
    s_barrier
    ds_read_b64 v[222:223], v7
    ds_read_b64_tr_b16 v[84:85], v224 offset:28672
    ds_read_b64_tr_b16 v[86:87], v224 offset:32256
    ds_read_b64_tr_b16 v[88:89], v224 offset:28704
    ds_read_b64_tr_b16 v[90:91], v224 offset:32288
    ds_read_b64_tr_b16 v[92:93], v224 offset:28736
    ds_read_b64_tr_b16 v[94:95], v224 offset:32320
    s_lshl_b32 s57, s53, 3
    s_add_u32 s57, s57, s54
    s_lshl_b32 s57, s57, 1
    s_add_u32 s57, s57, s76
    s_lshl_b32 s57, s57, 9
    s_add_u32 s57, s57, 458752
    v_lshlrev_b32_e64 v6, 4, v6
    s_waitcnt lgkmcnt(6)
    v_pk_add_f32 v[220:221], v[220:221], v[222:223]
    v_mov_b32 v222, s56
    v_mov_b32 v223, s56
    s_mov_b32 exec_lo, 0x33333333
    s_mov_b32 exec_hi, 0x33333333
    buffer_store_dwordx4 v[220:223], v6, s[4:7], s57 offen sc1
    s_mov_b64 exec, -1
    s_waitcnt lgkmcnt(4)
    v_mfma_f32_16x16x32_bf16 v[60:63], v[84:87], a[32:35], 0
    ds_read_b64_tr_b16 v[100:101], v224 offset:35840
    s_add_u32 m0, s18, 4096
    s_add_u32 s85, s64, s93
    buffer_load_dwordx4 v8, s[72:75], s85 offen offset:0 lds
    v_mfma_f32_16x16x32_bf16 v[64:67], v[84:87], a[36:39], 0
    ds_read_b64_tr_b16 v[102:103], v224 offset:39424
    s_waitcnt lgkmcnt(4)
    v_mfma_f32_16x16x32_bf16 v[68:71], v[88:91], a[32:35], 0
    ds_read_b64_tr_b16 v[104:105], v224 offset:35872
    v_mfma_f32_16x16x32_bf16 v[72:75], v[88:91], a[36:39], 0
    ds_read_b64_tr_b16 v[106:107], v224 offset:39456
    buffer_load_dwordx4 v9, s[72:75], s85 offen offset:1024 lds
    buffer_load_dwordx4 v10, s[72:75], s85 offen offset:2048 lds
    s_waitcnt lgkmcnt(4)
    v_mfma_f32_16x16x32_bf16 v[76:79], v[92:95], a[32:35], 0
    ds_read_b64_tr_b16 v[108:109], v224 offset:35904
    v_mfma_f32_16x16x32_bf16 v[80:83], v[92:95], a[36:39], 0
    ds_read_b64_tr_b16 v[110:111], v224 offset:39488
    buffer_load_dwordx4 v11, s[72:75], s85 offen offset:3072 lds
    s_waitcnt lgkmcnt(4)
    v_mfma_f32_16x16x32_bf16 v[60:63], v[100:103], a[40:43], v[60:63]
    ds_read_b64_tr_b16 v[84:85], v224 offset:43008
    s_add_u32 m0, s18, 8192
    s_add_u32 s85, s65, s93
    buffer_load_dwordx4 v8, s[72:75], s85 offen offset:0 lds
    v_mfma_f32_16x16x32_bf16 v[64:67], v[100:103], a[44:47], v[64:67]
    ds_read_b64_tr_b16 v[86:87], v224 offset:46592
    s_waitcnt lgkmcnt(4)
    v_mfma_f32_16x16x32_bf16 v[68:71], v[104:107], a[40:43], v[68:71]
    ds_read_b64_tr_b16 v[88:89], v224 offset:43040
    v_mfma_f32_16x16x32_bf16 v[72:75], v[104:107], a[44:47], v[72:75]
    ds_read_b64_tr_b16 v[90:91], v224 offset:46624
    buffer_load_dwordx4 v9, s[72:75], s85 offen offset:1024 lds
    buffer_load_dwordx4 v10, s[72:75], s85 offen offset:2048 lds
    s_waitcnt lgkmcnt(4)
    v_mfma_f32_16x16x32_bf16 v[76:79], v[108:111], a[40:43], v[76:79]
    ds_read_b64_tr_b16 v[92:93], v224 offset:43072
    v_mfma_f32_16x16x32_bf16 v[80:83], v[108:111], a[44:47], v[80:83]
    ds_read_b64_tr_b16 v[94:95], v224 offset:46656
    buffer_load_dwordx4 v11, s[72:75], s85 offen offset:3072 lds
    s_waitcnt lgkmcnt(4)
    v_mfma_f32_16x16x32_bf16 v[60:63], v[84:87], a[48:51], v[60:63]
    ds_read_b64_tr_b16 v[100:101], v224 offset:50176
    ds_read_b64_tr_b16 v[102:103], v224 offset:53760
    v_mfma_f32_16x16x32_bf16 v[64:67], v[84:87], a[52:55], v[64:67]
    ds_read_b64_tr_b16 v[104:105], v224 offset:50208
    ds_read_b64_tr_b16 v[106:107], v224 offset:53792
    s_waitcnt lgkmcnt(6)
    v_mfma_f32_16x16x32_bf16 v[68:71], v[88:91], a[48:51], v[68:71]
    ds_read_b64_tr_b16 v[108:109], v224 offset:50240
    v_mfma_f32_16x16x32_bf16 v[72:75], v[88:91], a[52:55], v[72:75]
    ds_read_b64_tr_b16 v[110:111], v224 offset:53824
    s_waitcnt lgkmcnt(6)
    v_mfma_f32_16x16x32_bf16 v[76:79], v[92:95], a[48:51], v[76:79]
    v_mfma_f32_16x16x32_bf16 v[80:83], v[92:95], a[52:55], v[80:83]
    s_waitcnt vmcnt(22)
    s_waitcnt lgkmcnt(0)
    s_barrier
    v_mfma_f32_16x16x32_bf16 v[60:63], v[100:103], a[56:59], v[60:63]
    ds_read_b64_tr_b16 v[84:85], v225 offset:0
    s_add_u32 m0, s19, 28672
    s_nop 0
    buffer_load_dwordx4 v252, s[4:7], s17 offen offset:0 sc1 lds
    v_mfma_f32_16x16x32_bf16 v[64:67], v[100:103], a[60:63], v[64:67]
    ds_read_b64_tr_b16 v[86:87], v225 offset:3584
    v_mfma_f32_16x16x32_bf16 v[68:71], v[104:107], a[56:59], v[68:71]
    ds_read_b64_tr_b16 v[88:89], v225 offset:32
    v_mfma_f32_16x16x32_bf16 v[72:75], v[104:107], a[60:63], v[72:75]
    ds_read_b64_tr_b16 v[90:91], v225 offset:3616
    buffer_load_dwordx4 v252, s[4:7], s17 offen offset:1024 sc1 lds
    buffer_load_dwordx4 v252, s[4:7], s17 offen offset:2048 sc1 lds
    v_mfma_f32_16x16x32_bf16 v[76:79], v[108:111], a[56:59], v[76:79]
    ds_read_b64_tr_b16 v[92:93], v225 offset:64
    v_mfma_f32_16x16x32_bf16 v[80:83], v[108:111], a[60:63], v[80:83]
    ds_read_b64_tr_b16 v[94:95], v225 offset:3648
    buffer_load_dwordx4 v252, s[4:7], s17 offen offset:3072 sc1 lds
    s_waitcnt lgkmcnt(4)
    v_mfma_f32_16x16x32_bf16 v[60:63], v[84:87], a[96:99], v[60:63]
    s_nop 0
    ds_read_b64_tr_b16 v[100:101], v225 offset:7168
    s_add_u32 m0, s19, 32768
    s_add_u32 s17, s17, 4096
    buffer_load_dwordx4 v252, s[4:7], s17 offen offset:0 sc1 lds
    v_mfma_f32_16x16x32_bf16 v[64:67], v[84:87], a[100:103], v[64:67]
    ds_read_b64_tr_b16 v[102:103], v225 offset:10752
    s_waitcnt lgkmcnt(4)
    v_mfma_f32_16x16x32_bf16 v[68:71], v[88:91], a[96:99], v[68:71]
    ds_read_b64_tr_b16 v[104:105], v225 offset:7200
    v_mfma_f32_16x16x32_bf16 v[72:75], v[88:91], a[100:103], v[72:75]
    s_nop 0
    ds_read_b64_tr_b16 v[106:107], v225 offset:10784
    buffer_load_dwordx4 v252, s[4:7], s17 offen offset:1024 sc1 lds
    buffer_load_dwordx4 v252, s[4:7], s17 offen offset:2048 sc1 lds
    s_add_u32 s17, s17, 24576
    s_waitcnt lgkmcnt(4)
    v_mfma_f32_16x16x32_bf16 v[76:79], v[92:95], a[96:99], v[76:79]
    ds_read_b64_tr_b16 v[108:109], v225 offset:7232
    v_mfma_f32_16x16x32_bf16 v[80:83], v[92:95], a[100:103], v[80:83]
    ds_read_b64_tr_b16 v[110:111], v225 offset:10816
    s_add_u32 m0, s18, 12288
    s_add_u32 s85, s66, s93
    buffer_load_dwordx4 v8, s[72:75], s85 offen offset:0 lds
    s_waitcnt lgkmcnt(4)
    v_mfma_f32_16x16x32_bf16 v[60:63], v[100:103], a[104:107], v[60:63]
    ds_read_b64_tr_b16 v[84:85], v225 offset:14336
    buffer_load_dwordx4 v9, s[72:75], s85 offen offset:1024 lds
    v_mfma_f32_16x16x32_bf16 v[64:67], v[100:103], a[108:111], v[64:67]
    ds_read_b64_tr_b16 v[86:87], v225 offset:17920
    s_waitcnt lgkmcnt(4)
    v_mfma_f32_16x16x32_bf16 v[68:71], v[104:107], a[104:107], v[68:71]
    ds_read_b64_tr_b16 v[88:89], v225 offset:14368
    v_mfma_f32_16x16x32_bf16 v[72:75], v[104:107], a[108:111], v[72:75]
    ds_read_b64_tr_b16 v[90:91], v225 offset:17952
    buffer_load_dwordx4 v10, s[72:75], s85 offen offset:2048 lds
    buffer_load_dwordx4 v11, s[72:75], s85 offen offset:3072 lds
    s_waitcnt lgkmcnt(4)
    v_mfma_f32_16x16x32_bf16 v[76:79], v[108:111], a[104:107], v[76:79]
    ds_read_b64_tr_b16 v[92:93], v225 offset:14400
    v_mfma_f32_16x16x32_bf16 v[80:83], v[108:111], a[108:111], v[80:83]
    ds_read_b64_tr_b16 v[94:95], v225 offset:17984
    v_and_b32 v6, 31, v1
    v_lshlrev_b32 v6, 4, v6
    s_waitcnt lgkmcnt(4)
    v_mfma_f32_16x16x32_bf16 v[60:63], v[84:87], a[112:115], v[60:63]
    ds_read_b64_tr_b16 v[100:101], v225 offset:21504
    ds_read_b64_tr_b16 v[102:103], v225 offset:25088
    v_mfma_f32_16x16x32_bf16 v[64:67], v[84:87], a[116:119], v[64:67]
    ds_read_b64_tr_b16 v[104:105], v225 offset:21536
    ds_read_b64_tr_b16 v[106:107], v225 offset:25120
    s_waitcnt lgkmcnt(6)
    v_mfma_f32_16x16x32_bf16 v[68:71], v[88:91], a[112:115], v[68:71]
    ds_read_b64_tr_b16 v[108:109], v225 offset:21568
    v_lshrrev_b32 v7, 5, v1
    v_lshl_add_u32 v6, v7, 10, v6
    v_mfma_f32_16x16x32_bf16 v[72:75], v[88:91], a[116:119], v[72:75]
    ds_read_b64_tr_b16 v[110:111], v225 offset:25152
    s_waitcnt lgkmcnt(6)
    v_mfma_f32_16x16x32_bf16 v[76:79], v[92:95], a[112:115], v[76:79]
    s_lshl_b32 s25, s53, 13
    s_lshl_b32 s28, s76, 9
    s_add_u32 s25, s25, s28
    v_mfma_f32_16x16x32_bf16 v[80:83], v[92:95], a[116:119], v[80:83]
    s_add_u32 s25, s25, 458752
    s_add_u32 s28, s25, 4096
    s_waitcnt vmcnt(26)
    s_waitcnt lgkmcnt(0)
    s_barrier
    v_mfma_f32_16x16x32_bf16 v[60:63], v[100:103], a[120:123], v[60:63]
    ds_read_b64_tr_b16 v[84:85], v224 offset:0
    v_mfma_f32_16x16x32_bf16 v[64:67], v[100:103], a[124:127], v[64:67]
    ds_read_b64_tr_b16 v[86:87], v224 offset:3584
    v_mfma_f32_16x16x32_bf16 v[68:71], v[104:107], a[120:123], v[68:71]
    ds_read_b64_tr_b16 v[88:89], v224 offset:32
    v_mfma_f32_16x16x32_bf16 v[72:75], v[104:107], a[124:127], v[72:75]
    ds_read_b64_tr_b16 v[90:91], v224 offset:3616
    v_mfma_f32_16x16x32_bf16 v[76:79], v[108:111], a[120:123], v[76:79]
    ds_read_b64_tr_b16 v[92:93], v224 offset:64
    v_mfma_f32_16x16x32_bf16 v[80:83], v[108:111], a[124:127], v[80:83]
    ds_read_b64_tr_b16 v[94:95], v224 offset:3648
    s_waitcnt lgkmcnt(4)
    v_mfma_f32_16x16x32_bf16 v[60:63], v[84:87], a[160:163], v[60:63]
    ds_read_b64_tr_b16 v[100:101], v224 offset:7168
    v_mfma_f32_16x16x32_bf16 v[64:67], v[84:87], a[164:167], v[64:67]
    ds_read_b64_tr_b16 v[102:103], v224 offset:10752
    s_waitcnt lgkmcnt(4)
    v_mfma_f32_16x16x32_bf16 v[68:71], v[88:91], a[160:163], v[68:71]
    ds_read_b64_tr_b16 v[104:105], v224 offset:7200
    v_mfma_f32_16x16x32_bf16 v[72:75], v[88:91], a[164:167], v[72:75]
    ds_read_b64_tr_b16 v[106:107], v224 offset:10784
    s_waitcnt lgkmcnt(4)
    v_mfma_f32_16x16x32_bf16 v[76:79], v[92:95], a[160:163], v[76:79]
    ds_read_b64_tr_b16 v[108:109], v224 offset:7232
    v_mfma_f32_16x16x32_bf16 v[80:83], v[92:95], a[164:167], v[80:83]
    ds_read_b64_tr_b16 v[110:111], v224 offset:10816
    s_waitcnt lgkmcnt(4)
    v_mfma_f32_16x16x32_bf16 v[60:63], v[100:103], a[168:171], v[60:63]
    ds_read_b64_tr_b16 v[84:85], v224 offset:14336
    v_mfma_f32_16x16x32_bf16 v[64:67], v[100:103], a[172:175], v[64:67]
    ds_read_b64_tr_b16 v[86:87], v224 offset:17920
    s_waitcnt lgkmcnt(4)
    v_mfma_f32_16x16x32_bf16 v[68:71], v[104:107], a[168:171], v[68:71]
    ds_read_b64_tr_b16 v[88:89], v224 offset:14368
    v_mfma_f32_16x16x32_bf16 v[72:75], v[104:107], a[172:175], v[72:75]
    ds_read_b64_tr_b16 v[90:91], v224 offset:17952
    s_waitcnt lgkmcnt(4)
    v_mfma_f32_16x16x32_bf16 v[76:79], v[108:111], a[168:171], v[76:79]
    ds_read_b64_tr_b16 v[92:93], v224 offset:14400
    v_mfma_f32_16x16x32_bf16 v[80:83], v[108:111], a[172:175], v[80:83]
    ds_read_b64_tr_b16 v[94:95], v224 offset:17984
    s_waitcnt lgkmcnt(4)
    v_mfma_f32_16x16x32_bf16 v[60:63], v[84:87], a[176:179], v[60:63]
    ds_read_b64_tr_b16 v[100:101], v224 offset:21504
    ds_read_b64_tr_b16 v[102:103], v224 offset:25088
    v_mfma_f32_16x16x32_bf16 v[64:67], v[84:87], a[180:183], v[64:67]
    ds_read_b64_tr_b16 v[104:105], v224 offset:21536
    ds_read_b64_tr_b16 v[106:107], v224 offset:25120
    s_waitcnt lgkmcnt(6)
    v_mfma_f32_16x16x32_bf16 v[68:71], v[88:91], a[176:179], v[68:71]
    ds_read_b64_tr_b16 v[108:109], v224 offset:21568
    buffer_load_dwordx4 v[168:171], v6, s[4:7], s25 offen offset:0 sc1
    v_mfma_f32_16x16x32_bf16 v[72:75], v[88:91], a[180:183], v[72:75]
    ds_read_b64_tr_b16 v[110:111], v224 offset:25152
    buffer_load_dwordx4 v[172:175], v6, s[4:7], s25 offen offset:2048 sc1
    s_waitcnt lgkmcnt(6)
    v_mfma_f32_16x16x32_bf16 v[76:79], v[92:95], a[176:179], v[76:79]
    buffer_load_dwordx4 v[176:179], v6, s[4:7], s28 offen offset:0 sc1
    v_mfma_f32_16x16x32_bf16 v[80:83], v[92:95], a[180:183], v[80:83]
    buffer_load_dwordx4 v[180:183], v6, s[4:7], s28 offen offset:2048 sc1
    s_waitcnt vmcnt(8)
    s_waitcnt lgkmcnt(0)
    s_barrier
    v_mfma_f32_16x16x32_bf16 v[60:63], v[100:103], a[184:187], v[60:63]
    ds_read_b64_tr_b16 v[84:85], v224 offset:28672
    v_mfma_f32_16x16x32_bf16 v[64:67], v[100:103], a[188:191], v[64:67]
    ds_read_b64_tr_b16 v[86:87], v224 offset:32256
    v_mfma_f32_16x16x32_bf16 v[68:71], v[104:107], a[184:187], v[68:71]
    ds_read_b64_tr_b16 v[88:89], v224 offset:28704
    v_mfma_f32_16x16x32_bf16 v[72:75], v[104:107], a[188:191], v[72:75]
    ds_read_b64_tr_b16 v[90:91], v224 offset:32288
    v_mfma_f32_16x16x32_bf16 v[76:79], v[108:111], a[184:187], v[76:79]
    ds_read_b64_tr_b16 v[92:93], v224 offset:28736
    v_mfma_f32_16x16x32_bf16 v[80:83], v[108:111], a[188:191], v[80:83]
    ds_read_b64_tr_b16 v[94:95], v224 offset:32320
    s_waitcnt vmcnt(3)
    v_xor_b32 v170, s56, v170
    s_waitcnt vmcnt(2)
    v_xor_b32 v174, s56, v174
    s_waitcnt vmcnt(1)
    v_xor_b32 v178, s56, v178
    s_waitcnt vmcnt(0)
    v_xor_b32_e64 v182, s56, v182
    v_or3_b32 v170, v170, v174, v178
    v_or_b32 v170, v170, v182
    v_cmp_ne_u32 vcc, 0, v170
    s_mov_b32 s59, 0
    s_cbranch_vccz adaLN_cond__ssm_conv_s4d__mixer_gmlp__prompt_kernel_s2d17
adaLN_cond__ssm_conv_s4d__mixer_gmlp__prompt_kernel_s216:
    buffer_load_dwordx4 v[168:171], v6, s[4:7], s25 offen offset:0 sc1
    buffer_load_dwordx4 v[172:175], v6, s[4:7], s25 offen offset:2048 sc1
    buffer_load_dwordx4 v[176:179], v6, s[4:7], s28 offen offset:0 sc1
    buffer_load_dwordx4 v[180:183], v6, s[4:7], s28 offen offset:2048 sc1
    s_add_u32 s59, s59, 1
    s_waitcnt vmcnt(3)
    v_xor_b32 v170, s56, v170
    s_waitcnt vmcnt(2)
    v_xor_b32 v174, s56, v174
    s_waitcnt vmcnt(1)
    v_xor_b32 v178, s56, v178
    s_waitcnt vmcnt(0)
    v_xor_b32_e64 v182, s56, v182
    v_or3_b32 v170, v170, v174, v178
    v_or_b32 v170, v170, v182
    v_cmp_ne_u32 vcc, 0, v170
    s_nop 0
    s_cbranch_vccz adaLN_cond__ssm_conv_s4d__mixer_gmlp__prompt_kernel_s2d17
    s_cmp_lt_u32 s59, 524288
    s_cbranch_scc1 adaLN_cond__ssm_conv_s4d__mixer_gmlp__prompt_kernel_s216
adaLN_cond__ssm_conv_s4d__mixer_gmlp__prompt_kernel_s2d17:
    v_pk_add_f32 v[168:169], v[168:169], v[172:173]
    v_pk_add_f32 v[176:177], v[176:177], v[180:181]
    s_lshl_b32 s57, s52, 8
    s_add_u32 s57, s57, 155648
    v_and_b32_e64 v6, 31, v1
    v_pk_add_f32 v[168:169], v[168:169], v[176:177]
    v_lshl_add_u32 v6, v6, 2, s57
    v_mov_b32 v170, v168
    v_mov_b32 v171, v169
    v_lshl_add_u32 v7, v3, 4, s57
    v_permlane32_swap_b32 v168, v170
    v_permlane32_swap_b32 v169, v171
    v_pk_add_f32 v[168:169], v[168:169], v[170:171]
    v_mul_f32 v168, 0x3a924925, v168
    v_mul_f32 v169, 0x3a924925, v169
    v_fma_f32 v169, -v168, v168, v169
    v_max_f32_e64 v169, 0, v169
    v_cvt_pk_bf16_f32 v168, v168, v168
    v_and_b32 v168, 0xffff0000, v168
    v_cvt_pk_bf16_f32 v169, v169, v169
    v_and_b32 v169, 0xffff0000, v169
    v_add_f32 v169, 0x3727c5ac, v169
    v_cvt_pk_bf16_f32 v169, v169, v169
    v_and_b32 v169, 0xffff0000, v169
    v_sqrt_f32 v169, v169
    s_nop 0
    v_cvt_pk_bf16_f32 v169, v169, v169
    v_and_b32 v169, 0xffff0000, v169
    v_rcp_f32 v169, v169
    s_nop 0
    v_mul_f32_e64 v168, -v168, v169
    ds_write2_b32 v6, v169, v168 offset0:0 offset1:32
    ds_read_b128 v[148:151], v7 offset:0
    ds_read_b128 v[156:159], v7 offset:128
    ds_read_b128 v[152:155], v7 offset:64
    ds_read_b128 v[160:163], v7 offset:192
    s_mul_i32 s25, s54, 458752
    s_lshl_b32 s57, s53, 1
    s_add_u32 s57, s57, s76
    s_lshl_b32 s57, s57, 10
    s_add_u32 s24, s57, s25
    s_add_u32 s57, s57, s24
    s_add_u32 s57, s57, 9437184
    s_add_u32 s24, s57, 131072
    s_waitcnt lgkmcnt(2)
    v_pk_fma_f32 v[28:29], v[28:29], v[148:149], v[156:157]
    v_pk_fma_f32 v[30:31], v[30:31], v[150:151], v[158:159]
    s_waitcnt lgkmcnt(0)
    s_nop 0
    v_pk_fma_f32 v[32:33], v[32:33], v[152:153], v[160:161]
    v_pk_fma_f32 v[34:35], v[34:35], v[154:155], v[162:163]
    v_cvt_pk_bf16_f32 v28, v28, v29
    v_cvt_pk_bf16_f32 v29, v30, v31
    v_cvt_pk_bf16_f32 v30, v32, v33
    v_cvt_pk_bf16_f32 v31, v34, v35
    buffer_store_dwordx4 v[28:31], v252, s[4:7], s57 offen offset:0 sc1
    v_pk_fma_f32 v[36:37], v[36:37], v[148:149], v[156:157]
    v_pk_fma_f32 v[38:39], v[38:39], v[150:151], v[158:159]
    v_pk_fma_f32 v[40:41], v[40:41], v[152:153], v[160:161]
    v_pk_fma_f32 v[42:43], v[42:43], v[154:155], v[162:163]
    v_cvt_pk_bf16_f32 v36, v36, v37
    v_cvt_pk_bf16_f32 v37, v38, v39
    v_cvt_pk_bf16_f32 v38, v40, v41
    v_cvt_pk_bf16_f32 v39, v42, v43
    buffer_store_dwordx4 v[36:39], v252, s[4:7], s57 offen offset:1024 sc1
    v_pk_fma_f32 v[44:45], v[44:45], v[148:149], v[156:157]
    v_pk_fma_f32 v[46:47], v[46:47], v[150:151], v[158:159]
    v_pk_fma_f32 v[48:49], v[48:49], v[152:153], v[160:161]
    v_pk_fma_f32 v[50:51], v[50:51], v[154:155], v[162:163]
    v_cvt_pk_bf16_f32 v44, v44, v45
    v_cvt_pk_bf16_f32 v45, v46, v47
    v_cvt_pk_bf16_f32 v46, v48, v49
    v_cvt_pk_bf16_f32 v47, v50, v51
    buffer_store_dwordx4 v[44:47], v252, s[4:7], s24 offen offset:0 sc1
    v_pk_fma_f32 v[52:53], v[52:53], v[148:149], v[156:157]
    v_pk_fma_f32 v[54:55], v[54:55], v[150:151], v[158:159]
    v_pk_fma_f32 v[56:57], v[56:57], v[152:153], v[160:161]
    v_pk_fma_f32 v[58:59], v[58:59], v[154:155], v[162:163]
    v_cvt_pk_bf16_f32 v52, v52, v53
    v_cvt_pk_bf16_f32 v53, v54, v55
    v_cvt_pk_bf16_f32 v54, v56, v57
    v_cvt_pk_bf16_f32 v55, v58, v59
    buffer_store_dwordx4 v[52:55], v252, s[4:7], s24 offen offset:1024 sc1
    v_mfma_f32_16x16x32_bf16 v[60:63], v[84:87], a[224:227], v[60:63]
    ds_read_b64_tr_b16 v[100:101], v224 offset:35840
    s_add_u32 m0, s19, 57344
    s_add_u32 s58, s26, 458752
    buffer_load_dwordx4 v18, s[8:11], s58 offen offset:0 lds
    v_mfma_f32_16x16x32_bf16 v[64:67], v[84:87], a[228:231], v[64:67]
    ds_read_b64_tr_b16 v[102:103], v224 offset:39424
    v_mfma_f32_16x16x32_bf16 v[68:71], v[88:91], a[224:227], v[68:71]
    ds_read_b64_tr_b16 v[104:105], v224 offset:35872
    v_mfma_f32_16x16x32_bf16 v[72:75], v[88:91], a[228:231], v[72:75]
    ds_read_b64_tr_b16 v[106:107], v224 offset:39456
    s_add_u32 s58, s26, 465920
    buffer_load_dwordx4 v18, s[8:11], s58 offen offset:1024 lds
    s_add_u32 s58, s26, 473088
    buffer_load_dwordx4 v18, s[8:11], s58 offen offset:2048 lds
    v_mfma_f32_16x16x32_bf16 v[76:79], v[92:95], a[224:227], v[76:79]
    ds_read_b64_tr_b16 v[108:109], v224 offset:35904
    v_mfma_f32_16x16x32_bf16 v[80:83], v[92:95], a[228:231], v[80:83]
    ds_read_b64_tr_b16 v[110:111], v224 offset:39488
    s_add_u32 s58, s26, 480256
    buffer_load_dwordx4 v18, s[8:11], s58 offen offset:3072 lds
    s_waitcnt lgkmcnt(4)
    v_mfma_f32_16x16x32_bf16 v[60:63], v[100:103], a[232:235], v[60:63]
    s_nop 0
    ds_read_b64_tr_b16 v[84:85], v224 offset:43008
    s_add_u32 m0, s19, 61440
    s_add_u32 s58, s26, 491520
    buffer_load_dwordx4 v18, s[8:11], s58 offen offset:0 lds
    v_mfma_f32_16x16x32_bf16 v[64:67], v[100:103], a[236:239], v[64:67]
    ds_read_b64_tr_b16 v[86:87], v224 offset:46592
    s_waitcnt lgkmcnt(4)
    v_mfma_f32_16x16x32_bf16 v[68:71], v[104:107], a[232:235], v[68:71]
    ds_read_b64_tr_b16 v[88:89], v224 offset:43040
    v_mfma_f32_16x16x32_bf16 v[72:75], v[104:107], a[236:239], v[72:75]
    s_nop 0
    ds_read_b64_tr_b16 v[90:91], v224 offset:46624
    s_add_u32 s58, s26, 498688
    buffer_load_dwordx4 v18, s[8:11], s58 offen offset:1024 lds
    s_add_u32 s58, s26, 505856
    buffer_load_dwordx4 v18, s[8:11], s58 offen offset:2048 lds
    s_waitcnt lgkmcnt(4)
    v_mfma_f32_16x16x32_bf16 v[76:79], v[108:111], a[232:235], v[76:79]
    ds_read_b64_tr_b16 v[92:93], v224 offset:43072
    v_mfma_f32_16x16x32_bf16 v[80:83], v[108:111], a[236:239], v[80:83]
    ds_read_b64_tr_b16 v[94:95], v224 offset:46656
    s_add_u32 m0, s19, 0
    s_add_u32 s58, s26, 0
    buffer_load_dwordx4 v18, s[8:11], s58 offen offset:0 lds
    s_waitcnt lgkmcnt(4)
    v_mfma_f32_16x16x32_bf16 v[60:63], v[84:87], a[240:243], v[60:63]
    ds_read_b64_tr_b16 v[100:101], v224 offset:50176
    s_add_u32 s58, s26, 7168
    buffer_load_dwordx4 v18, s[8:11], s58 offen offset:1024 lds
    v_mfma_f32_16x16x32_bf16 v[64:67], v[84:87], a[244:247], v[64:67]
    ds_read_b64_tr_b16 v[102:103], v224 offset:53760
    s_waitcnt lgkmcnt(4)
    v_mfma_f32_16x16x32_bf16 v[68:71], v[88:91], a[240:243], v[68:71]
    ds_read_b64_tr_b16 v[104:105], v224 offset:50208
    v_mfma_f32_16x16x32_bf16 v[72:75], v[88:91], a[244:247], v[72:75]
    s_nop 0
    ds_read_b64_tr_b16 v[106:107], v224 offset:53792
    s_add_u32 s58, s26, 14336
    buffer_load_dwordx4 v18, s[8:11], s58 offen offset:2048 lds
    s_add_u32 s58, s26, 21504
    buffer_load_dwordx4 v18, s[8:11], s58 offen offset:3072 lds
    s_waitcnt lgkmcnt(4)
    v_mfma_f32_16x16x32_bf16 v[76:79], v[92:95], a[240:243], v[76:79]
    ds_read_b64_tr_b16 v[108:109], v224 offset:50240
    v_mfma_f32_16x16x32_bf16 v[80:83], v[92:95], a[244:247], v[80:83]
    s_nop 0
    ds_read_b64_tr_b16 v[110:111], v224 offset:53824
    s_add_u32 m0, s19, 4096
    s_add_u32 s58, s26, 32768
    buffer_load_dwordx4 v18, s[8:11], s58 offen offset:0 lds
    s_waitcnt lgkmcnt(4)
    v_mfma_f32_16x16x32_bf16 v[60:63], v[100:103], a[248:251], v[60:63]
    v_mfma_f32_16x16x32_bf16 v[64:67], v[100:103], a[252:255], v[64:67]
    s_waitcnt lgkmcnt(2)
    v_mfma_f32_16x16x32_bf16 v[68:71], v[104:107], a[248:251], v[68:71]
    v_mfma_f32_16x16x32_bf16 v[72:75], v[104:107], a[252:255], v[72:75]
    s_waitcnt lgkmcnt(0)
    v_mfma_f32_16x16x32_bf16 v[76:79], v[108:111], a[248:251], v[76:79]
    s_add_u32 s58, s26, 39936
    buffer_load_dwordx4 v18, s[8:11], s58 offen offset:1024 lds
    v_mfma_f32_16x16x32_bf16 v[80:83], v[108:111], a[252:255], v[80:83]
    s_nop 0
    s_add_u32 s58, s26, 47104
    buffer_load_dwordx4 v18, s[8:11], s58 offen offset:2048 lds
    s_mul_i32 s80, s52, 6144
    s_add_u32 s80, s80, 114688
    s_add_u32 s82, s19, 86016
    v_lshlrev_b32_e64 v5, 4, v3
    v_add_u32 v5, 158720, v5
    ds_read_b128 v[116:119], v5 offset:0
    ds_read_b128 v[120:123], v5 offset:1024
    ds_read_b128 v[124:127], v5 offset:64
    ds_read_b128 v[128:131], v5 offset:1088
    ds_read_b128 v[132:135], v5 offset:128
    ds_read_b128 v[136:139], v5 offset:1152
    s_sub_u32 s88, 0, s54
    s_and_b32 s88, s88, 3
    s_lshl_b32 s88, s88, 12
    s_add_u32 s88, s88, s18
    v_add_u32 v14, s88, v12
    v_add_u32 v15, s88, v13
    ds_read_b128 a[32:35], v14 offset:0
    ds_read_b128 a[36:39], v15 offset:0
    ds_read_b128 a[40:43], v14 offset:2048
    ds_read_b128 a[44:47], v15 offset:2048
    s_sub_u32 s88, 1, s54
    s_and_b32 s88, s88, 3
    s_lshl_b32 s88, s88, 12
    s_add_u32 s88, s88, s18
    v_add_u32 v14, s88, v12
    v_add_u32 v15, s88, v13
    ds_read_b128 a[96:99], v14 offset:0
    ds_read_b128 a[100:103], v15 offset:0
    ds_read_b128 a[104:107], v14 offset:2048
    ds_read_b128 a[108:111], v15 offset:2048
    s_sub_u32 s88, 2, s54
    s_and_b32 s88, s88, 3
    s_lshl_b32 s88, s88, 12
    s_add_u32 s88, s88, s18
    v_add_u32 v14, s88, v12
    v_add_u32 v15, s88, v13
    ds_read_b128 a[160:163], v14 offset:0
    ds_read_b128 a[164:167], v15 offset:0
    ds_read_b128 a[168:171], v14 offset:2048
    ds_read_b128 a[172:175], v15 offset:2048
    s_sub_u32 s88, 3, s54
    s_and_b32 s88, s88, 3
    s_lshl_b32 s88, s88, 12
    s_add_u32 s88, s88, s18
    v_add_u32 v14, s88, v12
    v_add_u32 v15, s88, v13
    ds_read_b128 a[224:227], v14 offset:0
    ds_read_b128 a[228:231], v15 offset:0
    ds_read_b128 a[232:235], v14 offset:2048
    ds_read_b128 a[236:239], v15 offset:2048
    s_waitcnt lgkmcnt(15)
    s_nop 0
    v_pk_fma_f32 v[60:61], v[116:117], v[164:165], v[60:61] op_sel:[0,1,0] op_sel_hi:[1,1,1] neg_lo:[1,0,0] neg_hi:[1,0,0]
    v_pk_fma_f32 v[62:63], v[118:119], v[164:165], v[62:63] op_sel:[0,1,0] op_sel_hi:[1,1,1] neg_lo:[1,0,0] neg_hi:[1,0,0]
    v_pk_fma_f32 v[64:65], v[116:117], v[166:167], v[64:65] op_sel:[0,1,0] op_sel_hi:[1,1,1] neg_lo:[1,0,0] neg_hi:[1,0,0]
    v_pk_fma_f32 v[66:67], v[118:119], v[166:167], v[66:67] op_sel:[0,1,0] op_sel_hi:[1,1,1] neg_lo:[1,0,0] neg_hi:[1,0,0]
    v_pk_fma_f32 v[60:61], v[60:61], v[164:165], v[120:121] op_sel_hi:[1,0,1]
    v_pk_fma_f32 v[62:63], v[62:63], v[164:165], v[122:123] op_sel_hi:[1,0,1]
    v_pk_fma_f32 v[64:65], v[64:65], v[166:167], v[120:121] op_sel_hi:[1,0,1]
    v_pk_fma_f32 v[66:67], v[66:67], v[166:167], v[122:123] op_sel_hi:[1,0,1]
    v_pk_mul_f32 v[208:209], v[60:61], v[60:61]
    v_pk_mul_f32 v[210:211], v[62:63], v[62:63]
    v_pk_mul_f32 v[212:213], v[64:65], v[64:65]
    v_pk_mul_f32 v[214:215], v[66:67], v[66:67]
    v_pk_fma_f32 v[208:209], v[208:209], s[22:23], s[22:23] op_sel:[0,0,1] op_sel_hi:[1,0,1]
    v_pk_fma_f32 v[210:211], v[210:211], s[22:23], s[22:23] op_sel:[0,0,1] op_sel_hi:[1,0,1]
    v_pk_fma_f32 v[212:213], v[212:213], s[22:23], s[22:23] op_sel:[0,0,1] op_sel_hi:[1,0,1]
    v_pk_fma_f32 v[214:215], v[214:215], s[22:23], s[22:23] op_sel:[0,0,1] op_sel_hi:[1,0,1]
    v_pk_mul_f32 v[208:209], v[208:209], v[60:61]
    v_pk_mul_f32 v[210:211], v[210:211], v[62:63]
    v_pk_mul_f32 v[212:213], v[212:213], v[64:65]
    v_pk_mul_f32 v[214:215], v[214:215], v[66:67]
    v_exp_f32 v208, v208
    v_exp_f32 v209, v209
    v_exp_f32 v210, v210
    v_exp_f32 v211, v211
    v_exp_f32 v212, v212
    v_exp_f32 v213, v213
    v_exp_f32 v214, v214
    v_exp_f32 v215, v215
    v_pk_add_f32 v[208:209], v[208:209], 1.0 op_sel_hi:[1,0]
    v_pk_add_f32 v[210:211], v[210:211], 1.0 op_sel_hi:[1,0]
    v_pk_add_f32 v[212:213], v[212:213], 1.0 op_sel_hi:[1,0]
    v_pk_add_f32 v[214:215], v[214:215], 1.0 op_sel_hi:[1,0]
    v_rcp_f32 v208, v208
    v_rcp_f32 v209, v209
    v_rcp_f32 v210, v210
    v_rcp_f32 v211, v211
    v_rcp_f32 v212, v212
    v_rcp_f32 v213, v213
    v_rcp_f32 v214, v214
    v_rcp_f32 v215, v215
    v_pk_mul_f32 v[60:61], v[60:61], v[208:209]
    v_pk_mul_f32 v[62:63], v[62:63], v[210:211]
    v_pk_mul_f32 v[64:65], v[64:65], v[212:213]
    v_pk_mul_f32 v[66:67], v[66:67], v[214:215]
    v_cvt_pk_bf16_f32 v60, v60, v61
    v_cvt_pk_bf16_f32 v61, v62, v63
    v_cvt_pk_bf16_f32 v64, v64, v65
    v_cvt_pk_bf16_f32 v65, v66, v67
    s_lshl_b32 s57, s54, 12
    s_lshl_b32 s58, s53, 5
    s_add_u32 s57, s57, s58
    v_lshl_add_u32 v4, v1, 10, s57
    s_waitcnt vmcnt(14)
    s_waitcnt lgkmcnt(0)
    s_barrier
    s_cmp_lg_u32 s52, 0
    s_cbranch_scc1 adaLN_cond__ssm_conv_s4d__mixer_gmlp__prompt_kernel_pub18
    v_mov_b32_e64 v5, s56
    s_mov_b32 s60, 327680
    s_mov_b64 exec, 0xf
    buffer_store_dword v5, v4, s[4:7], s60 offen sc1
    s_mov_b64 exec, -1
adaLN_cond__ssm_conv_s4d__mixer_gmlp__prompt_kernel_pub18:
    s_add_u32 s83, s69, 118784
    s_lshl_b32 s92, s52, 13
    s_add_u32 s92, s92, 86016
    s_add_u32 s88, s19, 28672
    s_add_u32 s89, s92, 0
    s_add_u32 s90, s92, 4096
    s_add_u32 s91, s83, 0
    s_bitcmp1_b32 s54, 0
    s_cselect_b32 s85, s88, s91
    s_cselect_b32 s88, s89, s88
    s_cselect_b32 s89, s90, s89
    s_cselect_b32 s90, s91, s90
    s_mov_b32 s91, s85
    s_bitcmp1_b32 s54, 1
    s_cselect_b32 s85, s88, s90
    s_cselect_b32 s88, s90, s88
    s_mov_b32 s90, s85
    s_cselect_b32 s85, s89, s91
    s_cselect_b32 s89, s91, s89
    s_mov_b32 s91, s85
    s_add_u32 s93, s94, 3
    s_and_b32 s93, s93, 3
    s_lshl_b32 s93, s93, 8
    s_mov_b32 m0, s88
    s_add_u32 s85, s61, s93
    s_nop 0
    buffer_load_dwordx4 v8, s[72:75], s85 offen offset:0 lds
    buffer_load_dwordx4 v9, s[72:75], s85 offen offset:1024 lds
    buffer_load_dwordx4 v10, s[72:75], s85 offen offset:2048 lds
    buffer_load_dwordx4 v11, s[72:75], s85 offen offset:3072 lds
    s_mov_b32 m0, s89
    s_add_u32 s85, s64, s93
    buffer_load_dwordx4 v8, s[72:75], s85 offen offset:0 lds
    buffer_load_dwordx4 v9, s[72:75], s85 offen offset:1024 lds
    buffer_load_dwordx4 v10, s[72:75], s85 offen offset:2048 lds
    buffer_load_dwordx4 v11, s[72:75], s85 offen offset:3072 lds
    ds_write_b64 v226, v[60:61] offset:0
    ds_write_b64 v226, v[64:65] offset:3584
    v_pk_fma_f32 v[68:69], v[124:125], v[164:165], v[68:69] op_sel:[0,1,0] op_sel_hi:[1,1,1] neg_lo:[1,0,0] neg_hi:[1,0,0]
    v_pk_fma_f32 v[70:71], v[126:127], v[164:165], v[70:71] op_sel:[0,1,0] op_sel_hi:[1,1,1] neg_lo:[1,0,0] neg_hi:[1,0,0]
    s_mov_b32 m0, s90
    s_add_u32 s85, s65, s93
    buffer_load_dwordx4 v8, s[72:75], s85 offen offset:0 lds
    v_pk_fma_f32 v[72:73], v[124:125], v[166:167], v[72:73] op_sel:[0,1,0] op_sel_hi:[1,1,1] neg_lo:[1,0,0] neg_hi:[1,0,0]
    v_pk_fma_f32 v[74:75], v[126:127], v[166:167], v[74:75] op_sel:[0,1,0] op_sel_hi:[1,1,1] neg_lo:[1,0,0] neg_hi:[1,0,0]
    v_pk_fma_f32 v[68:69], v[68:69], v[164:165], v[128:129] op_sel_hi:[1,0,1]
    v_pk_fma_f32 v[70:71], v[70:71], v[164:165], v[130:131] op_sel_hi:[1,0,1]
    v_pk_fma_f32 v[72:73], v[72:73], v[166:167], v[128:129] op_sel_hi:[1,0,1]
    v_pk_fma_f32 v[74:75], v[74:75], v[166:167], v[130:131] op_sel_hi:[1,0,1]
    v_pk_mul_f32 v[208:209], v[68:69], v[68:69]
    v_pk_mul_f32 v[210:211], v[70:71], v[70:71]
    v_pk_mul_f32 v[212:213], v[72:73], v[72:73]
    v_pk_mul_f32 v[214:215], v[74:75], v[74:75]
    v_pk_fma_f32 v[208:209], v[208:209], s[22:23], s[22:23] op_sel:[0,0,1] op_sel_hi:[1,0,1]
    buffer_load_dwordx4 v9, s[72:75], s85 offen offset:1024 lds
    v_pk_fma_f32 v[210:211], v[210:211], s[22:23], s[22:23] op_sel:[0,0,1] op_sel_hi:[1,0,1]
    v_pk_fma_f32 v[212:213], v[212:213], s[22:23], s[22:23] op_sel:[0,0,1] op_sel_hi:[1,0,1]
    v_pk_fma_f32 v[214:215], v[214:215], s[22:23], s[22:23] op_sel:[0,0,1] op_sel_hi:[1,0,1]
    v_pk_mul_f32 v[208:209], v[208:209], v[68:69]
    v_pk_mul_f32 v[210:211], v[210:211], v[70:71]
    v_pk_mul_f32 v[212:213], v[212:213], v[72:73]
    v_pk_mul_f32 v[214:215], v[214:215], v[74:75]
    v_exp_f32 v208, v208
    v_exp_f32 v209, v209
    v_exp_f32 v210, v210
    v_exp_f32 v211, v211
    buffer_load_dwordx4 v10, s[72:75], s85 offen offset:2048 lds
    v_exp_f32 v212, v212
    v_exp_f32 v213, v213
    v_exp_f32 v214, v214
    v_exp_f32 v215, v215
    v_pk_add_f32 v[208:209], v[208:209], 1.0 op_sel_hi:[1,0]
    v_pk_add_f32 v[210:211], v[210:211], 1.0 op_sel_hi:[1,0]
    v_pk_add_f32 v[212:213], v[212:213], 1.0 op_sel_hi:[1,0]
    v_pk_add_f32 v[214:215], v[214:215], 1.0 op_sel_hi:[1,0]
    v_rcp_f32 v208, v208
    v_rcp_f32 v209, v209
    v_rcp_f32_e64 v210, v210
    buffer_load_dwordx4 v11, s[72:75], s85 offen offset:3072 lds
    v_rcp_f32 v211, v211
    v_rcp_f32 v212, v212
    v_rcp_f32 v213, v213
    v_rcp_f32 v214, v214
    v_rcp_f32_e64 v215, v215
    v_pk_mul_f32 v[68:69], v[68:69], v[208:209]
    v_pk_mul_f32 v[70:71], v[70:71], v[210:211]
    v_pk_mul_f32 v[72:73], v[72:73], v[212:213]
    v_pk_mul_f32 v[74:75], v[74:75], v[214:215]
    v_cvt_pk_bf16_f32 v68, v68, v69
    v_cvt_pk_bf16_f32 v69, v70, v71
    s_mov_b32 m0, s91
    s_add_u32 s85, s66, s93
    buffer_load_dwordx4 v8, s[72:75], s85 offen offset:0 lds
    v_cvt_pk_bf16_f32 v72, v72, v73
    v_cvt_pk_bf16_f32 v73, v74, v75
    ds_write_b64 v226, v[68:69] offset:512
    ds_write_b64 v226, v[72:73] offset:4096
    v_pk_fma_f32 v[76:77], v[132:133], v[164:165], v[76:77] op_sel:[0,1,0] op_sel_hi:[1,1,1] neg_lo:[1,0,0] neg_hi:[1,0,0]
    v_pk_fma_f32 v[78:79], v[134:135], v[164:165], v[78:79] op_sel:[0,1,0] op_sel_hi:[1,1,1] neg_lo:[1,0,0] neg_hi:[1,0,0]
    v_pk_fma_f32 v[80:81], v[132:133], v[166:167], v[80:81] op_sel:[0,1,0] op_sel_hi:[1,1,1] neg_lo:[1,0,0] neg_hi:[1,0,0]
    v_pk_fma_f32 v[82:83], v[134:135], v[166:167], v[82:83] op_sel:[0,1,0] op_sel_hi:[1,1,1] neg_lo:[1,0,0] neg_hi:[1,0,0]
    v_pk_fma_f32 v[76:77], v[76:77], v[164:165], v[136:137] op_sel_hi:[1,0,1]
    v_pk_fma_f32 v[78:79], v[78:79], v[164:165], v[138:139] op_sel_hi:[1,0,1]
    v_pk_fma_f32 v[80:81], v[80:81], v[166:167], v[136:137] op_sel_hi:[1,0,1]
    buffer_load_dwordx4 v9, s[72:75], s85 offen offset:1024 lds
    v_pk_fma_f32 v[82:83], v[82:83], v[166:167], v[138:139] op_sel_hi:[1,0,1]
    v_pk_mul_f32 v[208:209], v[76:77], v[76:77]
    v_pk_mul_f32 v[210:211], v[78:79], v[78:79]
    v_pk_mul_f32 v[212:213], v[80:81], v[80:81]
    v_pk_mul_f32 v[214:215], v[82:83], v[82:83]
    v_pk_fma_f32 v[208:209], v[208:209], s[22:23], s[22:23] op_sel:[0,0,1] op_sel_hi:[1,0,1]
    v_pk_fma_f32 v[210:211], v[210:211], s[22:23], s[22:23] op_sel:[0,0,1] op_sel_hi:[1,0,1]
    v_pk_fma_f32 v[212:213], v[212:213], s[22:23], s[22:23] op_sel:[0,0,1] op_sel_hi:[1,0,1]
    v_pk_fma_f32 v[214:215], v[214:215], s[22:23], s[22:23] op_sel:[0,0,1] op_sel_hi:[1,0,1]
    v_pk_mul_f32 v[208:209], v[208:209], v[76:77]
    v_pk_mul_f32 v[210:211], v[210:211], v[78:79]
    buffer_load_dwordx4 v10, s[72:75], s85 offen offset:2048 lds
    v_pk_mul_f32 v[212:213], v[212:213], v[80:81]
    v_pk_mul_f32 v[214:215], v[214:215], v[82:83]
    v_exp_f32 v208, v208
    v_exp_f32 v209, v209
    v_exp_f32 v210, v210
    v_exp_f32 v211, v211
    v_exp_f32 v212, v212
    v_exp_f32 v213, v213
    v_exp_f32 v214, v214
    v_exp_f32 v215, v215
    v_pk_add_f32 v[208:209], v[208:209], 1.0 op_sel_hi:[1,0]
    buffer_load_dwordx4 v11, s[72:75], s85 offen offset:3072 lds
    v_pk_add_f32 v[210:211], v[210:211], 1.0 op_sel_hi:[1,0]
    v_pk_add_f32 v[212:213], v[212:213], 1.0 op_sel_hi:[1,0]
    v_pk_add_f32 v[214:215], v[214:215], 1.0 op_sel_hi:[1,0]
    v_rcp_f32 v208, v208
    v_rcp_f32 v209, v209
    v_rcp_f32 v210, v210
    v_rcp_f32 v211, v211
    v_rcp_f32 v212, v212
    v_rcp_f32 v213, v213
    v_rcp_f32 v214, v214
    v_rcp_f32 v215, v215
    v_pk_mul_f32 v[76:77], v[76:77], v[208:209]
    v_pk_mul_f32 v[78:79], v[78:79], v[210:211]
    v_pk_mul_f32 v[80:81], v[80:81], v[212:213]
    v_pk_mul_f32 v[82:83], v[82:83], v[214:215]
    v_cvt_pk_bf16_f32 v76, v76, v77
    v_cvt_pk_bf16_f32 v77, v78, v79
    v_cvt_pk_bf16_f32 v80, v80, v81
    v_cvt_pk_bf16_f32 v81, v82, v83
    ds_write_b64 v226, v[76:77] offset:1024
    ds_write_b64 v226, v[80:81] offset:4608
    s_branch adaLN_cond__ssm_conv_s4d__mixer_gmlp__prompt_kernel_join15
adaLN_cond__ssm_conv_s4d__mixer_gmlp__prompt_kernel_role114:
    s_waitcnt vmcnt(12)
    s_barrier
    s_nop 0
    ds_read_b64_tr_b16 a[32:33], v19 offset:0
    ds_read_b64_tr_b16 a[34:35], v19 offset:512
    ds_read_b64_tr_b16 a[36:37], v19 offset:16384
    ds_read_b64_tr_b16 a[38:39], v19 offset:16896
    ds_read_b64_tr_b16 v[84:85], v224 offset:128
    ds_read_b64_tr_b16 v[86:87], v224 offset:3712
    ds_read_b64_tr_b16 v[88:89], v224 offset:160
    ds_read_b64_tr_b16 v[90:91], v224 offset:3744
    ds_read_b64_tr_b16 v[92:93], v224 offset:192
    ds_read_b64_tr_b16 v[94:95], v224 offset:3776
    s_waitcnt lgkmcnt(4)
    v_mfma_f32_16x16x32_bf16 v[28:31], a[32:35], v[84:87], 0
    s_nop 0
    ds_read_b64_tr_b16 a[40:41], v19 offset:1024
    s_mul_i32 s24, s54, 896
    s_add_u32 s24, s24, 720896
    v_cmp_le_u32 vcc, 112, v0
    v_lshlrev_b32_e64 v4, 3, v0
    v_mfma_f32_16x16x32_bf16 v[32:35], a[36:39], v[84:87], 0
    ds_read_b64_tr_b16 a[42:43], v19 offset:1536
    ds_read_b64_tr_b16 a[44:45], v19 offset:17408
    v_mfma_f32_16x16x32_bf16 v[184:187], a[36:39], v[204:207], 0
    ds_read_b64_tr_b16 a[46:47], v19 offset:17920
    v_mfma_f32_16x16x32_bf16 v[188:191], a[32:35], a[32:35], 0
    ds_read_b64_tr_b16 v[100:101], v224 offset:7296
    v_mfma_f32_16x16x32_bf16 v[192:195], a[36:39], a[36:39], 0
    ds_read_b64_tr_b16 v[102:103], v224 offset:10880
    v_add_u32 v5, 6272, v4
    v_cndmask_b32 v5, v4, v5, vcc
    s_waitcnt lgkmcnt(8)
    v_mfma_f32_16x16x32_bf16 v[36:39], a[32:35], v[88:91], 0
    ds_read_b64_tr_b16 v[104:105], v224 offset:7328
    v_mfma_f32_16x16x32_bf16 v[40:43], a[36:39], v[88:91], 0
    ds_read_b64_tr_b16 v[106:107], v224 offset:10912
    s_waitcnt lgkmcnt(8)
    v_mfma_f32_16x16x32_bf16 v[44:47], a[32:35], v[92:95], 0
    ds_read_b64_tr_b16 v[108:109], v224 offset:7360
    v_mfma_f32_16x16x32_bf16 v[48:51], a[36:39], v[92:95], 0
    s_nop 0
    ds_read_b64_tr_b16 v[110:111], v224 offset:10944
    buffer_load_dwordx2 v[196:197], v5, s[4:7], s24 offen sc1
    s_add_u32 s24, s24, 14336
    s_waitcnt lgkmcnt(4)
    v_mfma_f32_16x16x32_bf16 v[28:31], a[40:43], v[100:103], v[28:31]
    ds_read_b64_tr_b16 a[48:49], v19 offset:2048
    buffer_load_dwordx2 v[198:199], v5, s[4:7], s24 offen sc1
    s_add_u32 s24, s24, 14336
    v_mfma_f32_16x16x32_bf16 v[32:35], a[44:47], v[100:103], v[32:35]
    ds_read_b64_tr_b16 a[50:51], v19 offset:2560
    ds_read_b64_tr_b16 a[52:53], v19 offset:18432
    v_mfma_f32_16x16x32_bf16 v[184:187], a[44:47], v[204:207], v[184:187]
    ds_read_b64_tr_b16 a[54:55], v19 offset:18944
    v_mfma_f32_16x16x32_bf16 v[188:191], a[40:43], a[40:43], v[188:191]
    ds_read_b64_tr_b16 v[84:85], v224 offset:14464
    v_mfma_f32_16x16x32_bf16 v[192:195], a[44:47], a[44:47], v[192:195]
    s_nop 0
    ds_read_b64_tr_b16 v[86:87], v224 offset:18048
    buffer_load_dwordx2 v[200:201], v5, s[4:7], s24 offen sc1
    s_add_u32 s24, s24, 14336
    s_waitcnt lgkmcnt(8)
    v_mfma_f32_16x16x32_bf16 v[36:39], a[40:43], v[104:107], v[36:39]
    ds_read_b64_tr_b16 v[88:89], v224 offset:14496
    v_mfma_f32_16x16x32_bf16 v[40:43], a[44:47], v[104:107], v[40:43]
    ds_read_b64_tr_b16 v[90:91], v224 offset:18080
    s_waitcnt lgkmcnt(8)
    v_mfma_f32_16x16x32_bf16 v[44:47], a[40:43], v[108:111], v[44:47]
    ds_read_b64_tr_b16 v[92:93], v224 offset:14528
    v_mfma_f32_16x16x32_bf16 v[48:51], a[44:47], v[108:111], v[48:51]
    ds_read_b64_tr_b16 v[94:95], v224 offset:18112
    buffer_load_dwordx2 v[202:203], v5, s[4:7], s24 offen sc1
    s_add_u32 s24, s24, 14336
    s_waitcnt lgkmcnt(4)
    v_mfma_f32_16x16x32_bf16 v[28:31], a[48:51], v[84:87], v[28:31]
    ds_read_b64_tr_b16 a[56:57], v19 offset:3072
    ds_read_b64_tr_b16 a[58:59], v19 offset:3584
    v_mfma_f32_16x16x32_bf16 v[32:35], a[52:55], v[84:87], v[32:35]
    ds_read_b64_tr_b16 a[60:61], v19 offset:19456
    ds_read_b64_tr_b16 a[62:63], v19 offset:19968
    v_mfma_f32_16x16x32_bf16 v[184:187], a[52:55], v[204:207], v[184:187]
    ds_read_b64_tr_b16 v[100:101], v224 offset:21632
    ds_read_b64_tr_b16 v[102:103], v224 offset:25216
    v_mfma_f32_16x16x32_bf16 v[188:191], a[48:51], a[48:51], v[188:191]
    ds_read_b64_tr_b16 v[104:105], v224 offset:21664
    ds_read_b64_tr_b16 v[106:107], v224 offset:25248
    v_mfma_f32_16x16x32_bf16 v[192:195], a[52:55], a[52:55], v[192:195]
    ds_read_b64_tr_b16 v[108:109], v224 offset:21696
    s_waitcnt lgkmcnt(11)
    v_mfma_f32_16x16x32_bf16 v[36:39], a[48:51], v[88:91], v[36:39]
    ds_read_b64_tr_b16 v[110:111], v224 offset:25280
    v_mfma_f32_16x16x32_bf16 v[40:43], a[52:55], v[88:91], v[40:43]
    s_waitcnt lgkmcnt(10)
    v_mfma_f32_16x16x32_bf16 v[44:47], a[48:51], v[92:95], v[44:47]
    v_mfma_f32_16x16x32_bf16 v[48:51], a[52:55], v[92:95], v[48:51]
    s_waitcnt vmcnt(12)
    s_waitcnt lgkmcnt(0)
    s_barrier
    v_mfma_f32_16x16x32_bf16 v[28:31], a[56:59], v[100:103], v[28:31]
    ds_read_b64_tr_b16 a[96:97], v19 offset:4096
    s_add_u32 m0, s19, 0
    s_nop 0
    buffer_load_dwordx4 v252, s[4:7], s17 offen offset:0 sc1 lds
    v_mfma_f32_16x16x32_bf16 v[32:35], a[60:63], v[100:103], v[32:35]
    ds_read_b64_tr_b16 a[98:99], v19 offset:4608
    ds_read_b64_tr_b16 a[100:101], v19 offset:20480
    v_mfma_f32_16x16x32_bf16 v[184:187], a[60:63], v[204:207], v[184:187]
    ds_read_b64_tr_b16 a[102:103], v19 offset:20992
    v_mfma_f32_16x16x32_bf16 v[188:191], a[56:59], a[56:59], v[188:191]
    ds_read_b64_tr_b16 v[84:85], v224 offset:28800
    v_mfma_f32_16x16x32_bf16 v[192:195], a[60:63], a[60:63], v[192:195]
    ds_read_b64_tr_b16 v[86:87], v224 offset:32384
    buffer_load_dwordx4 v252, s[4:7], s17 offen offset:1024 sc1 lds
    v_mfma_f32_16x16x32_bf16 v[36:39], a[56:59], v[104:107], v[36:39]
    ds_read_b64_tr_b16 v[88:89], v224 offset:28832
    v_mfma_f32_16x16x32_bf16 v[40:43], a[60:63], v[104:107], v[40:43]
    ds_read_b64_tr_b16 v[90:91], v224 offset:32416
    v_mfma_f32_16x16x32_bf16 v[44:47], a[56:59], v[108:111], v[44:47]
    ds_read_b64_tr_b16 v[92:93], v224 offset:28864
    v_mfma_f32_16x16x32_bf16 v[48:51], a[60:63], v[108:111], v[48:51]
    ds_read_b64_tr_b16 v[94:95], v224 offset:32448
    buffer_load_dwordx4 v252, s[4:7], s17 offen offset:2048 sc1 lds
    s_waitcnt lgkmcnt(4)
    v_mfma_f32_16x16x32_bf16 v[28:31], a[96:99], v[84:87], v[28:31]
    ds_read_b64_tr_b16 a[104:105], v19 offset:5120
    buffer_load_dwordx4 v252, s[4:7], s17 offen offset:3072 sc1 lds
    v_mfma_f32_16x16x32_bf16 v[32:35], a[100:103], v[84:87], v[32:35]
    ds_read_b64_tr_b16 a[106:107], v19 offset:5632
    ds_read_b64_tr_b16 a[108:109], v19 offset:21504
    v_mfma_f32_16x16x32_bf16 v[184:187], a[100:103], v[204:207], v[184:187]
    ds_read_b64_tr_b16 a[110:111], v19 offset:22016
    v_mfma_f32_16x16x32_bf16 v[188:191], a[96:99], a[96:99], v[188:191]
    ds_read_b64_tr_b16 v[100:101], v224 offset:35968
    v_mfma_f32_16x16x32_bf16 v[192:195], a[100:103], a[100:103], v[192:195]
    s_nop 0
    ds_read_b64_tr_b16 v[102:103], v224 offset:39552
    s_add_u32 m0, s19, 4096
    s_add_u32 s17, s17, 4096
    buffer_load_dwordx4 v252, s[4:7], s17 offen offset:0 sc1 lds
    s_waitcnt lgkmcnt(8)
    v_mfma_f32_16x16x32_bf16 v[36:39], a[96:99], v[88:91], v[36:39]
    ds_read_b64_tr_b16 v[104:105], v224 offset:36000
    v_mfma_f32_16x16x32_bf16 v[40:43], a[100:103], v[88:91], v[40:43]
    ds_read_b64_tr_b16 v[106:107], v224 offset:39584
    s_waitcnt lgkmcnt(8)
    v_mfma_f32_16x16x32_bf16 v[44:47], a[96:99], v[92:95], v[44:47]
    ds_read_b64_tr_b16 v[108:109], v224 offset:36032
    v_mfma_f32_16x16x32_bf16 v[48:51], a[100:103], v[92:95], v[48:51]
    ds_read_b64_tr_b16 v[110:111], v224 offset:39616
    buffer_load_dwordx4 v252, s[4:7], s17 offen offset:1024 sc1 lds
    s_waitcnt lgkmcnt(4)
    v_mfma_f32_16x16x32_bf16 v[28:31], a[104:107], v[100:103], v[28:31]
    ds_read_b64_tr_b16 a[112:113], v19 offset:6144
    buffer_load_dwordx4 v252, s[4:7], s17 offen offset:2048 sc1 lds
    s_add_u32 s17, s17, 4294762496
    v_mfma_f32_16x16x32_bf16 v[32:35], a[108:111], v[100:103], v[32:35]
    ds_read_b64_tr_b16 a[114:115], v19 offset:6656
    ds_read_b64_tr_b16 a[116:117], v19 offset:22528
    v_mfma_f32_16x16x32_bf16 v[184:187], a[108:111], v[204:207], v[184:187]
    ds_read_b64_tr_b16 a[118:119], v19 offset:23040
    v_mfma_f32_16x16x32_bf16 v[188:191], a[104:107], a[104:107], v[188:191]
    ds_read_b64_tr_b16 v[84:85], v224 offset:43136
    v_mfma_f32_16x16x32_bf16 v[192:195], a[108:111], a[108:111], v[192:195]
    ds_read_b64_tr_b16 v[86:87], v224 offset:46720
    v_mov_b32 v168, -1
    v_mov_b32 v169, -1
    v_mov_b32 v170, -1
    v_mov_b32 v171, -1
    s_waitcnt lgkmcnt(8)
    v_mfma_f32_16x16x32_bf16 v[36:39], a[104:107], v[104:107], v[36:39]
    ds_read_b64_tr_b16 v[88:89], v224 offset:43168
    v_mfma_f32_16x16x32_bf16 v[40:43], a[108:111], v[104:107], v[40:43]
    ds_read_b64_tr_b16 v[90:91], v224 offset:46752
    s_waitcnt lgkmcnt(8)
    v_mfma_f32_16x16x32_bf16 v[44:47], a[104:107], v[108:111], v[44:47]
    ds_read_b64_tr_b16 v[92:93], v224 offset:43200
    v_mfma_f32_16x16x32_bf16 v[48:51], a[108:111], v[108:111], v[48:51]
    ds_read_b64_tr_b16 v[94:95], v224 offset:46784
    buffer_store_dwordx4 v[168:171], v252, s[4:7], s28 offen offset:0 sc1
    s_waitcnt lgkmcnt(4)
    v_mfma_f32_16x16x32_bf16 v[28:31], a[112:115], v[84:87], v[28:31]
    ds_read_b64_tr_b16 a[120:121], v19 offset:7168
    ds_read_b64_tr_b16 a[122:123], v19 offset:7680
    v_mfma_f32_16x16x32_bf16 v[32:35], a[116:119], v[84:87], v[32:35]
    ds_read_b64_tr_b16 a[124:125], v19 offset:23552
    ds_read_b64_tr_b16 a[126:127], v19 offset:24064
    v_mfma_f32_16x16x32_bf16 v[184:187], a[116:119], v[204:207], v[184:187]
    ds_read_b64_tr_b16 v[100:101], v224 offset:50304
    ds_read_b64_tr_b16 v[102:103], v224 offset:53888
    v_mfma_f32_16x16x32_bf16 v[188:191], a[112:115], a[112:115], v[188:191]
    ds_read_b64_tr_b16 v[104:105], v224 offset:50336
    ds_read_b64_tr_b16 v[106:107], v224 offset:53920
    v_mfma_f32_16x16x32_bf16 v[192:195], a[116:119], a[116:119], v[192:195]
    ds_read_b64_tr_b16 v[108:109], v224 offset:50368
    s_waitcnt lgkmcnt(11)
    v_mfma_f32_16x16x32_bf16 v[36:39], a[112:115], v[88:91], v[36:39]
    ds_read_b64_tr_b16 v[110:111], v224 offset:53952
    buffer_store_dwordx4 v[168:171], v252, s[4:7], s28 offen offset:1024 sc1
    v_mfma_f32_16x16x32_bf16 v[40:43], a[116:119], v[88:91], v[40:43]
    s_waitcnt lgkmcnt(10)
    v_mfma_f32_16x16x32_bf16 v[44:47], a[112:115], v[92:95], v[44:47]
    buffer_store_dwordx4 v[168:171], v252, s[4:7], s28 offen offset:2048 sc1
    v_mfma_f32_16x16x32_bf16 v[48:51], a[116:119], v[92:95], v[48:51]
    buffer_store_dwordx2 v[168:169], v17, s[4:7], s28 offen offset:3072 sc1
    s_waitcnt vmcnt(19)
    s_waitcnt lgkmcnt(0)
    s_barrier
    v_mfma_f32_16x16x32_bf16 v[28:31], a[120:123], v[100:103], v[28:31]
    ds_read_b64_tr_b16 a[160:161], v19 offset:8192
    s_add_u32 m0, s19, 28672
    s_nop 0
    buffer_load_dwordx4 v252, s[4:7], s17 offen offset:0 sc1 lds
    v_mfma_f32_16x16x32_bf16 v[32:35], a[124:127], v[100:103], v[32:35]
    ds_read_b64_tr_b16 a[162:163], v19 offset:8704
    ds_read_b64_tr_b16 a[164:165], v19 offset:24576
    v_mfma_f32_16x16x32_bf16 v[184:187], a[124:127], v[204:207], v[184:187]
    ds_read_b64_tr_b16 a[166:167], v19 offset:25088
    v_mfma_f32_16x16x32_bf16 v[188:191], a[120:123], a[120:123], v[188:191]
    ds_read_b64_tr_b16 v[84:85], v225 offset:128
    v_mfma_f32_16x16x32_bf16 v[192:195], a[124:127], a[124:127], v[192:195]
    ds_read_b64_tr_b16 v[86:87], v225 offset:3712
    buffer_load_dwordx4 v252, s[4:7], s17 offen offset:1024 sc1 lds
    v_mfma_f32_16x16x32_bf16 v[36:39], a[120:123], v[104:107], v[36:39]
    ds_read_b64_tr_b16 v[88:89], v225 offset:160
    v_mfma_f32_16x16x32_bf16 v[40:43], a[124:127], v[104:107], v[40:43]
    ds_read_b64_tr_b16 v[90:91], v225 offset:3744
    v_mfma_f32_16x16x32_bf16 v[44:47], a[120:123], v[108:111], v[44:47]
    ds_read_b64_tr_b16 v[92:93], v225 offset:192
    v_mfma_f32_16x16x32_bf16 v[48:51], a[124:127], v[108:111], v[48:51]
    ds_read_b64_tr_b16 v[94:95], v225 offset:3776
    buffer_load_dwordx4 v252, s[4:7], s17 offen offset:2048 sc1 lds
    s_waitcnt lgkmcnt(4)
    v_mfma_f32_16x16x32_bf16 v[28:31], a[160:163], v[84:87], v[28:31]
    ds_read_b64_tr_b16 a[168:169], v19 offset:9216
    buffer_load_dwordx4 v252, s[4:7], s17 offen offset:3072 sc1 lds
    v_mfma_f32_16x16x32_bf16 v[32:35], a[164:167], v[84:87], v[32:35]
    ds_read_b64_tr_b16 a[170:171], v19 offset:9728
    ds_read_b64_tr_b16 a[172:173], v19 offset:25600
    v_mfma_f32_16x16x32_bf16 v[184:187], a[164:167], v[204:207], v[184:187]
    ds_read_b64_tr_b16 a[174:175], v19 offset:26112
    v_mfma_f32_16x16x32_bf16 v[188:191], a[160:163], a[160:163], v[188:191]
    ds_read_b64_tr_b16 v[100:101], v225 offset:7296
    v_mfma_f32_16x16x32_bf16 v[192:195], a[164:167], a[164:167], v[192:195]
    s_nop 0
    ds_read_b64_tr_b16 v[102:103], v225 offset:10880
    s_add_u32 m0, s19, 32768
    s_add_u32 s17, s17, 4096
    buffer_load_dwordx4 v252, s[4:7], s17 offen offset:0 sc1 lds
    s_waitcnt lgkmcnt(8)
    v_mfma_f32_16x16x32_bf16 v[36:39], a[160:163], v[88:91], v[36:39]
    ds_read_b64_tr_b16 v[104:105], v225 offset:7328
    v_mfma_f32_16x16x32_bf16 v[40:43], a[164:167], v[88:91], v[40:43]
    ds_read_b64_tr_b16 v[106:107], v225 offset:10912
    s_waitcnt lgkmcnt(8)
    v_mfma_f32_16x16x32_bf16 v[44:47], a[160:163], v[92:95], v[44:47]
    ds_read_b64_tr_b16 v[108:109], v225 offset:7360
    v_mfma_f32_16x16x32_bf16 v[48:51], a[164:167], v[92:95], v[48:51]
    ds_read_b64_tr_b16 v[110:111], v225 offset:10944
    buffer_load_dwordx4 v252, s[4:7], s17 offen offset:1024 sc1 lds
    s_waitcnt lgkmcnt(4)
    v_mfma_f32_16x16x32_bf16 v[28:31], a[168:171], v[100:103], v[28:31]
    ds_read_b64_tr_b16 a[176:177], v19 offset:10240
    buffer_load_dwordx4 v252, s[4:7], s17 offen offset:2048 sc1 lds
    s_add_u32 s17, s17, 24576
    v_mfma_f32_16x16x32_bf16 v[32:35], a[172:175], v[100:103], v[32:35]
    ds_read_b64_tr_b16 a[178:179], v19 offset:10752
    ds_read_b64_tr_b16 a[180:181], v19 offset:26624
    v_mfma_f32_16x16x32_bf16 v[184:187], a[172:175], v[204:207], v[184:187]
    ds_read_b64_tr_b16 a[182:183], v19 offset:27136
    v_mfma_f32_16x16x32_bf16 v[188:191], a[168:171], a[168:171], v[188:191]
    ds_read_b64_tr_b16 v[84:85], v225 offset:14464
    v_mfma_f32_16x16x32_bf16 v[192:195], a[172:175], a[172:175], v[192:195]
    ds_read_b64_tr_b16 v[86:87], v225 offset:18048
    s_waitcnt vmcnt(20)
    v_add_f32 v196, v196, v198
    s_waitcnt vmcnt(18)
    v_add_f32 v200, v200, v202
    s_waitcnt lgkmcnt(8)
    v_mfma_f32_16x16x32_bf16 v[36:39], a[168:171], v[104:107], v[36:39]
    ds_read_b64_tr_b16 v[88:89], v225 offset:14496
    v_mfma_f32_16x16x32_bf16 v[40:43], a[172:175], v[104:107], v[40:43]
    ds_read_b64_tr_b16 v[90:91], v225 offset:18080
    s_waitcnt lgkmcnt(8)
    v_mfma_f32_16x16x32_bf16 v[44:47], a[168:171], v[108:111], v[44:47]
    ds_read_b64_tr_b16 v[92:93], v225 offset:14528
    v_mfma_f32_16x16x32_bf16 v[48:51], a[172:175], v[108:111], v[48:51]
    ds_read_b64_tr_b16 v[94:95], v225 offset:18112
    v_add_f32 v197, v197, v199
    v_add_f32 v201, v201, v203
    s_waitcnt lgkmcnt(4)
    v_mfma_f32_16x16x32_bf16 v[28:31], a[176:179], v[84:87], v[28:31]
    ds_read_b64_tr_b16 a[184:185], v19 offset:11264
    ds_read_b64_tr_b16 a[186:187], v19 offset:11776
    v_mfma_f32_16x16x32_bf16 v[32:35], a[180:183], v[84:87], v[32:35]
    ds_read_b64_tr_b16 a[188:189], v19 offset:27648
    ds_read_b64_tr_b16 a[190:191], v19 offset:28160
    v_mfma_f32_16x16x32_bf16 v[184:187], a[180:183], v[204:207], v[184:187]
    ds_read_b64_tr_b16 v[100:101], v225 offset:21632
    ds_read_b64_tr_b16 v[102:103], v225 offset:25216
    v_mfma_f32_16x16x32_bf16 v[188:191], a[176:179], a[176:179], v[188:191]
    ds_read_b64_tr_b16 v[104:105], v225 offset:21664
    ds_read_b64_tr_b16 v[106:107], v225 offset:25248
    v_mfma_f32_16x16x32_bf16 v[192:195], a[180:183], a[180:183], v[192:195]
    ds_read_b64_tr_b16 v[108:109], v225 offset:21696
    s_waitcnt lgkmcnt(11)
    v_mfma_f32_16x16x32_bf16 v[36:39], a[176:179], v[88:91], v[36:39]
    ds_read_b64_tr_b16 v[110:111], v225 offset:25280
    v_mfma_f32_16x16x32_bf16 v[40:43], a[180:183], v[88:91], v[40:43]
    s_waitcnt lgkmcnt(10)
    v_mfma_f32_16x16x32_bf16 v[44:47], a[176:179], v[92:95], v[44:47]
    v_mfma_f32_16x16x32_bf16 v[48:51], a[180:183], v[92:95], v[48:51]
    v_add_f32 v196, v196, v200
    v_add_f32_e64 v197, v197, v201
    s_waitcnt vmcnt(11)
    s_waitcnt lgkmcnt(0)
    s_barrier
    v_mfma_f32_16x16x32_bf16 v[28:31], a[184:187], v[100:103], v[28:31]
    ds_read_b64_tr_b16 a[224:225], v19 offset:12288
    v_add_u32 v4, 156672, v4
    v_lshlrev_b32_e64 v5, 2, v0
    v_mfma_f32_16x16x32_bf16 v[32:35], a[188:191], v[100:103], v[32:35]
    ds_read_b64_tr_b16 a[226:227], v19 offset:12800
    ds_read_b64_tr_b16 a[228:229], v19 offset:28672
    v_mfma_f32_16x16x32_bf16 v[184:187], a[188:191], v[204:207], v[184:187]
    ds_read_b64_tr_b16 a[230:231], v19 offset:29184
    v_mfma_f32_16x16x32_bf16 v[188:191], a[184:187], a[184:187], v[188:191]
    ds_read_b64_tr_b16 v[84:85], v224 offset:128
    v_mfma_f32_16x16x32_bf16 v[192:195], a[188:191], a[188:191], v[192:195]
    ds_read_b64_tr_b16 v[86:87], v224 offset:3712
    v_add_u32 v5, 158720, v5
    v_mfma_f32_16x16x32_bf16 v[36:39], a[184:187], v[104:107], v[36:39]
    ds_read_b64_tr_b16 v[88:89], v224 offset:160
    v_mfma_f32_16x16x32_bf16 v[40:43], a[188:191], v[104:107], v[40:43]
    ds_read_b64_tr_b16 v[90:91], v224 offset:3744
    v_mfma_f32_16x16x32_bf16 v[44:47], a[184:187], v[108:111], v[44:47]
    ds_read_b64_tr_b16 v[92:93], v224 offset:192
    v_mfma_f32_16x16x32_bf16 v[48:51], a[188:191], v[108:111], v[48:51]
    ds_read_b64_tr_b16 v[94:95], v224 offset:3776
    ds_write_b64 v4, v[196:197]
    s_waitcnt lgkmcnt(5)
    v_mfma_f32_16x16x32_bf16 v[28:31], a[224:227], v[84:87], v[28:31]
    ds_read_b64_tr_b16 a[232:233], v19 offset:13312
    ds_write2st64_b32 v5, v196, v197 offset0:0 offset1:4
    v_mfma_f32_16x16x32_bf16 v[32:35], a[228:231], v[84:87], v[32:35]
    ds_read_b64_tr_b16 a[234:235], v19 offset:13824
    ds_read_b64_tr_b16 a[236:237], v19 offset:29696
    v_mfma_f32_16x16x32_bf16 v[184:187], a[228:231], v[204:207], v[184:187]
    ds_read_b64_tr_b16 a[238:239], v19 offset:30208
    v_mfma_f32_16x16x32_bf16 v[188:191], a[224:227], a[224:227], v[188:191]
    ds_read_b64_tr_b16 v[100:101], v224 offset:7296
    v_mfma_f32_16x16x32_bf16 v[192:195], a[228:231], a[228:231], v[192:195]
    ds_read_b64_tr_b16 v[102:103], v224 offset:10880
    s_add_u32 m0, s19, 57344
    s_nop 0
    buffer_load_dwordx4 v252, s[4:7], s17 offen offset:0 sc1 lds
    s_waitcnt lgkmcnt(10)
    v_mfma_f32_16x16x32_bf16 v[36:39], a[224:227], v[88:91], v[36:39]
    ds_read_b64_tr_b16 v[104:105], v224 offset:7328
    v_mfma_f32_16x16x32_bf16 v[40:43], a[228:231], v[88:91], v[40:43]
    ds_read_b64_tr_b16 v[106:107], v224 offset:10912
    s_waitcnt lgkmcnt(10)
    v_mfma_f32_16x16x32_bf16 v[44:47], a[224:227], v[92:95], v[44:47]
    ds_read_b64_tr_b16 v[108:109], v224 offset:7360
    v_mfma_f32_16x16x32_bf16 v[48:51], a[228:231], v[92:95], v[48:51]
    ds_read_b64_tr_b16 v[110:111], v224 offset:10944
    buffer_load_dwordx4 v252, s[4:7], s17 offen offset:1024 sc1 lds
    s_waitcnt lgkmcnt(4)
    v_mfma_f32_16x16x32_bf16 v[28:31], a[232:235], v[100:103], v[28:31]
    ds_read_b64_tr_b16 a[240:241], v19 offset:14336
    buffer_load_dwordx4 v252, s[4:7], s17 offen offset:2048 sc1 lds
    v_mfma_f32_16x16x32_bf16 v[32:35], a[236:239], v[100:103], v[32:35]
    ds_read_b64_tr_b16 a[242:243], v19 offset:14848
    ds_read_b64_tr_b16 a[244:245], v19 offset:30720
    v_mfma_f32_16x16x32_bf16 v[184:187], a[236:239], v[204:207], v[184:187]
    ds_read_b64_tr_b16 a[246:247], v19 offset:31232
    v_mfma_f32_16x16x32_bf16 v[188:191], a[232:235], a[232:235], v[188:191]
    ds_read_b64_tr_b16 v[84:85], v224 offset:14464
    v_mfma_f32_16x16x32_bf16 v[192:195], a[236:239], a[236:239], v[192:195]
    ds_read_b64_tr_b16 v[86:87], v224 offset:18048
    buffer_load_dwordx4 v252, s[4:7], s17 offen offset:3072 sc1 lds
    s_waitcnt lgkmcnt(8)
    v_mfma_f32_16x16x32_bf16 v[36:39], a[232:235], v[104:107], v[36:39]
    ds_read_b64_tr_b16 v[88:89], v224 offset:14496
    v_mfma_f32_16x16x32_bf16 v[40:43], a[236:239], v[104:107], v[40:43]
    ds_read_b64_tr_b16 v[90:91], v224 offset:18080
    s_waitcnt lgkmcnt(8)
    v_mfma_f32_16x16x32_bf16 v[44:47], a[232:235], v[108:111], v[44:47]
    ds_read_b64_tr_b16 v[92:93], v224 offset:14528
    v_mfma_f32_16x16x32_bf16 v[48:51], a[236:239], v[108:111], v[48:51]
    s_nop 0
    ds_read_b64_tr_b16 v[94:95], v224 offset:18112
    s_add_u32 m0, s19, 61440
    s_add_u32 s17, s17, 4096
    buffer_load_dwordx4 v252, s[4:7], s17 offen offset:0 sc1 lds
    s_waitcnt lgkmcnt(4)
    v_mfma_f32_16x16x32_bf16 v[28:31], a[240:243], v[84:87], v[28:31]
    ds_read_b64_tr_b16 a[248:249], v19 offset:15360
    v_mfma_f32_16x16x32_bf16 v[32:35], a[244:247], v[84:87], v[32:35]
    ds_read_b64_tr_b16 a[250:251], v19 offset:15872
    ds_read_b64_tr_b16 a[252:253], v19 offset:31744
    v_mfma_f32_16x16x32_bf16 v[184:187], a[244:247], v[204:207], v[184:187]
    ds_read_b64_tr_b16 a[254:255], v19 offset:32256
    v_mfma_f32_16x16x32_bf16 v[188:191], a[240:243], a[240:243], v[188:191]
    ds_read_b64_tr_b16 v[100:101], v224 offset:21632
    v_mfma_f32_16x16x32_bf16 v[192:195], a[244:247], a[244:247], v[192:195]
    ds_read_b64_tr_b16 v[102:103], v224 offset:25216
    buffer_load_dwordx4 v252, s[4:7], s17 offen offset:1024 sc1 lds
    s_waitcnt lgkmcnt(8)
    v_mfma_f32_16x16x32_bf16 v[36:39], a[240:243], v[88:91], v[36:39]
    ds_read_b64_tr_b16 v[104:105], v224 offset:21664
    v_mfma_f32_16x16x32_bf16 v[40:43], a[244:247], v[88:91], v[40:43]
    ds_read_b64_tr_b16 v[106:107], v224 offset:25248
    s_waitcnt lgkmcnt(8)
    v_mfma_f32_16x16x32_bf16 v[44:47], a[240:243], v[92:95], v[44:47]
    ds_read_b64_tr_b16 v[108:109], v224 offset:21696
    v_mfma_f32_16x16x32_bf16 v[48:51], a[244:247], v[92:95], v[48:51]
    s_nop 0
    ds_read_b64_tr_b16 v[110:111], v224 offset:25280
    buffer_load_dwordx4 v252, s[4:7], s17 offen offset:2048 sc1 lds
    s_add_u32 s17, s17, 24576
    s_waitcnt lgkmcnt(4)
    v_mfma_f32_16x16x32_bf16 v[28:31], a[248:251], v[100:103], v[28:31]
    v_mfma_f32_16x16x32_bf16 v[32:35], a[252:255], v[100:103], v[32:35]
    v_mfma_f32_16x16x32_bf16 v[184:187], a[252:255], v[204:207], v[184:187]
    v_mfma_f32_16x16x32_bf16 v[188:191], a[248:251], a[248:251], v[188:191]
    v_mfma_f32_16x16x32_bf16 v[192:195], a[252:255], a[252:255], v[192:195]
    s_waitcnt lgkmcnt(2)
    v_mfma_f32_16x16x32_bf16 v[36:39], a[248:251], v[104:107], v[36:39]
    s_lshl_b32 s57, s54, 11
    s_add_u32 s57, s57, s18
    v_add_u32_e64 v4, s57, v17
    v_mfma_f32_16x16x32_bf16 v[40:43], a[252:255], v[104:107], v[40:43]
    s_waitcnt lgkmcnt(0)
    v_mfma_f32_16x16x32_bf16 v[44:47], a[248:251], v[108:111], v[44:47]
    ds_read_b64_tr_b16 v[20:21], v4 offset:0
    ds_read_b64_tr_b16 v[22:23], v4 offset:512
    v_mfma_f32_16x16x32_bf16 v[48:51], a[252:255], v[108:111], v[48:51]
    ds_read_b64_tr_b16 v[24:25], v4 offset:1024
    ds_read_b64_tr_b16 v[26:27], v4 offset:1536
    s_lshl_b32 s57, s76, 7
    s_add_u32 s57, s57, 153600
    v_lshl_add_u32 v6, v3, 4, s57
    v_lshl_add_u32 v7, v2, 2, s57
    s_mov_b32 exec_lo, 0x00010001
    s_mov_b32 exec_hi, 0x00010001
    ds_write_b128 v6, v[184:187] offset:64
    s_mov_b64 exec, -1
    s_nop 0
    s_mov_b32 vcc_lo, 0xaaaaaaaa
    s_mov_b32 vcc_hi, 0xaaaaaaaa
    s_mov_b32 s62, 0xcccccccc
    s_mov_b32 s63, 0xcccccccc
    v_cndmask_b32 v188, v188, v189, vcc
    v_cndmask_b32 v190, v190, v191, vcc
    v_cndmask_b32_e64 v188, v188, v190, s[62:63]
    v_cndmask_b32 v192, v192, v193, vcc
    v_cndmask_b32 v194, v194, v195, vcc
    v_cndmask_b32_e64 v192, v192, v194, s[62:63]
    s_mov_b32 exec_lo, 0x00f0000f
    s_mov_b32 exec_hi, 0xf0000f00
    ds_write2_b32 v7, v188, v192 offset0:64 offset1:80
    s_mov_b64 exec, -1
    v_and_b32 v6, 31, v1
    v_lshl_add_u32 v7, v6, 2, s57
    s_waitcnt lgkmcnt(0)
    s_barrier
    ds_read2st64_b32 v[184:185], v7 offset0:0 offset1:1
    v_lshlrev_b32_e64 v4, 3, v2
    v_add_u32 v4, 157568, v4
    ds_read_b64 v[196:197], v4 offset:512
    ds_read_b64 v[198:199], v4 offset:640
    ds_read_b64 v[200:201], v4 offset:768
    s_add_u32 m0, s19, 0
    s_nop 0
    buffer_load_dwordx4 v252, s[4:7], s17 offen offset:0 sc1 lds
    buffer_load_dwordx4 v252, s[4:7], s17 offen offset:1024 sc1 lds
    buffer_load_dwordx4 v252, s[4:7], s17 offen offset:2048 sc1 lds
    s_lshl_b32 s57, s52, 8
    s_nop 0
    s_add_u32 s57, s57, 154112
    v_lshl_add_u32 v6, v6, 2, s57
    v_lshl_add_u32 v7, v3, 4, s57
    v_lshl_add_u32 v5, v2, 2, s57
    s_waitcnt lgkmcnt(3)
    s_nop 0
    v_mul_f32 v184, 0x3b000000, v184
    v_mul_f32 v185, 0x3b000000, v185
    v_fma_f32 v185, -v184, v184, v185
    v_max_f32_e64 v185, 0, v185
    v_cvt_pk_bf16_f32 v184, v184, v184
    v_and_b32 v184, 0xffff0000, v184
    v_cvt_pk_bf16_f32 v185, v185, v185
    v_and_b32 v185, 0xffff0000, v185
    v_add_f32 v185, 0x3727c5ac, v185
    v_cvt_pk_bf16_f32 v185, v185, v185
    v_and_b32 v185, 0xffff0000, v185
    v_sqrt_f32 v185, v185
    s_nop 0
    v_cvt_pk_bf16_f32 v185, v185, v185
    v_and_b32 v185, 0xffff0000, v185
    v_rcp_f32_e64 v185, v185
    ds_write2_b32 v6, v185, v184 offset0:0 offset1:32
    ds_read_b128 v[148:151], v7 offset:0
    ds_read_b128 v[156:159], v7 offset:128
    ds_read_b128 v[152:155], v7 offset:64
    ds_read_b128 v[160:163], v7 offset:192
    ds_read2_b32 v[164:165], v5 offset0:0 offset1:32
    ds_read2_b32 v[166:167], v5 offset0:16 offset1:48
    buffer_load_dwordx4 v252, s[4:7], s17 offen offset:3072 sc1 lds
    s_add_u32 m0, s19, 4096
    s_add_u32 s17, s17, 4096
    buffer_load_dwordx4 v252, s[4:7], s17 offen offset:0 sc1 lds
    buffer_load_dwordx4 v252, s[4:7], s17 offen offset:1024 sc1 lds
    buffer_load_dwordx4 v252, s[4:7], s17 offen offset:2048 sc1 lds
    s_add_u32 s17, s17, 24576
    s_add_u32 s93, s94, 2
    s_and_b32 s93, s93, 3
    s_lshl_b32 s93, s93, 8
    s_add_u32 m0, s18, 0
    s_add_u32 s85, s61, s93
    buffer_load_dwordx4 v8, s[72:75], s85 offen offset:0 lds
    s_lshl_b32 s57, s50, 2
    s_add_u32 s57, s57, s52
    s_mul_i32 s57, s57, 8192
    s_and_b32 s58, s3, 1
    s_lshl_b32 s58, s58, 9
    s_add_u32 s57, s57, s58
    v_lshrrev_b32 v4, 2, v1
    v_and_b32 v5, 3, v1
    v_lshlrev_b32_e64 v5, 7, v5
    v_lshl_add_u32 v4, v4, 10, v5
    s_mov_b64 exec, 0xffffffff
    buffer_load_dword v254, v4, s[8:11], s57 offen
    s_mov_b64 exec, -1
    s_lshl_b32 s59, s50, 2
    s_add_u32 s59, s59, s52
    s_nop 0
    s_mul_i32 s59, s59, 128
    s_add_u32 s59, s59, adaLN_cond__ssm_conv_s4d__mixer_gmlp__prompt_kernel_g2c4-adaLN_cond__ssm_conv_s4d__mixer_gmlp__prompt_kernel_pc2
    v_lshl_add_u32 v4, v1, 7, s59
    v_min_u32 v4, adaLN_cond__ssm_conv_s4d__mixer_gmlp__prompt_kernel_end1-adaLN_cond__ssm_conv_s4d__mixer_gmlp__prompt_kernel_pc2-4, v4
    v_mov_b32 v5, s87
    v_add_co_u32 v4, vcc, s86, v4
    s_nop 1
    v_addc_co_u32_e64 v5, vcc, 0, v5, vcc
    s_mov_b64 exec, 1
    global_load_dword v254, v[4:5], off
    s_mov_b64 exec, -1
    s_waitcnt lgkmcnt(4)
    v_pk_fma_f32 v[28:29], v[156:157], v[196:197], v[28:29] op_sel_hi:[1,0,1] neg_lo:[1,0,0] neg_hi:[1,0,0]
    v_pk_fma_f32 v[30:31], v[158:159], v[196:197], v[30:31] op_sel_hi:[1,0,1] neg_lo:[1,0,0] neg_hi:[1,0,0]
    s_waitcnt lgkmcnt(2)
    s_nop 0
    v_pk_fma_f32 v[32:33], v[160:161], v[196:197], v[32:33] op_sel_hi:[1,0,1] neg_lo:[1,0,0] neg_hi:[1,0,0]
    buffer_load_dwordx4 v9, s[72:75], s85 offen offset:1024 lds
    v_pk_fma_f32 v[34:35], v[162:163], v[196:197], v[34:35] op_sel_hi:[1,0,1] neg_lo:[1,0,0] neg_hi:[1,0,0]
    v_pk_fma_f32 v[28:29], v[28:29], v[148:149], v[196:197] op_sel:[0,0,1] op_sel_hi:[1,1,1]
    v_pk_fma_f32 v[30:31], v[30:31], v[150:151], v[196:197] op_sel:[0,0,1] op_sel_hi:[1,1,1]
    v_pk_fma_f32 v[32:33], v[32:33], v[152:153], v[196:197] op_sel:[0,0,1] op_sel_hi:[1,1,1]
    v_pk_fma_f32 v[34:35], v[34:35], v[154:155], v[196:197] op_sel:[0,0,1] op_sel_hi:[1,1,1]
    v_pk_mul_f32 v[208:209], v[28:29], v[28:29]
    v_pk_mul_f32 v[210:211], v[30:31], v[30:31]
    v_pk_mul_f32 v[212:213], v[32:33], v[32:33]
    v_pk_mul_f32 v[214:215], v[34:35], v[34:35]
    v_pk_fma_f32 v[208:209], v[208:209], s[22:23], s[22:23] op_sel:[0,0,1] op_sel_hi:[1,0,1]
    v_pk_fma_f32 v[210:211], v[210:211], s[22:23], s[22:23] op_sel:[0,0,1] op_sel_hi:[1,0,1]
    v_pk_fma_f32 v[212:213], v[212:213], s[22:23], s[22:23] op_sel:[0,0,1] op_sel_hi:[1,0,1]
    v_pk_fma_f32 v[214:215], v[214:215], s[22:23], s[22:23] op_sel:[0,0,1] op_sel_hi:[1,0,1]
    v_pk_mul_f32 v[208:209], v[208:209], v[28:29]
    v_pk_mul_f32 v[210:211], v[210:211], v[30:31]
    v_pk_mul_f32 v[212:213], v[212:213], v[32:33]
    v_pk_mul_f32 v[214:215], v[214:215], v[34:35]
    v_exp_f32 v208, v208
    v_exp_f32 v209, v209
    v_exp_f32 v210, v210
    v_exp_f32 v211, v211
    v_exp_f32 v212, v212
    v_exp_f32 v213, v213
    v_exp_f32 v214, v214
    v_exp_f32 v215, v215
    v_pk_add_f32 v[208:209], v[208:209], 1.0 op_sel_hi:[1,0]
    v_pk_add_f32 v[210:211], v[210:211], 1.0 op_sel_hi:[1,0]
    v_pk_add_f32 v[212:213], v[212:213], 1.0 op_sel_hi:[1,0]
    v_pk_add_f32 v[214:215], v[214:215], 1.0 op_sel_hi:[1,0]
    v_rcp_f32 v208, v208
    v_rcp_f32 v209, v209
    v_rcp_f32 v210, v210
    v_rcp_f32 v211, v211
    v_rcp_f32 v212, v212
    v_rcp_f32 v213, v213
    v_rcp_f32 v214, v214
    v_rcp_f32 v215, v215
    v_pk_mul_f32 v[28:29], v[28:29], v[208:209]
    buffer_load_dwordx4 v10, s[72:75], s85 offen offset:2048 lds
    v_pk_mul_f32 v[30:31], v[30:31], v[210:211]
    v_pk_mul_f32 v[32:33], v[32:33], v[212:213]
    v_pk_mul_f32 v[34:35], v[34:35], v[214:215]
    v_pk_mul_f32 v[176:177], v[28:29], v[28:29]
    v_pk_mul_f32 v[178:179], v[30:31], v[30:31]
    v_pk_mul_f32 v[180:181], v[32:33], v[32:33]
    v_pk_mul_f32 v[182:183], v[34:35], v[34:35]
    v_pk_fma_f32 v[36:37], v[156:157], v[198:199], v[36:37] op_sel_hi:[1,0,1] neg_lo:[1,0,0] neg_hi:[1,0,0]
    v_pk_fma_f32 v[38:39], v[158:159], v[198:199], v[38:39] op_sel_hi:[1,0,1] neg_lo:[1,0,0] neg_hi:[1,0,0]
    v_pk_fma_f32 v[40:41], v[160:161], v[198:199], v[40:41] op_sel_hi:[1,0,1] neg_lo:[1,0,0] neg_hi:[1,0,0]
    v_pk_fma_f32 v[42:43], v[162:163], v[198:199], v[42:43] op_sel_hi:[1,0,1] neg_lo:[1,0,0] neg_hi:[1,0,0]
    v_pk_fma_f32 v[36:37], v[36:37], v[148:149], v[198:199] op_sel:[0,0,1] op_sel_hi:[1,1,1]
    v_pk_fma_f32 v[38:39], v[38:39], v[150:151], v[198:199] op_sel:[0,0,1] op_sel_hi:[1,1,1]
    v_pk_fma_f32 v[40:41], v[40:41], v[152:153], v[198:199] op_sel:[0,0,1] op_sel_hi:[1,1,1]
    v_pk_fma_f32 v[42:43], v[42:43], v[154:155], v[198:199] op_sel:[0,0,1] op_sel_hi:[1,1,1]
    v_pk_mul_f32 v[208:209], v[36:37], v[36:37]
    v_pk_mul_f32 v[210:211], v[38:39], v[38:39]
    v_pk_mul_f32 v[212:213], v[40:41], v[40:41]
    v_pk_mul_f32 v[214:215], v[42:43], v[42:43]
    v_pk_fma_f32 v[208:209], v[208:209], s[22:23], s[22:23] op_sel:[0,0,1] op_sel_hi:[1,0,1]
    v_pk_fma_f32 v[210:211], v[210:211], s[22:23], s[22:23] op_sel:[0,0,1] op_sel_hi:[1,0,1]
    v_pk_fma_f32 v[212:213], v[212:213], s[22:23], s[22:23] op_sel:[0,0,1] op_sel_hi:[1,0,1]
    v_pk_fma_f32 v[214:215], v[214:215], s[22:23], s[22:23] op_sel:[0,0,1] op_sel_hi:[1,0,1]
    v_pk_mul_f32 v[208:209], v[208:209], v[36:37]
    v_pk_mul_f32 v[210:211], v[210:211], v[38:39]
    v_pk_mul_f32 v[212:213], v[212:213], v[40:41]
    v_pk_mul_f32 v[214:215], v[214:215], v[42:43]
    v_exp_f32 v208, v208
    v_exp_f32 v209, v209
    v_exp_f32 v210, v210
    v_exp_f32 v211, v211
    v_exp_f32 v212, v212
    v_exp_f32 v213, v213
    v_exp_f32 v214, v214
    v_exp_f32 v215, v215
    v_pk_add_f32 v[208:209], v[208:209], 1.0 op_sel_hi:[1,0]
    v_pk_add_f32 v[210:211], v[210:211], 1.0 op_sel_hi:[1,0]
    v_pk_add_f32 v[212:213], v[212:213], 1.0 op_sel_hi:[1,0]
    buffer_load_dwordx4 v11, s[72:75], s85 offen offset:3072 lds
    v_pk_add_f32 v[214:215], v[214:215], 1.0 op_sel_hi:[1,0]
    v_rcp_f32 v208, v208
    v_rcp_f32 v209, v209
    v_rcp_f32 v210, v210
    v_rcp_f32 v211, v211
    v_rcp_f32 v212, v212
    v_rcp_f32 v213, v213
    v_rcp_f32 v214, v214
    v_rcp_f32 v215, v215
    v_pk_mul_f32 v[36:37], v[36:37], v[208:209]
    v_pk_mul_f32 v[38:39], v[38:39], v[210:211]
    v_pk_mul_f32 v[40:41], v[40:41], v[212:213]
    v_pk_mul_f32 v[42:43], v[42:43], v[214:215]
    v_pk_add_f32 v[168:169], v[28:29], v[36:37]
    v_pk_fma_f32 v[176:177], v[36:37], v[36:37], v[176:177]
    v_pk_add_f32 v[170:171], v[30:31], v[38:39]
    v_pk_fma_f32 v[178:179], v[38:39], v[38:39], v[178:179]
    v_pk_add_f32 v[172:173], v[32:33], v[40:41]
    v_pk_fma_f32 v[180:181], v[40:41], v[40:41], v[180:181]
    v_pk_add_f32 v[174:175], v[34:35], v[42:43]
    v_pk_fma_f32 v[182:183], v[42:43], v[42:43], v[182:183]
    v_pk_fma_f32 v[44:45], v[156:157], v[200:201], v[44:45] op_sel_hi:[1,0,1] neg_lo:[1,0,0] neg_hi:[1,0,0]
    v_pk_fma_f32 v[46:47], v[158:159], v[200:201], v[46:47] op_sel_hi:[1,0,1] neg_lo:[1,0,0] neg_hi:[1,0,0]
    v_pk_fma_f32 v[48:49], v[160:161], v[200:201], v[48:49] op_sel_hi:[1,0,1] neg_lo:[1,0,0] neg_hi:[1,0,0]
    v_pk_fma_f32 v[50:51], v[162:163], v[200:201], v[50:51] op_sel_hi:[1,0,1] neg_lo:[1,0,0] neg_hi:[1,0,0]
    v_pk_fma_f32 v[44:45], v[44:45], v[148:149], v[200:201] op_sel:[0,0,1] op_sel_hi:[1,1,1]
    v_pk_fma_f32 v[46:47], v[46:47], v[150:151], v[200:201] op_sel:[0,0,1] op_sel_hi:[1,1,1]
    v_pk_fma_f32 v[48:49], v[48:49], v[152:153], v[200:201] op_sel:[0,0,1] op_sel_hi:[1,1,1]
    v_pk_fma_f32 v[50:51], v[50:51], v[154:155], v[200:201] op_sel:[0,0,1] op_sel_hi:[1,1,1]
    v_pk_mul_f32 v[208:209], v[44:45], v[44:45]
    v_pk_mul_f32 v[210:211], v[46:47], v[46:47]
    v_pk_mul_f32 v[212:213], v[48:49], v[48:49]
    v_pk_mul_f32 v[214:215], v[50:51], v[50:51]
    v_pk_fma_f32 v[208:209], v[208:209], s[22:23], s[22:23] op_sel:[0,0,1] op_sel_hi:[1,0,1]
    v_pk_fma_f32 v[210:211], v[210:211], s[22:23], s[22:23] op_sel:[0,0,1] op_sel_hi:[1,0,1]
    v_pk_fma_f32 v[212:213], v[212:213], s[22:23], s[22:23] op_sel:[0,0,1] op_sel_hi:[1,0,1]
    v_pk_fma_f32 v[214:215], v[214:215], s[22:23], s[22:23] op_sel:[0,0,1] op_sel_hi:[1,0,1]
    v_pk_mul_f32 v[208:209], v[208:209], v[44:45]
    v_pk_mul_f32 v[210:211], v[210:211], v[46:47]
    v_pk_mul_f32 v[212:213], v[212:213], v[48:49]
    v_pk_mul_f32 v[214:215], v[214:215], v[50:51]
    v_exp_f32 v208, v208
    v_exp_f32 v209, v209
    v_exp_f32 v210, v210
    v_exp_f32 v211, v211
    v_exp_f32 v212, v212
    v_exp_f32 v213, v213
    v_exp_f32 v214, v214
    v_exp_f32 v215, v215
    v_pk_add_f32 v[208:209], v[208:209], 1.0 op_sel_hi:[1,0]
    v_pk_add_f32 v[210:211], v[210:211], 1.0 op_sel_hi:[1,0]
    v_pk_add_f32 v[212:213], v[212:213], 1.0 op_sel_hi:[1,0]
    v_pk_add_f32 v[214:215], v[214:215], 1.0 op_sel_hi:[1,0]
    v_rcp_f32 v208, v208
    v_rcp_f32 v209, v209
    v_rcp_f32 v210, v210
    v_rcp_f32 v211, v211
    v_rcp_f32 v212, v212
    v_rcp_f32 v213, v213
    v_rcp_f32 v214, v214
    v_rcp_f32 v215, v215
    v_pk_mul_f32 v[44:45], v[44:45], v[208:209]
    v_pk_mul_f32 v[46:47], v[46:47], v[210:211]
    v_pk_mul_f32 v[48:49], v[48:49], v[212:213]
    v_pk_mul_f32 v[50:51], v[50:51], v[214:215]
    v_pk_add_f32 v[168:169], v[168:169], v[44:45]
    v_pk_fma_f32 v[176:177], v[44:45], v[44:45], v[176:177]
    v_pk_add_f32 v[170:171], v[170:171], v[46:47]
    v_pk_fma_f32 v[178:179], v[46:47], v[46:47], v[178:179]
    v_pk_add_f32 v[172:173], v[172:173], v[48:49]
    v_pk_fma_f32 v[180:181], v[48:49], v[48:49], v[180:181]
    v_pk_add_f32 v[174:175], v[174:175], v[50:51]
    v_pk_fma_f32 v[182:183], v[50:51], v[50:51], v[182:183]
    v_add_f32_dpp v208, v168, v168 row_ror:8 row_mask:0xf bank_mask:0x3
    v_add_f32_dpp v209, v169, v169 row_ror:8 row_mask:0xf bank_mask:0x3
    v_add_f32_dpp v210, v170, v170 row_ror:8 row_mask:0xf bank_mask:0x3
    v_add_f32_dpp v211, v171, v171 row_ror:8 row_mask:0xf bank_mask:0x3
    v_add_f32_dpp v212, v176, v176 row_ror:8 row_mask:0xf bank_mask:0x3
    v_add_f32_dpp v213, v177, v177 row_ror:8 row_mask:0xf bank_mask:0x3
    v_add_f32_dpp v214, v178, v178 row_ror:8 row_mask:0xf bank_mask:0x3
    v_add_f32_dpp v215, v179, v179 row_ror:8 row_mask:0xf bank_mask:0x3
    v_add_f32_dpp v208, v172, v172 row_ror:8 row_mask:0xf bank_mask:0xc
    v_add_f32_dpp v209, v173, v173 row_ror:8 row_mask:0xf bank_mask:0xc
    v_add_f32_dpp v210, v174, v174 row_ror:8 row_mask:0xf bank_mask:0xc
    v_add_f32_dpp v211, v175, v175 row_ror:8 row_mask:0xf bank_mask:0xc
    v_add_f32_dpp v212, v180, v180 row_ror:8 row_mask:0xf bank_mask:0xc
    v_add_f32_dpp v213, v181, v181 row_ror:8 row_mask:0xf bank_mask:0xc
    v_add_f32_dpp v214, v182, v182 row_ror:8 row_mask:0xf bank_mask:0xc
    v_add_f32_dpp v215, v183, v183 row_ror:8 row_mask:0xf bank_mask:0xc
    v_add_f32_dpp v216, v208, v208 row_shl:4 row_mask:0xf bank_mask:0x5
    v_add_f32_dpp v217, v209, v209 row_shl:4 row_mask:0xf bank_mask:0x5
    v_add_f32_dpp v218, v212, v212 row_shl:4 row_mask:0xf bank_mask:0x5
    v_add_f32_dpp v219, v213, v213 row_shl:4 row_mask:0xf bank_mask:0x5
    v_add_f32_dpp v216, v210, v210 row_shr:4 row_mask:0xf bank_mask:0xa
    v_add_f32_dpp v217, v211, v211 row_shr:4 row_mask:0xf bank_mask:0xa
    v_add_f32_dpp v218, v214, v214 row_shr:4 row_mask:0xf bank_mask:0xa
    v_add_f32_dpp v219, v215, v215 row_shr:4 row_mask:0xf bank_mask:0xa
    v_add_f32_dpp v216, v216, v216 quad_perm:[1,0,3,2] row_mask:0xf bank_mask:0xf
    v_add_f32_dpp v217, v217, v217 quad_perm:[1,0,3,2] row_mask:0xf bank_mask:0xf
    v_add_f32_dpp v218, v218, v218 quad_perm:[1,0,3,2] row_mask:0xf bank_mask:0xf
    v_add_f32_dpp v219, v219, v219 quad_perm:[1,0,3,2] row_mask:0xf bank_mask:0xf
    v_add_f32_dpp v216, v216, v216 quad_perm:[2,3,0,1] row_mask:0xf bank_mask:0xf
    v_add_f32_dpp v217, v217, v217 quad_perm:[2,3,0,1] row_mask:0xf bank_mask:0xf
    v_add_f32_dpp v218, v218, v218 quad_perm:[2,3,0,1] row_mask:0xf bank_mask:0xf
    v_add_f32_dpp v219, v219, v219 quad_perm:[2,3,0,1] row_mask:0xf bank_mask:0xf
    s_mov_b32 vcc_lo, 0xaaaaaaaa
    s_mov_b32 vcc_hi, 0xaaaaaaaa
    v_bfe_u32 v6, v2, 3, 1
    v_lshlrev_b32_e64 v6, 4, v6
    v_lshl_add_u32 v6, v3, 2, v6
    v_bfe_u32 v7, v2, 2, 1
    v_lshl_add_u32 v6, v7, 1, v6
    v_and_b32 v7, 1, v2
    v_add_u32_e64 v6, v6, v7
    s_lshl_b32 s57, s76, 8
    s_add_u32 s57, s57, 155136
    v_lshl_add_u32 v7, v6, 3, s57
    v_cndmask_b32 v220, v216, v217, vcc
    v_cndmask_b32 v221, v218, v219, vcc
    ds_write_b64 v7, v[220:221]
    s_waitcnt vmcnt(20)
    s_waitcnt lgkmcnt(0)
    s_barrier
    s_nop 0
    ds_read_b64_tr_b16 v[84:85], v224 offset:28768
    ds_read_b64_tr_b16 v[86:87], v224 offset:32352
    ds_read_b64_tr_b16 v[88:89], v224 offset:28800
    ds_read_b64_tr_b16 v[90:91], v224 offset:32384
    ds_read_b64_tr_b16 v[92:93], v224 offset:28832
    ds_read_b64_tr_b16 v[94:95], v224 offset:32416
    ds_read_b64_tr_b16 v[96:97], v224 offset:28864
    ds_read_b64_tr_b16 v[98:99], v224 offset:32448
    s_waitcnt lgkmcnt(6)
    v_mfma_f32_16x16x32_bf16 v[52:55], v[84:87], a[32:35], 0
    ds_read_b64_tr_b16 v[100:101], v224 offset:35936
    s_add_u32 m0, s18, 4096
    s_add_u32 s85, s64, s93
    buffer_load_dwordx4 v8, s[72:75], s85 offen offset:0 lds
    v_mfma_f32_16x16x32_bf16 v[56:59], v[84:87], a[36:39], 0
    ds_read_b64_tr_b16 v[102:103], v224 offset:39520
    s_waitcnt lgkmcnt(6)
    v_mfma_f32_16x16x32_bf16 v[60:63], v[88:91], a[32:35], 0
    ds_read_b64_tr_b16 v[104:105], v224 offset:35968
    v_mfma_f32_16x16x32_bf16 v[64:67], v[88:91], a[36:39], 0
    ds_read_b64_tr_b16 v[106:107], v224 offset:39552
    s_waitcnt lgkmcnt(6)
    v_mfma_f32_16x16x32_bf16 v[68:71], v[92:95], a[32:35], 0
    ds_read_b64_tr_b16 v[108:109], v224 offset:36000
    buffer_load_dwordx4 v9, s[72:75], s85 offen offset:1024 lds
    v_mfma_f32_16x16x32_bf16 v[72:75], v[92:95], a[36:39], 0
    ds_read_b64_tr_b16 v[110:111], v224 offset:39584
    buffer_load_dwordx4 v10, s[72:75], s85 offen offset:2048 lds
    s_waitcnt lgkmcnt(6)
    v_mfma_f32_16x16x32_bf16 v[76:79], v[96:99], a[32:35], 0
    ds_read_b64_tr_b16 v[112:113], v224 offset:36032
    v_mfma_f32_16x16x32_bf16 v[80:83], v[96:99], a[36:39], 0
    ds_read_b64_tr_b16 v[114:115], v224 offset:39616
    buffer_load_dwordx4 v11, s[72:75], s85 offen offset:3072 lds
    s_waitcnt lgkmcnt(6)
    v_mfma_f32_16x16x32_bf16 v[52:55], v[100:103], a[40:43], v[52:55]
    ds_read_b64_tr_b16 v[84:85], v224 offset:43104
    s_add_u32 m0, s18, 8192
    s_add_u32 s85, s65, s93
    buffer_load_dwordx4 v8, s[72:75], s85 offen offset:0 lds
    v_mfma_f32_16x16x32_bf16 v[56:59], v[100:103], a[44:47], v[56:59]
    ds_read_b64_tr_b16 v[86:87], v224 offset:46688
    s_waitcnt lgkmcnt(6)
    v_mfma_f32_16x16x32_bf16 v[60:63], v[104:107], a[40:43], v[60:63]
    ds_read_b64_tr_b16 v[88:89], v224 offset:43136
    v_mfma_f32_16x16x32_bf16 v[64:67], v[104:107], a[44:47], v[64:67]
    ds_read_b64_tr_b16 v[90:91], v224 offset:46720
    s_waitcnt lgkmcnt(6)
    v_mfma_f32_16x16x32_bf16 v[68:71], v[108:111], a[40:43], v[68:71]
    ds_read_b64_tr_b16 v[92:93], v224 offset:43168
    buffer_load_dwordx4 v9, s[72:75], s85 offen offset:1024 lds
    v_mfma_f32_16x16x32_bf16 v[72:75], v[108:111], a[44:47], v[72:75]
    ds_read_b64_tr_b16 v[94:95], v224 offset:46752
    buffer_load_dwordx4 v10, s[72:75], s85 offen offset:2048 lds
    s_waitcnt lgkmcnt(6)
    v_mfma_f32_16x16x32_bf16 v[76:79], v[112:115], a[40:43], v[76:79]
    ds_read_b64_tr_b16 v[96:97], v224 offset:43200
    v_mfma_f32_16x16x32_bf16 v[80:83], v[112:115], a[44:47], v[80:83]
    ds_read_b64_tr_b16 v[98:99], v224 offset:46784
    buffer_load_dwordx4 v11, s[72:75], s85 offen offset:3072 lds
    s_waitcnt lgkmcnt(6)
    v_mfma_f32_16x16x32_bf16 v[52:55], v[84:87], a[48:51], v[52:55]
    ds_read_b64_tr_b16 v[100:101], v224 offset:50272
    ds_read_b64_tr_b16 v[102:103], v224 offset:53856
    v_mfma_f32_16x16x32_bf16 v[56:59], v[84:87], a[52:55], v[56:59]
    ds_read_b64_tr_b16 v[104:105], v224 offset:50304
    ds_read_b64_tr_b16 v[106:107], v224 offset:53888
    s_waitcnt lgkmcnt(8)
    v_mfma_f32_16x16x32_bf16 v[60:63], v[88:91], a[48:51], v[60:63]
    ds_read_b64_tr_b16 v[108:109], v224 offset:50336
    ds_read_b64_tr_b16 v[110:111], v224 offset:53920
    v_mfma_f32_16x16x32_bf16 v[64:67], v[88:91], a[52:55], v[64:67]
    ds_read_b64_tr_b16 v[112:113], v224 offset:50368
    s_waitcnt lgkmcnt(9)
    v_mfma_f32_16x16x32_bf16 v[68:71], v[92:95], a[48:51], v[68:71]
    ds_read_b64_tr_b16 v[114:115], v224 offset:53952
    v_mfma_f32_16x16x32_bf16 v[72:75], v[92:95], a[52:55], v[72:75]
    s_waitcnt lgkmcnt(8)
    v_mfma_f32_16x16x32_bf16 v[76:79], v[96:99], a[48:51], v[76:79]
    v_mfma_f32_16x16x32_bf16 v[80:83], v[96:99], a[52:55], v[80:83]
    s_waitcnt vmcnt(21)
    s_waitcnt lgkmcnt(0)
    s_barrier
    v_mfma_f32_16x16x32_bf16 v[52:55], v[100:103], a[56:59], v[52:55]
    ds_read_b64_tr_b16 v[84:85], v225 offset:96
    s_add_u32 m0, s19, 28672
    s_nop 0
    buffer_load_dwordx4 v252, s[4:7], s17 offen offset:0 sc1 lds
    v_mfma_f32_16x16x32_bf16 v[56:59], v[100:103], a[60:63], v[56:59]
    ds_read_b64_tr_b16 v[86:87], v225 offset:3680
    v_mfma_f32_16x16x32_bf16 v[60:63], v[104:107], a[56:59], v[60:63]
    ds_read_b64_tr_b16 v[88:89], v225 offset:128
    v_mfma_f32_16x16x32_bf16 v[64:67], v[104:107], a[60:63], v[64:67]
    ds_read_b64_tr_b16 v[90:91], v225 offset:3712
    v_mfma_f32_16x16x32_bf16 v[68:71], v[108:111], a[56:59], v[68:71]
    ds_read_b64_tr_b16 v[92:93], v225 offset:160
    buffer_load_dwordx4 v252, s[4:7], s17 offen offset:1024 sc1 lds
    v_mfma_f32_16x16x32_bf16 v[72:75], v[108:111], a[60:63], v[72:75]
    ds_read_b64_tr_b16 v[94:95], v225 offset:3744
    buffer_load_dwordx4 v252, s[4:7], s17 offen offset:2048 sc1 lds
    v_mfma_f32_16x16x32_bf16 v[76:79], v[112:115], a[56:59], v[76:79]
    ds_read_b64_tr_b16 v[96:97], v225 offset:192
    v_mfma_f32_16x16x32_bf16 v[80:83], v[112:115], a[60:63], v[80:83]
    ds_read_b64_tr_b16 v[98:99], v225 offset:3776
    buffer_load_dwordx4 v252, s[4:7], s17 offen offset:3072 sc1 lds
    s_waitcnt lgkmcnt(6)
    v_mfma_f32_16x16x32_bf16 v[52:55], v[84:87], a[96:99], v[52:55]
    s_nop 0
    ds_read_b64_tr_b16 v[100:101], v225 offset:7264
    s_add_u32 m0, s19, 32768
    s_add_u32 s17, s17, 4096
    buffer_load_dwordx4 v252, s[4:7], s17 offen offset:0 sc1 lds
    v_mfma_f32_16x16x32_bf16 v[56:59], v[84:87], a[100:103], v[56:59]
    ds_read_b64_tr_b16 v[102:103], v225 offset:10848
    s_waitcnt lgkmcnt(6)
    v_mfma_f32_16x16x32_bf16 v[60:63], v[88:91], a[96:99], v[60:63]
    ds_read_b64_tr_b16 v[104:105], v225 offset:7296
    v_mfma_f32_16x16x32_bf16 v[64:67], v[88:91], a[100:103], v[64:67]
    ds_read_b64_tr_b16 v[106:107], v225 offset:10880
    s_waitcnt lgkmcnt(6)
    v_mfma_f32_16x16x32_bf16 v[68:71], v[92:95], a[96:99], v[68:71]
    ds_read_b64_tr_b16 v[108:109], v225 offset:7328
    buffer_load_dwordx4 v252, s[4:7], s17 offen offset:1024 sc1 lds
    v_mfma_f32_16x16x32_bf16 v[72:75], v[92:95], a[100:103], v[72:75]
    ds_read_b64_tr_b16 v[110:111], v225 offset:10912
    buffer_load_dwordx4 v252, s[4:7], s17 offen offset:2048 sc1 lds
    s_add_u32 s17, s17, 24576
    s_waitcnt lgkmcnt(6)
    v_mfma_f32_16x16x32_bf16 v[76:79], v[96:99], a[96:99], v[76:79]
    ds_read_b64_tr_b16 v[112:113], v225 offset:7360
    v_mfma_f32_16x16x32_bf16 v[80:83], v[96:99], a[100:103], v[80:83]
    ds_read_b64_tr_b16 v[114:115], v225 offset:10944
    s_add_u32 m0, s18, 12288
    s_add_u32 s85, s66, s93
    buffer_load_dwordx4 v8, s[72:75], s85 offen offset:0 lds
    s_waitcnt lgkmcnt(6)
    v_mfma_f32_16x16x32_bf16 v[52:55], v[100:103], a[104:107], v[52:55]
    ds_read_b64_tr_b16 v[84:85], v225 offset:14432
    buffer_load_dwordx4 v9, s[72:75], s85 offen offset:1024 lds
    v_mfma_f32_16x16x32_bf16 v[56:59], v[100:103], a[108:111], v[56:59]
    ds_read_b64_tr_b16 v[86:87], v225 offset:18016
    s_waitcnt lgkmcnt(6)
    v_mfma_f32_16x16x32_bf16 v[60:63], v[104:107], a[104:107], v[60:63]
    ds_read_b64_tr_b16 v[88:89], v225 offset:14464
    v_mfma_f32_16x16x32_bf16 v[64:67], v[104:107], a[108:111], v[64:67]
    ds_read_b64_tr_b16 v[90:91], v225 offset:18048
    s_waitcnt lgkmcnt(6)
    v_mfma_f32_16x16x32_bf16 v[68:71], v[108:111], a[104:107], v[68:71]
    ds_read_b64_tr_b16 v[92:93], v225 offset:14496
    buffer_load_dwordx4 v10, s[72:75], s85 offen offset:2048 lds
    v_mfma_f32_16x16x32_bf16 v[72:75], v[108:111], a[108:111], v[72:75]
    ds_read_b64_tr_b16 v[94:95], v225 offset:18080
    buffer_load_dwordx4 v11, s[72:75], s85 offen offset:3072 lds
    s_waitcnt lgkmcnt(6)
    v_mfma_f32_16x16x32_bf16 v[76:79], v[112:115], a[104:107], v[76:79]
    ds_read_b64_tr_b16 v[96:97], v225 offset:14528
    v_mfma_f32_16x16x32_bf16 v[80:83], v[112:115], a[108:111], v[80:83]
    ds_read_b64_tr_b16 v[98:99], v225 offset:18112
    v_and_b32 v6, 31, v1
    v_lshlrev_b32_e64 v6, 4, v6
    s_waitcnt lgkmcnt(6)
    v_mfma_f32_16x16x32_bf16 v[52:55], v[84:87], a[112:115], v[52:55]
    ds_read_b64_tr_b16 v[100:101], v225 offset:21600
    ds_read_b64_tr_b16 v[102:103], v225 offset:25184
    v_mfma_f32_16x16x32_bf16 v[56:59], v[84:87], a[116:119], v[56:59]
    ds_read_b64_tr_b16 v[104:105], v225 offset:21632
    ds_read_b64_tr_b16 v[106:107], v225 offset:25216
    s_waitcnt lgkmcnt(8)
    v_mfma_f32_16x16x32_bf16 v[60:63], v[88:91], a[112:115], v[60:63]
    ds_read_b64_tr_b16 v[108:109], v225 offset:21664
    ds_read_b64_tr_b16 v[110:111], v225 offset:25248
    v_mfma_f32_16x16x32_bf16 v[64:67], v[88:91], a[116:119], v[64:67]
    ds_read_b64_tr_b16 v[112:113], v225 offset:21696
    s_waitcnt lgkmcnt(9)
    v_mfma_f32_16x16x32_bf16 v[68:71], v[92:95], a[112:115], v[68:71]
    ds_read_b64_tr_b16 v[114:115], v225 offset:25280
    v_lshrrev_b32_e64 v7, 5, v1
    v_lshl_add_u32 v6, v7, 10, v6
    v_mfma_f32_16x16x32_bf16 v[72:75], v[92:95], a[116:119], v[72:75]
    s_waitcnt lgkmcnt(8)
    v_mfma_f32_16x16x32_bf16 v[76:79], v[96:99], a[112:115], v[76:79]
    s_lshl_b32 s25, s53, 13
    s_lshl_b32 s28, s76, 9
    s_add_u32 s25, s25, s28
    v_mfma_f32_16x16x32_bf16 v[80:83], v[96:99], a[116:119], v[80:83]
    s_add_u32 s25, s25, 458752
    s_add_u32 s28, s25, 4096
    s_waitcnt vmcnt(25)
    s_waitcnt lgkmcnt(0)
    s_barrier
    v_mfma_f32_16x16x32_bf16 v[52:55], v[100:103], a[120:123], v[52:55]
    ds_read_b64_tr_b16 v[84:85], v224 offset:96
    v_mfma_f32_16x16x32_bf16 v[56:59], v[100:103], a[124:127], v[56:59]
    ds_read_b64_tr_b16 v[86:87], v224 offset:3680
    v_mfma_f32_16x16x32_bf16 v[60:63], v[104:107], a[120:123], v[60:63]
    ds_read_b64_tr_b16 v[88:89], v224 offset:128
    v_mfma_f32_16x16x32_bf16 v[64:67], v[104:107], a[124:127], v[64:67]
    ds_read_b64_tr_b16 v[90:91], v224 offset:3712
    v_mfma_f32_16x16x32_bf16 v[68:71], v[108:111], a[120:123], v[68:71]
    ds_read_b64_tr_b16 v[92:93], v224 offset:160
    v_mfma_f32_16x16x32_bf16 v[72:75], v[108:111], a[124:127], v[72:75]
    ds_read_b64_tr_b16 v[94:95], v224 offset:3744
    v_mfma_f32_16x16x32_bf16 v[76:79], v[112:115], a[120:123], v[76:79]
    ds_read_b64_tr_b16 v[96:97], v224 offset:192
    v_mfma_f32_16x16x32_bf16 v[80:83], v[112:115], a[124:127], v[80:83]
    ds_read_b64_tr_b16 v[98:99], v224 offset:3776
    s_waitcnt lgkmcnt(6)
    v_mfma_f32_16x16x32_bf16 v[52:55], v[84:87], a[160:163], v[52:55]
    ds_read_b64_tr_b16 v[100:101], v224 offset:7264
    v_mfma_f32_16x16x32_bf16 v[56:59], v[84:87], a[164:167], v[56:59]
    ds_read_b64_tr_b16 v[102:103], v224 offset:10848
    s_waitcnt lgkmcnt(6)
    v_mfma_f32_16x16x32_bf16 v[60:63], v[88:91], a[160:163], v[60:63]
    ds_read_b64_tr_b16 v[104:105], v224 offset:7296
    v_mfma_f32_16x16x32_bf16 v[64:67], v[88:91], a[164:167], v[64:67]
    ds_read_b64_tr_b16 v[106:107], v224 offset:10880
    s_waitcnt lgkmcnt(6)
    v_mfma_f32_16x16x32_bf16 v[68:71], v[92:95], a[160:163], v[68:71]
    ds_read_b64_tr_b16 v[108:109], v224 offset:7328
    v_mfma_f32_16x16x32_bf16 v[72:75], v[92:95], a[164:167], v[72:75]
    ds_read_b64_tr_b16 v[110:111], v224 offset:10912
    s_waitcnt lgkmcnt(6)
    v_mfma_f32_16x16x32_bf16 v[76:79], v[96:99], a[160:163], v[76:79]
    ds_read_b64_tr_b16 v[112:113], v224 offset:7360
    v_mfma_f32_16x16x32_bf16 v[80:83], v[96:99], a[164:167], v[80:83]
    ds_read_b64_tr_b16 v[114:115], v224 offset:10944
    s_waitcnt lgkmcnt(6)
    v_mfma_f32_16x16x32_bf16 v[52:55], v[100:103], a[168:171], v[52:55]
    ds_read_b64_tr_b16 v[84:85], v224 offset:14432
    v_mfma_f32_16x16x32_bf16 v[56:59], v[100:103], a[172:175], v[56:59]
    ds_read_b64_tr_b16 v[86:87], v224 offset:18016
    s_waitcnt lgkmcnt(6)
    v_mfma_f32_16x16x32_bf16 v[60:63], v[104:107], a[168:171], v[60:63]
    ds_read_b64_tr_b16 v[88:89], v224 offset:14464
    v_mfma_f32_16x16x32_bf16 v[64:67], v[104:107], a[172:175], v[64:67]
    ds_read_b64_tr_b16 v[90:91], v224 offset:18048
    s_waitcnt lgkmcnt(6)
    v_mfma_f32_16x16x32_bf16 v[68:71], v[108:111], a[168:171], v[68:71]
    ds_read_b64_tr_b16 v[92:93], v224 offset:14496
    v_mfma_f32_16x16x32_bf16 v[72:75], v[108:111], a[172:175], v[72:75]
    ds_read_b64_tr_b16 v[94:95], v224 offset:18080
    s_waitcnt lgkmcnt(6)
    v_mfma_f32_16x16x32_bf16 v[76:79], v[112:115], a[168:171], v[76:79]
    ds_read_b64_tr_b16 v[96:97], v224 offset:14528
    v_mfma_f32_16x16x32_bf16 v[80:83], v[112:115], a[172:175], v[80:83]
    ds_read_b64_tr_b16 v[98:99], v224 offset:18112
    s_waitcnt lgkmcnt(6)
    v_mfma_f32_16x16x32_bf16 v[52:55], v[84:87], a[176:179], v[52:55]
    ds_read_b64_tr_b16 v[100:101], v224 offset:21600
    ds_read_b64_tr_b16 v[102:103], v224 offset:25184
    v_mfma_f32_16x16x32_bf16 v[56:59], v[84:87], a[180:183], v[56:59]
    ds_read_b64_tr_b16 v[104:105], v224 offset:21632
    ds_read_b64_tr_b16 v[106:107], v224 offset:25216
    s_waitcnt lgkmcnt(8)
    v_mfma_f32_16x16x32_bf16 v[60:63], v[88:91], a[176:179], v[60:63]
    ds_read_b64_tr_b16 v[108:109], v224 offset:21664
    ds_read_b64_tr_b16 v[110:111], v224 offset:25248
    v_mfma_f32_16x16x32_bf16 v[64:67], v[88:91], a[180:183], v[64:67]
    ds_read_b64_tr_b16 v[112:113], v224 offset:21696
    s_waitcnt lgkmcnt(9)
    v_mfma_f32_16x16x32_bf16 v[68:71], v[92:95], a[176:179], v[68:71]
    ds_read_b64_tr_b16 v[114:115], v224 offset:25280
    buffer_load_dwordx4 v[168:171], v6, s[4:7], s25 offen offset:0 sc1
    v_mfma_f32_16x16x32_bf16 v[72:75], v[92:95], a[180:183], v[72:75]
    buffer_load_dwordx4 v[172:175], v6, s[4:7], s25 offen offset:2048 sc1
    s_waitcnt lgkmcnt(8)
    v_mfma_f32_16x16x32_bf16 v[76:79], v[96:99], a[176:179], v[76:79]
    buffer_load_dwordx4 v[176:179], v6, s[4:7], s28 offen offset:0 sc1
    v_mfma_f32_16x16x32_bf16 v[80:83], v[96:99], a[180:183], v[80:83]
    buffer_load_dwordx4 v[180:183], v6, s[4:7], s28 offen offset:2048 sc1
    s_waitcnt vmcnt(8)
    s_waitcnt lgkmcnt(0)
    s_barrier
    v_mfma_f32_16x16x32_bf16 v[52:55], v[100:103], a[184:187], v[52:55]
    ds_read_b64_tr_b16 v[84:85], v224 offset:28768
    v_mfma_f32_16x16x32_bf16 v[56:59], v[100:103], a[188:191], v[56:59]
    ds_read_b64_tr_b16 v[86:87], v224 offset:32352
    v_mfma_f32_16x16x32_bf16 v[60:63], v[104:107], a[184:187], v[60:63]
    ds_read_b64_tr_b16 v[88:89], v224 offset:28800
    v_mfma_f32_16x16x32_bf16 v[64:67], v[104:107], a[188:191], v[64:67]
    ds_read_b64_tr_b16 v[90:91], v224 offset:32384
    v_mfma_f32_16x16x32_bf16 v[68:71], v[108:111], a[184:187], v[68:71]
    ds_read_b64_tr_b16 v[92:93], v224 offset:28832
    v_mfma_f32_16x16x32_bf16 v[72:75], v[108:111], a[188:191], v[72:75]
    ds_read_b64_tr_b16 v[94:95], v224 offset:32416
    v_mfma_f32_16x16x32_bf16 v[76:79], v[112:115], a[184:187], v[76:79]
    ds_read_b64_tr_b16 v[96:97], v224 offset:28864
    v_mfma_f32_16x16x32_bf16 v[80:83], v[112:115], a[188:191], v[80:83]
    ds_read_b64_tr_b16 v[98:99], v224 offset:32448
    s_waitcnt vmcnt(3)
    v_xor_b32 v170, s56, v170
    s_waitcnt vmcnt(2)
    v_xor_b32 v174, s56, v174
    s_waitcnt vmcnt(1)
    v_xor_b32 v178, s56, v178
    s_waitcnt vmcnt(0)
    v_xor_b32 v182, s56, v182
    v_or3_b32 v170, v170, v174, v178
    v_or_b32 v170, v170, v182
    v_cmp_ne_u32 vcc, 0, v170
    s_mov_b32 s59, 0
    s_cbranch_vccz adaLN_cond__ssm_conv_s4d__mixer_gmlp__prompt_kernel_s2d20
adaLN_cond__ssm_conv_s4d__mixer_gmlp__prompt_kernel_s219:
    buffer_load_dwordx4 v[168:171], v6, s[4:7], s25 offen offset:0 sc1
    buffer_load_dwordx4 v[172:175], v6, s[4:7], s25 offen offset:2048 sc1
    buffer_load_dwordx4 v[176:179], v6, s[4:7], s28 offen offset:0 sc1
    buffer_load_dwordx4 v[180:183], v6, s[4:7], s28 offen offset:2048 sc1
    s_add_u32 s59, s59, 1
    s_waitcnt vmcnt(3)
    v_xor_b32 v170, s56, v170
    s_waitcnt vmcnt(2)
    v_xor_b32 v174, s56, v174
    s_waitcnt vmcnt(1)
    v_xor_b32 v178, s56, v178
    s_waitcnt vmcnt(0)
    v_xor_b32_e64 v182, s56, v182
    v_or3_b32 v170, v170, v174, v178
    v_or_b32 v170, v170, v182
    v_cmp_ne_u32 vcc, 0, v170
    s_nop 0
    s_cbranch_vccz adaLN_cond__ssm_conv_s4d__mixer_gmlp__prompt_kernel_s2d20
    s_cmp_lt_u32 s59, 524288
    s_cbranch_scc1 adaLN_cond__ssm_conv_s4d__mixer_gmlp__prompt_kernel_s219
adaLN_cond__ssm_conv_s4d__mixer_gmlp__prompt_kernel_s2d20:
    v_pk_add_f32 v[168:169], v[168:169], v[172:173]
    v_pk_add_f32 v[176:177], v[176:177], v[180:181]
    s_lshl_b32 s57, s52, 8
    s_add_u32 s57, s57, 155648
    v_and_b32_e64 v6, 31, v1
    v_pk_add_f32 v[168:169], v[168:169], v[176:177]
    v_lshl_add_u32 v6, v6, 2, s57
    v_mov_b32 v170, v168
    v_mov_b32 v171, v169
    v_lshl_add_u32 v7, v3, 4, s57
    v_permlane32_swap_b32 v168, v170
    v_permlane32_swap_b32 v169, v171
    v_pk_add_f32 v[168:169], v[168:169], v[170:171]
    v_mul_f32 v168, 0x3a924925, v168
    v_mul_f32 v169, 0x3a924925, v169
    v_fma_f32 v169, -v168, v168, v169
    v_max_f32_e64 v169, 0, v169
    v_cvt_pk_bf16_f32 v168, v168, v168
    v_and_b32 v168, 0xffff0000, v168
    v_cvt_pk_bf16_f32 v169, v169, v169
    v_and_b32 v169, 0xffff0000, v169
    v_add_f32 v169, 0x3727c5ac, v169
    v_cvt_pk_bf16_f32 v169, v169, v169
    v_and_b32 v169, 0xffff0000, v169
    v_sqrt_f32 v169, v169
    s_nop 0
    v_cvt_pk_bf16_f32 v169, v169, v169
    v_and_b32 v169, 0xffff0000, v169
    v_rcp_f32 v169, v169
    s_nop 0
    v_mul_f32_e64 v168, -v168, v169
    ds_write2_b32 v6, v169, v168 offset0:0 offset1:32
    ds_read_b128 v[148:151], v7 offset:0
    ds_read_b128 v[156:159], v7 offset:128
    ds_read_b128 v[152:155], v7 offset:64
    ds_read_b128 v[160:163], v7 offset:192
    s_mul_i32 s25, s54, 458752
    s_lshl_b32 s57, s53, 1
    s_add_u32 s57, s57, s76
    s_lshl_b32 s57, s57, 10
    s_add_u32 s24, s57, s25
    s_add_u32 s57, s57, s24
    s_add_u32 s57, s57, 9699328
    s_add_u32 s24, s24, 9830400
    s_waitcnt lgkmcnt(2)
    v_pk_fma_f32 v[28:29], v[28:29], v[148:149], v[156:157]
    v_pk_fma_f32 v[30:31], v[30:31], v[150:151], v[158:159]
    s_waitcnt lgkmcnt(0)
    s_nop 0
    v_pk_fma_f32 v[32:33], v[32:33], v[152:153], v[160:161]
    v_pk_fma_f32 v[34:35], v[34:35], v[154:155], v[162:163]
    v_cvt_pk_bf16_f32 v28, v28, v29
    v_cvt_pk_bf16_f32 v29, v30, v31
    v_cvt_pk_bf16_f32 v30, v32, v33
    v_cvt_pk_bf16_f32 v31, v34, v35
    buffer_store_dwordx4 v[28:31], v252, s[4:7], s57 offen offset:0 sc1
    v_pk_fma_f32 v[36:37], v[36:37], v[148:149], v[156:157]
    v_pk_fma_f32 v[38:39], v[38:39], v[150:151], v[158:159]
    v_pk_fma_f32 v[40:41], v[40:41], v[152:153], v[160:161]
    v_pk_fma_f32 v[42:43], v[42:43], v[154:155], v[162:163]
    v_cvt_pk_bf16_f32 v36, v36, v37
    v_cvt_pk_bf16_f32 v37, v38, v39
    v_cvt_pk_bf16_f32 v38, v40, v41
    v_cvt_pk_bf16_f32 v39, v42, v43
    buffer_store_dwordx4 v[36:39], v252, s[4:7], s57 offen offset:1024 sc1
    v_pk_fma_f32 v[44:45], v[44:45], v[148:149], v[156:157]
    v_pk_fma_f32 v[46:47], v[46:47], v[150:151], v[158:159]
    v_pk_fma_f32 v[48:49], v[48:49], v[152:153], v[160:161]
    v_pk_fma_f32 v[50:51], v[50:51], v[154:155], v[162:163]
    v_cvt_pk_bf16_f32 v44, v44, v45
    v_cvt_pk_bf16_f32 v45, v46, v47
    v_cvt_pk_bf16_f32 v46, v48, v49
    v_cvt_pk_bf16_f32 v47, v50, v51
    buffer_store_dwordx4 v[44:47], v252, s[4:7], s24 offen offset:0 sc1
    v_mfma_f32_16x16x32_bf16 v[52:55], v[84:87], a[224:227], v[52:55]
    ds_read_b64_tr_b16 v[100:101], v224 offset:35936
    s_add_u32 m0, s19, 57344
    s_add_u32 s58, s26, 458752
    buffer_load_dwordx4 v18, s[8:11], s58 offen offset:0 lds
    v_mfma_f32_16x16x32_bf16 v[56:59], v[84:87], a[228:231], v[56:59]
    ds_read_b64_tr_b16 v[102:103], v224 offset:39520
    v_mfma_f32_16x16x32_bf16 v[60:63], v[88:91], a[224:227], v[60:63]
    ds_read_b64_tr_b16 v[104:105], v224 offset:35968
    v_mfma_f32_16x16x32_bf16 v[64:67], v[88:91], a[228:231], v[64:67]
    ds_read_b64_tr_b16 v[106:107], v224 offset:39552
    v_mfma_f32_16x16x32_bf16 v[68:71], v[92:95], a[224:227], v[68:71]
    ds_read_b64_tr_b16 v[108:109], v224 offset:36000
    s_add_u32 s58, s26, 465920
    buffer_load_dwordx4 v18, s[8:11], s58 offen offset:1024 lds
    v_mfma_f32_16x16x32_bf16 v[72:75], v[92:95], a[228:231], v[72:75]
    ds_read_b64_tr_b16 v[110:111], v224 offset:39584
    s_add_u32 s58, s26, 473088
    buffer_load_dwordx4 v18, s[8:11], s58 offen offset:2048 lds
    v_mfma_f32_16x16x32_bf16 v[76:79], v[96:99], a[224:227], v[76:79]
    ds_read_b64_tr_b16 v[112:113], v224 offset:36032
    v_mfma_f32_16x16x32_bf16 v[80:83], v[96:99], a[228:231], v[80:83]
    ds_read_b64_tr_b16 v[114:115], v224 offset:39616
    s_add_u32 s58, s26, 480256
    buffer_load_dwordx4 v18, s[8:11], s58 offen offset:3072 lds
    s_waitcnt lgkmcnt(6)
    v_mfma_f32_16x16x32_bf16 v[52:55], v[100:103], a[232:235], v[52:55]
    s_nop 0
    ds_read_b64_tr_b16 v[84:85], v224 offset:43104
    s_add_u32 m0, s19, 61440
    s_add_u32 s58, s26, 491520
    buffer_load_dwordx4 v18, s[8:11], s58 offen offset:0 lds
    v_mfma_f32_16x16x32_bf16 v[56:59], v[100:103], a[236:239], v[56:59]
    ds_read_b64_tr_b16 v[86:87], v224 offset:46688
    s_waitcnt lgkmcnt(6)
    v_mfma_f32_16x16x32_bf16 v[60:63], v[104:107], a[232:235], v[60:63]
    ds_read_b64_tr_b16 v[88:89], v224 offset:43136
    v_mfma_f32_16x16x32_bf16 v[64:67], v[104:107], a[236:239], v[64:67]
    ds_read_b64_tr_b16 v[90:91], v224 offset:46720
    s_waitcnt lgkmcnt(6)
    v_mfma_f32_16x16x32_bf16 v[68:71], v[108:111], a[232:235], v[68:71]
    ds_read_b64_tr_b16 v[92:93], v224 offset:43168
    s_add_u32 s58, s26, 498688
    buffer_load_dwordx4 v18, s[8:11], s58 offen offset:1024 lds
    v_mfma_f32_16x16x32_bf16 v[72:75], v[108:111], a[236:239], v[72:75]
    ds_read_b64_tr_b16 v[94:95], v224 offset:46752
    s_add_u32 s58, s26, 505856
    buffer_load_dwordx4 v18, s[8:11], s58 offen offset:2048 lds
    s_waitcnt lgkmcnt(6)
    v_mfma_f32_16x16x32_bf16 v[76:79], v[112:115], a[232:235], v[76:79]
    ds_read_b64_tr_b16 v[96:97], v224 offset:43200
    v_mfma_f32_16x16x32_bf16 v[80:83], v[112:115], a[236:239], v[80:83]
    ds_read_b64_tr_b16 v[98:99], v224 offset:46784
    s_add_u32 m0, s19, 0
    s_add_u32 s58, s26, 0
    buffer_load_dwordx4 v18, s[8:11], s58 offen offset:0 lds
    s_waitcnt lgkmcnt(6)
    v_mfma_f32_16x16x32_bf16 v[52:55], v[84:87], a[240:243], v[52:55]
    ds_read_b64_tr_b16 v[100:101], v224 offset:50272
    s_add_u32 s58, s26, 7168
    buffer_load_dwordx4 v18, s[8:11], s58 offen offset:1024 lds
    v_mfma_f32_16x16x32_bf16 v[56:59], v[84:87], a[244:247], v[56:59]
    ds_read_b64_tr_b16 v[102:103], v224 offset:53856
    s_waitcnt lgkmcnt(6)
    v_mfma_f32_16x16x32_bf16 v[60:63], v[88:91], a[240:243], v[60:63]
    ds_read_b64_tr_b16 v[104:105], v224 offset:50304
    v_mfma_f32_16x16x32_bf16 v[64:67], v[88:91], a[244:247], v[64:67]
    ds_read_b64_tr_b16 v[106:107], v224 offset:53888
    s_waitcnt lgkmcnt(6)
    v_mfma_f32_16x16x32_bf16 v[68:71], v[92:95], a[240:243], v[68:71]
    ds_read_b64_tr_b16 v[108:109], v224 offset:50336
    s_add_u32 s58, s26, 14336
    buffer_load_dwordx4 v18, s[8:11], s58 offen offset:2048 lds
    v_mfma_f32_16x16x32_bf16 v[72:75], v[92:95], a[244:247], v[72:75]
    ds_read_b64_tr_b16 v[110:111], v224 offset:53920
    s_add_u32 s58, s26, 21504
    buffer_load_dwordx4 v18, s[8:11], s58 offen offset:3072 lds
    s_waitcnt lgkmcnt(6)
    v_mfma_f32_16x16x32_bf16 v[76:79], v[96:99], a[240:243], v[76:79]
    ds_read_b64_tr_b16 v[112:113], v224 offset:50368
    v_mfma_f32_16x16x32_bf16 v[80:83], v[96:99], a[244:247], v[80:83]
    s_nop 0
    ds_read_b64_tr_b16 v[114:115], v224 offset:53952
    s_add_u32 m0, s19, 4096
    s_add_u32 s58, s26, 32768
    buffer_load_dwordx4 v18, s[8:11], s58 offen offset:0 lds
    s_waitcnt lgkmcnt(6)
    v_mfma_f32_16x16x32_bf16 v[52:55], v[100:103], a[248:251], v[52:55]
    v_mfma_f32_16x16x32_bf16 v[56:59], v[100:103], a[252:255], v[56:59]
    s_waitcnt lgkmcnt(4)
    v_mfma_f32_16x16x32_bf16 v[60:63], v[104:107], a[248:251], v[60:63]
    v_mfma_f32_16x16x32_bf16 v[64:67], v[104:107], a[252:255], v[64:67]
    s_waitcnt lgkmcnt(2)
    v_mfma_f32_16x16x32_bf16 v[68:71], v[108:111], a[248:251], v[68:71]
    v_mfma_f32_16x16x32_bf16 v[72:75], v[108:111], a[252:255], v[72:75]
    s_waitcnt lgkmcnt(0)
    v_mfma_f32_16x16x32_bf16 v[76:79], v[112:115], a[248:251], v[76:79]
    s_add_u32 s58, s26, 39936
    buffer_load_dwordx4 v18, s[8:11], s58 offen offset:1024 lds
    v_mfma_f32_16x16x32_bf16 v[80:83], v[112:115], a[252:255], v[80:83]
    s_add_u32 s58, s26, 47104
    buffer_load_dwordx4 v18, s[8:11], s58 offen offset:2048 lds
    s_mul_i32 s80, s52, 6144
    s_add_u32 s80, s80, 114688
    s_add_u32 s82, s19, 86016
    v_lshlrev_b32_e64 v5, 4, v3
    v_add_u32 v5, 158720, v5
    ds_read_b128 v[116:119], v5 offset:192
    ds_read_b128 v[120:123], v5 offset:1216
    ds_read_b128 v[124:127], v5 offset:256
    ds_read_b128 v[128:131], v5 offset:1280
    ds_read_b128 v[132:135], v5 offset:320
    ds_read_b128 v[136:139], v5 offset:1344
    ds_read_b128 v[140:143], v5 offset:384
    ds_read_b128 v[144:147], v5 offset:1408
    s_sub_u32 s88, 0, s54
    s_and_b32 s88, s88, 3
    s_lshl_b32 s88, s88, 12
    s_add_u32 s88, s88, s18
    v_add_u32 v14, s88, v12
    v_add_u32 v15, s88, v13
    ds_read_b128 a[32:35], v14 offset:0
    ds_read_b128 a[36:39], v15 offset:0
    ds_read_b128 a[40:43], v14 offset:2048
    ds_read_b128 a[44:47], v15 offset:2048
    s_sub_u32 s88, 1, s54
    s_and_b32 s88, s88, 3
    s_lshl_b32 s88, s88, 12
    s_add_u32 s88, s88, s18
    v_add_u32 v14, s88, v12
    v_add_u32 v15, s88, v13
    ds_read_b128 a[96:99], v14 offset:0
    ds_read_b128 a[100:103], v15 offset:0
    ds_read_b128 a[104:107], v14 offset:2048
    ds_read_b128 a[108:111], v15 offset:2048
    s_sub_u32 s88, 2, s54
    s_and_b32 s88, s88, 3
    s_lshl_b32 s88, s88, 12
    s_add_u32 s88, s88, s18
    v_add_u32 v14, s88, v12
    v_add_u32 v15, s88, v13
    ds_read_b128 a[160:163], v14 offset:0
    ds_read_b128 a[164:167], v15 offset:0
    ds_read_b128 a[168:171], v14 offset:2048
    ds_read_b128 a[172:175], v15 offset:2048
    s_sub_u32 s88, 3, s54
    s_and_b32 s88, s88, 3
    s_lshl_b32 s88, s88, 12
    s_add_u32 s88, s88, s18
    v_add_u32 v14, s88, v12
    v_add_u32 v15, s88, v13
    ds_read_b128 a[224:227], v14 offset:0
    ds_read_b128 a[228:231], v15 offset:0
    ds_read_b128 a[232:235], v14 offset:2048
    ds_read_b128 a[236:239], v15 offset:2048
    s_waitcnt lgkmcnt(15)
    s_nop 0
    v_pk_fma_f32 v[52:53], v[116:117], v[164:165], v[52:53] op_sel:[0,1,0] op_sel_hi:[1,1,1] neg_lo:[1,0,0] neg_hi:[1,0,0]
    v_pk_fma_f32 v[54:55], v[118:119], v[164:165], v[54:55] op_sel:[0,1,0] op_sel_hi:[1,1,1] neg_lo:[1,0,0] neg_hi:[1,0,0]
    v_pk_fma_f32 v[56:57], v[116:117], v[166:167], v[56:57] op_sel:[0,1,0] op_sel_hi:[1,1,1] neg_lo:[1,0,0] neg_hi:[1,0,0]
    v_pk_fma_f32 v[58:59], v[118:119], v[166:167], v[58:59] op_sel:[0,1,0] op_sel_hi:[1,1,1] neg_lo:[1,0,0] neg_hi:[1,0,0]
    v_pk_fma_f32 v[52:53], v[52:53], v[164:165], v[120:121] op_sel_hi:[1,0,1]
    v_pk_fma_f32 v[54:55], v[54:55], v[164:165], v[122:123] op_sel_hi:[1,0,1]
    v_pk_fma_f32 v[56:57], v[56:57], v[166:167], v[120:121] op_sel_hi:[1,0,1]
    v_pk_fma_f32 v[58:59], v[58:59], v[166:167], v[122:123] op_sel_hi:[1,0,1]
    v_pk_mul_f32 v[208:209], v[52:53], v[52:53]
    v_pk_mul_f32 v[210:211], v[54:55], v[54:55]
    v_pk_mul_f32 v[212:213], v[56:57], v[56:57]
    v_pk_mul_f32 v[214:215], v[58:59], v[58:59]
    v_pk_fma_f32 v[208:209], v[208:209], s[22:23], s[22:23] op_sel:[0,0,1] op_sel_hi:[1,0,1]
    v_pk_fma_f32 v[210:211], v[210:211], s[22:23], s[22:23] op_sel:[0,0,1] op_sel_hi:[1,0,1]
    v_pk_fma_f32 v[212:213], v[212:213], s[22:23], s[22:23] op_sel:[0,0,1] op_sel_hi:[1,0,1]
    v_pk_fma_f32 v[214:215], v[214:215], s[22:23], s[22:23] op_sel:[0,0,1] op_sel_hi:[1,0,1]
    v_pk_mul_f32 v[208:209], v[208:209], v[52:53]
    v_pk_mul_f32 v[210:211], v[210:211], v[54:55]
    v_pk_mul_f32 v[212:213], v[212:213], v[56:57]
    v_pk_mul_f32 v[214:215], v[214:215], v[58:59]
    v_exp_f32 v208, v208
    v_exp_f32 v209, v209
    v_exp_f32 v210, v210
    v_exp_f32 v211, v211
    v_exp_f32 v212, v212
    v_exp_f32 v213, v213
    v_exp_f32 v214, v214
    v_exp_f32 v215, v215
    v_pk_add_f32 v[208:209], v[208:209], 1.0 op_sel_hi:[1,0]
    v_pk_add_f32 v[210:211], v[210:211], 1.0 op_sel_hi:[1,0]
    v_pk_add_f32 v[212:213], v[212:213], 1.0 op_sel_hi:[1,0]
    v_pk_add_f32 v[214:215], v[214:215], 1.0 op_sel_hi:[1,0]
    v_rcp_f32 v208, v208
    v_rcp_f32 v209, v209
    v_rcp_f32 v210, v210
    v_rcp_f32 v211, v211
    v_rcp_f32 v212, v212
    v_rcp_f32 v213, v213
    v_rcp_f32 v214, v214
    v_rcp_f32 v215, v215
    v_pk_mul_f32 v[52:53], v[52:53], v[208:209]
    v_pk_mul_f32 v[54:55], v[54:55], v[210:211]
    v_pk_mul_f32 v[56:57], v[56:57], v[212:213]
    v_pk_mul_f32 v[58:59], v[58:59], v[214:215]
    v_cvt_pk_bf16_f32 v52, v52, v53
    v_cvt_pk_bf16_f32 v53, v54, v55
    v_cvt_pk_bf16_f32 v56, v56, v57
    v_cvt_pk_bf16_f32 v57, v58, v59
    s_lshl_b32 s57, s54, 12
    s_lshl_b32 s58, s53, 5
    s_add_u32 s57, s57, s58
    v_lshl_add_u32 v4, v1, 10, s57
    s_waitcnt vmcnt(14)
    s_waitcnt lgkmcnt(0)
    s_barrier
    s_cmp_lg_u32 s52, 0
    s_cbranch_scc1 adaLN_cond__ssm_conv_s4d__mixer_gmlp__prompt_kernel_pub21
    v_mov_b32_e64 v5, s56
    s_mov_b32 s60, 327680
    s_mov_b64 exec, 0xf
    buffer_store_dword v5, v4, s[4:7], s60 offen sc1
    s_mov_b64 exec, -1
adaLN_cond__ssm_conv_s4d__mixer_gmlp__prompt_kernel_pub21:
    s_add_u32 s83, s69, 118784
    s_lshl_b32 s92, s52, 13
    s_add_u32 s92, s92, 86016
    s_add_u32 s88, s19, 28672
    s_add_u32 s89, s92, 0
    s_add_u32 s90, s92, 4096
    s_add_u32 s91, s83, 0
    s_bitcmp1_b32 s54, 0
    s_cselect_b32 s85, s88, s91
    s_cselect_b32 s88, s89, s88
    s_cselect_b32 s89, s90, s89
    s_cselect_b32 s90, s91, s90
    s_mov_b32 s91, s85
    s_bitcmp1_b32 s54, 1
    s_cselect_b32 s85, s88, s90
    s_cselect_b32 s88, s90, s88
    s_mov_b32 s90, s85
    s_cselect_b32 s85, s89, s91
    s_cselect_b32 s89, s91, s89
    s_mov_b32 s91, s85
    s_add_u32 s93, s94, 3
    s_and_b32 s93, s93, 3
    s_lshl_b32 s93, s93, 8
    s_mov_b32 m0, s88
    s_add_u32 s85, s61, s93
    s_nop 0
    buffer_load_dwordx4 v8, s[72:75], s85 offen offset:0 lds
    buffer_load_dwordx4 v9, s[72:75], s85 offen offset:1024 lds
    buffer_load_dwordx4 v10, s[72:75], s85 offen offset:2048 lds
    buffer_load_dwordx4 v11, s[72:75], s85 offen offset:3072 lds
    s_mov_b32 m0, s89
    s_add_u32 s85, s64, s93
    buffer_load_dwordx4 v8, s[72:75], s85 offen offset:0 lds
    buffer_load_dwordx4 v9, s[72:75], s85 offen offset:1024 lds
    buffer_load_dwordx4 v10, s[72:75], s85 offen offset:2048 lds
    buffer_load_dwordx4 v11, s[72:75], s85 offen offset:3072 lds
    ds_write_b64 v226, v[52:53] offset:1536
    ds_write_b64 v226, v[56:57] offset:5120
    v_pk_fma_f32 v[60:61], v[124:125], v[164:165], v[60:61] op_sel:[0,1,0] op_sel_hi:[1,1,1] neg_lo:[1,0,0] neg_hi:[1,0,0]
    v_pk_fma_f32 v[62:63], v[126:127], v[164:165], v[62:63] op_sel:[0,1,0] op_sel_hi:[1,1,1] neg_lo:[1,0,0] neg_hi:[1,0,0]
    s_mov_b32 m0, s90
    s_add_u32 s85, s65, s93
    buffer_load_dwordx4 v8, s[72:75], s85 offen offset:0 lds
    v_pk_fma_f32 v[64:65], v[124:125], v[166:167], v[64:65] op_sel:[0,1,0] op_sel_hi:[1,1,1] neg_lo:[1,0,0] neg_hi:[1,0,0]
    v_pk_fma_f32 v[66:67], v[126:127], v[166:167], v[66:67] op_sel:[0,1,0] op_sel_hi:[1,1,1] neg_lo:[1,0,0] neg_hi:[1,0,0]
    v_pk_fma_f32 v[60:61], v[60:61], v[164:165], v[128:129] op_sel_hi:[1,0,1]
    v_pk_fma_f32 v[62:63], v[62:63], v[164:165], v[130:131] op_sel_hi:[1,0,1]
    v_pk_fma_f32 v[64:65], v[64:65], v[166:167], v[128:129] op_sel_hi:[1,0,1]
    v_pk_fma_f32 v[66:67], v[66:67], v[166:167], v[130:131] op_sel_hi:[1,0,1]
    v_pk_mul_f32 v[208:209], v[60:61], v[60:61]
    v_pk_mul_f32 v[210:211], v[62:63], v[62:63]
    v_pk_mul_f32 v[212:213], v[64:65], v[64:65]
    v_pk_mul_f32 v[214:215], v[66:67], v[66:67]
    v_pk_fma_f32 v[208:209], v[208:209], s[22:23], s[22:23] op_sel:[0,0,1] op_sel_hi:[1,0,1]
    v_pk_fma_f32 v[210:211], v[210:211], s[22:23], s[22:23] op_sel:[0,0,1] op_sel_hi:[1,0,1]
    v_pk_fma_f32 v[212:213], v[212:213], s[22:23], s[22:23] op_sel:[0,0,1] op_sel_hi:[1,0,1]
    v_pk_fma_f32 v[214:215], v[214:215], s[22:23], s[22:23] op_sel:[0,0,1] op_sel_hi:[1,0,1]
    v_pk_mul_f32 v[208:209], v[208:209], v[60:61]
    v_pk_mul_f32 v[210:211], v[210:211], v[62:63]
    buffer_load_dwordx4 v9, s[72:75], s85 offen offset:1024 lds
    v_pk_mul_f32 v[212:213], v[212:213], v[64:65]
    v_pk_mul_f32 v[214:215], v[214:215], v[66:67]
    v_exp_f32 v208, v208
    v_exp_f32 v209, v209
    v_exp_f32 v210, v210
    v_exp_f32 v211, v211
    v_exp_f32 v212, v212
    v_exp_f32 v213, v213
    v_exp_f32 v214, v214
    v_exp_f32 v215, v215
    v_pk_add_f32 v[208:209], v[208:209], 1.0 op_sel_hi:[1,0]
    v_pk_add_f32 v[210:211], v[210:211], 1.0 op_sel_hi:[1,0]
    v_pk_add_f32 v[212:213], v[212:213], 1.0 op_sel_hi:[1,0]
    v_pk_add_f32 v[214:215], v[214:215], 1.0 op_sel_hi:[1,0]
    v_rcp_f32 v208, v208
    v_rcp_f32 v209, v209
    buffer_load_dwordx4 v10, s[72:75], s85 offen offset:2048 lds
    v_rcp_f32 v210, v210
    v_rcp_f32 v211, v211
    v_rcp_f32 v212, v212
    v_rcp_f32 v213, v213
    v_rcp_f32 v214, v214
    v_rcp_f32 v215, v215
    v_pk_mul_f32 v[60:61], v[60:61], v[208:209]
    v_pk_mul_f32 v[62:63], v[62:63], v[210:211]
    v_pk_mul_f32 v[64:65], v[64:65], v[212:213]
    v_pk_mul_f32 v[66:67], v[66:67], v[214:215]
    v_cvt_pk_bf16_f32 v60, v60, v61
    v_cvt_pk_bf16_f32 v61, v62, v63
    v_cvt_pk_bf16_f32 v64, v64, v65
    v_cvt_pk_bf16_f32 v65, v66, v67
    ds_write_b64 v226, v[60:61] offset:2048
    ds_write_b64 v226, v[64:65] offset:5632
    buffer_load_dwordx4 v11, s[72:75], s85 offen offset:3072 lds
    v_pk_fma_f32 v[68:69], v[132:133], v[164:165], v[68:69] op_sel:[0,1,0] op_sel_hi:[1,1,1] neg_lo:[1,0,0] neg_hi:[1,0,0]
    v_pk_fma_f32 v[70:71], v[134:135], v[164:165], v[70:71] op_sel:[0,1,0] op_sel_hi:[1,1,1] neg_lo:[1,0,0] neg_hi:[1,0,0]
    v_pk_fma_f32 v[72:73], v[132:133], v[166:167], v[72:73] op_sel:[0,1,0] op_sel_hi:[1,1,1] neg_lo:[1,0,0] neg_hi:[1,0,0]
    v_pk_fma_f32 v[74:75], v[134:135], v[166:167], v[74:75] op_sel:[0,1,0] op_sel_hi:[1,1,1] neg_lo:[1,0,0] neg_hi:[1,0,0]
    v_pk_fma_f32 v[68:69], v[68:69], v[164:165], v[136:137] op_sel_hi:[1,0,1]
    v_pk_fma_f32 v[70:71], v[70:71], v[164:165], v[138:139] op_sel_hi:[1,0,1]
    v_pk_fma_f32 v[72:73], v[72:73], v[166:167], v[136:137] op_sel_hi:[1,0,1]
    v_pk_fma_f32 v[74:75], v[74:75], v[166:167], v[138:139] op_sel_hi:[1,0,1]
    v_pk_mul_f32 v[208:209], v[68:69], v[68:69]
    v_pk_mul_f32 v[210:211], v[70:71], v[70:71]
    v_pk_mul_f32 v[212:213], v[72:73], v[72:73]
    v_pk_mul_f32 v[214:215], v[74:75], v[74:75]
    v_pk_fma_f32 v[208:209], v[208:209], s[22:23], s[22:23] op_sel:[0,0,1] op_sel_hi:[1,0,1]
    v_pk_fma_f32 v[210:211], v[210:211], s[22:23], s[22:23] op_sel:[0,0,1] op_sel_hi:[1,0,1]
    v_pk_fma_f32 v[212:213], v[212:213], s[22:23], s[22:23] op_sel:[0,0,1] op_sel_hi:[1,0,1]
    v_pk_fma_f32 v[214:215], v[214:215], s[22:23], s[22:23] op_sel:[0,0,1] op_sel_hi:[1,0,1]
    s_mov_b32 m0, s91
    s_add_u32 s85, s66, s93
    buffer_load_dwordx4 v8, s[72:75], s85 offen offset:0 lds
    v_pk_mul_f32 v[208:209], v[208:209], v[68:69]
    v_pk_mul_f32 v[210:211], v[210:211], v[70:71]
    v_pk_mul_f32 v[212:213], v[212:213], v[72:73]
    v_pk_mul_f32 v[214:215], v[214:215], v[74:75]
    v_exp_f32 v208, v208
    v_exp_f32 v209, v209
    v_exp_f32 v210, v210
    v_exp_f32 v211, v211
    v_exp_f32 v212, v212
    v_exp_f32 v213, v213
    v_exp_f32 v214, v214
    v_exp_f32 v215, v215
    v_pk_add_f32 v[208:209], v[208:209], 1.0 op_sel_hi:[1,0]
    v_pk_add_f32 v[210:211], v[210:211], 1.0 op_sel_hi:[1,0]
    v_pk_add_f32 v[212:213], v[212:213], 1.0 op_sel_hi:[1,0]
    v_pk_add_f32 v[214:215], v[214:215], 1.0 op_sel_hi:[1,0]
    buffer_load_dwordx4 v9, s[72:75], s85 offen offset:1024 lds
    v_rcp_f32 v208, v208
    v_rcp_f32 v209, v209
    v_rcp_f32 v210, v210
    v_rcp_f32 v211, v211
    v_rcp_f32 v212, v212
    v_rcp_f32 v213, v213
    v_rcp_f32 v214, v214
    v_rcp_f32 v215, v215
    v_pk_mul_f32 v[68:69], v[68:69], v[208:209]
    v_pk_mul_f32 v[70:71], v[70:71], v[210:211]
    v_pk_mul_f32 v[72:73], v[72:73], v[212:213]
    v_pk_mul_f32 v[74:75], v[74:75], v[214:215]
    v_cvt_pk_bf16_f32 v68, v68, v69
    v_cvt_pk_bf16_f32 v69, v70, v71
    v_cvt_pk_bf16_f32 v72, v72, v73
    v_cvt_pk_bf16_f32 v73, v74, v75
    buffer_load_dwordx4 v10, s[72:75], s85 offen offset:2048 lds
    ds_write_b64 v226, v[68:69] offset:2560
    ds_write_b64 v226, v[72:73] offset:6144
    v_pk_fma_f32 v[76:77], v[140:141], v[164:165], v[76:77] op_sel:[0,1,0] op_sel_hi:[1,1,1] neg_lo:[1,0,0] neg_hi:[1,0,0]
    v_pk_fma_f32 v[78:79], v[142:143], v[164:165], v[78:79] op_sel:[0,1,0] op_sel_hi:[1,1,1] neg_lo:[1,0,0] neg_hi:[1,0,0]
    v_pk_fma_f32 v[80:81], v[140:141], v[166:167], v[80:81] op_sel:[0,1,0] op_sel_hi:[1,1,1] neg_lo:[1,0,0] neg_hi:[1,0,0]
    v_pk_fma_f32 v[82:83], v[142:143], v[166:167], v[82:83] op_sel:[0,1,0] op_sel_hi:[1,1,1] neg_lo:[1,0,0] neg_hi:[1,0,0]
    v_pk_fma_f32 v[76:77], v[76:77], v[164:165], v[144:145] op_sel_hi:[1,0,1]
    v_pk_fma_f32 v[78:79], v[78:79], v[164:165], v[146:147] op_sel_hi:[1,0,1]
    v_pk_fma_f32 v[80:81], v[80:81], v[166:167], v[144:145] op_sel_hi:[1,0,1]
    v_pk_fma_f32 v[82:83], v[82:83], v[166:167], v[146:147] op_sel_hi:[1,0,1]
    v_pk_mul_f32 v[208:209], v[76:77], v[76:77]
    v_pk_mul_f32 v[210:211], v[78:79], v[78:79]
    v_pk_mul_f32 v[212:213], v[80:81], v[80:81]
    v_pk_mul_f32 v[214:215], v[82:83], v[82:83]
    v_pk_fma_f32 v[208:209], v[208:209], s[22:23], s[22:23] op_sel:[0,0,1] op_sel_hi:[1,0,1]
    v_pk_fma_f32 v[210:211], v[210:211], s[22:23], s[22:23] op_sel:[0,0,1] op_sel_hi:[1,0,1]
    buffer_load_dwordx4 v11, s[72:75], s85 offen offset:3072 lds
    v_pk_fma_f32 v[212:213], v[212:213], s[22:23], s[22:23] op_sel:[0,0,1] op_sel_hi:[1,0,1]
    v_pk_fma_f32 v[214:215], v[214:215], s[22:23], s[22:23] op_sel:[0,0,1] op_sel_hi:[1,0,1]
    v_pk_mul_f32 v[208:209], v[208:209], v[76:77]
    v_pk_mul_f32 v[210:211], v[210:211], v[78:79]
    v_pk_mul_f32 v[212:213], v[212:213], v[80:81]
    v_pk_mul_f32 v[214:215], v[214:215], v[82:83]
    v_exp_f32 v208, v208
    v_exp_f32 v209, v209
    v_exp_f32 v210, v210
    v_exp_f32 v211, v211
    v_exp_f32 v212, v212
    v_exp_f32 v213, v213
    v_exp_f32 v214, v214
    v_exp_f32 v215, v215
    v_pk_add_f32 v[208:209], v[208:209], 1.0 op_sel_hi:[1,0]
    v_pk_add_f32 v[210:211], v[210:211], 1.0 op_sel_hi:[1,0]
    v_pk_add_f32 v[212:213], v[212:213], 1.0 op_sel_hi:[1,0]
    v_pk_add_f32 v[214:215], v[214:215], 1.0 op_sel_hi:[1,0]
    v_rcp_f32 v208, v208
    v_rcp_f32 v209, v209
    v_rcp_f32 v210, v210
    v_rcp_f32 v211, v211
    v_rcp_f32 v212, v212
    v_rcp_f32 v213, v213
    v_rcp_f32 v214, v214
    v_rcp_f32 v215, v215
    v_pk_mul_f32 v[76:77], v[76:77], v[208:209]
    v_pk_mul_f32 v[78:79], v[78:79], v[210:211]
    v_pk_mul_f32 v[80:81], v[80:81], v[212:213]
    v_pk_mul_f32 v[82:83], v[82:83], v[214:215]
    v_cvt_pk_bf16_f32 v76, v76, v77
    v_cvt_pk_bf16_f32 v77, v78, v79
    v_cvt_pk_bf16_f32 v80, v80, v81
    v_cvt_pk_bf16_f32 v81, v82, v83
    ds_write_b64 v226, v[76:77] offset:3072
    ds_write_b64 v226, v[80:81] offset:6656
adaLN_cond__ssm_conv_s4d__mixer_gmlp__prompt_kernel_join15:
adaLN_cond__ssm_conv_s4d__mixer_gmlp__prompt_kernel_g2c4:
    s_lshl_b32 s57, s54, 2
    s_lshr_b32 s58, s3, 1
    s_add_u32 s57, s57, s58
    s_lshl_b32 s57, s57, 2
    s_add_u32 s57, s57, s52
    s_lshl_b32 s57, s57, 8
    v_and_b32_e64 v5, 7, v1
    v_lshl_add_u32 v5, v5, 5, s57
    s_mov_b32 s60, 327680
    buffer_load_dword v253, v5, s[4:7], s60 offen sc1
    s_load_dwordx2 s[62:63], s[0:1], 80
    s_lshl_b32 s57, s53, 6
    s_lshl_b32 s58, s76, 5
    s_add_u32 s57, s57, s58
    s_lshl_b32 s58, s77, 2
    s_add_u32 s57, s57, s58
    v_lshrrev_b32 v6, 2, v2
    v_and_b32_e64 v4, 3, v2
    v_lshl_add_u32 v6, v6, 3, v4
    v_add_u32 v16, s57, v6
    v_lshlrev_b32_e64 v6, 1, v16
    s_waitcnt lgkmcnt(0)
    s_mov_b32 s12, s62
    s_mov_b32 s13, s63
    s_mov_b32 s14, 0x1000
    s_mov_b32 s15, 0x20000
    buffer_load_ushort v236, v6, s[12:15], 0 offen
    s_add_u32 s57, s52, 1
    s_and_b32 s57, s57, 3
    s_mul_i32 s57, s57, 6144
    s_add_u32 s57, s57, 114688
    v_add_u32_e64 v28, s57, v252
    s_add_u32 s57, s52, 2
    s_and_b32 s57, s57, 3
    s_mul_i32 s57, s57, 6144
    s_add_u32 s57, s57, 116736
    v_add_u32_e64 v29, s57, v252
    s_add_u32 s57, s52, 3
    s_and_b32 s57, s57, 3
    s_mul_i32 s57, s57, 6144
    s_add_u32 s57, s57, 118784
    v_add_u32 v30, s57, v252
    v_add_u32 v19, s80, v252
    s_mul_i32 s57, s52, 3584
    s_add_u32 s57, s57, 139264
    v_add_u32_e64 v31, s57, v17
    s_lshl_b32 s28, s52, 15
    s_add_u32 s28, s28, s25
    s_add_u32 s28, s28, 9437184
    s_mul_i32 s17, s54, 3584
    s_add_u32 s17, s17, s29
    s_lshl_b32 s57, s54, 8
    s_add_u32 s57, s57, 403456
    v_lshlrev_b32_e64 v6, 2, v1
    buffer_load_dword v240, v6, s[4:7], s57 offen sc1
    s_add_u32 s57, s57, 12288
    buffer_load_dword v241, v6, s[4:7], s57 offen sc1
    s_add_u32 s57, s57, 12288
    buffer_load_dword v242, v6, s[4:7], s57 offen sc1
    s_add_u32 s57, s57, 12288
    buffer_load_dword v243, v6, s[4:7], s57 offen sc1
    v_lshrrev_b32 v4, 2, v1
    v_and_b32 v39, 3, v1
    v_lshlrev_b32_e64 v39, 3, v39
    v_lshl_add_u32 v39, v4, 7, v39
    v_bfe_u32 v4, v1, 3, 2
    v_xor_b32_e64 v32, 0, v4
    v_lshl_add_u32 v32, v32, 5, v39
    v_add_u32 v36, 0x10000, v32
    v_xor_b32_e64 v33, 1, v4
    v_lshl_add_u32 v33, v33, 5, v39
    v_add_u32 v37, 0x10000, v33
    v_xor_b32_e64 v34, 2, v4
    v_lshl_add_u32 v34, v34, 5, v39
    v_add_u32 v38, 0x10000, v34
    v_xor_b32_e64 v35, 3, v4
    v_lshl_add_u32 v35, v35, 5, v39
    v_add_u32 v39, 0x10000, v35
    s_waitcnt vmcnt(5)
    v_cmp_ne_u32_e64 vcc, s56, v253
    s_mov_b32 s59, 0
    s_cbranch_vccz adaLN_cond__ssm_conv_s4d__mixer_gmlp__prompt_kernel_polld23
adaLN_cond__ssm_conv_s4d__mixer_gmlp__prompt_kernel_poll22:
    s_sleep 2
    s_mov_b32 s60, 327680
    buffer_load_dword v253, v5, s[4:7], s60 offen sc1
    s_add_u32 s59, s59, 1
    s_waitcnt vmcnt(0)
    v_cmp_ne_u32_e64 vcc, s56, v253
    s_nop 0
    s_cbranch_vccz adaLN_cond__ssm_conv_s4d__mixer_gmlp__prompt_kernel_polld23
    s_cmp_lt_u32 s59, 524288
    s_cbranch_scc1 adaLN_cond__ssm_conv_s4d__mixer_gmlp__prompt_kernel_poll22
adaLN_cond__ssm_conv_s4d__mixer_gmlp__prompt_kernel_polld23:
    s_lshl_b32 s93, s94, 13
    s_add_u32 s81, s28, 0
    s_add_u32 s25, s81, s93
    buffer_load_dwordx4 v[168:171], v252, s[4:7], s25 offen offset:0 sc1
    buffer_load_dwordx4 v[172:175], v252, s[4:7], s25 offen offset:1024 sc1
    buffer_load_dwordx4 v[176:179], v252, s[4:7], s25 offen offset:2048 sc1
    buffer_load_dwordx4 v[180:183], v252, s[4:7], s25 offen offset:3072 sc1
    s_add_u32 s93, s93, 4096
    s_and_b32 s93, s93, 32767
    s_add_u32 s25, s81, s93
    s_nop 0
    buffer_load_dwordx4 v[184:187], v252, s[4:7], s25 offen offset:0 sc1
    buffer_load_dwordx4 v[188:191], v252, s[4:7], s25 offen offset:1024 sc1
    buffer_load_dwordx4 v[192:195], v252, s[4:7], s25 offen offset:2048 sc1
    buffer_load_dwordx4 v[196:199], v252, s[4:7], s25 offen offset:3072 sc1
    s_add_u32 s93, s93, 4096
    s_and_b32 s93, s93, 32767
    s_add_u32 s25, s81, s93
    buffer_load_dwordx4 v[200:203], v252, s[4:7], s25 offen offset:0 sc1
    buffer_load_dwordx4 v[204:207], v252, s[4:7], s25 offen offset:1024 sc1
    v_add_u32 v14, s19, v12
    v_add_u32_e64 v15, s19, v13
    ds_read_b128 a[48:51], v14 offset:28672
    ds_read_b128 a[52:55], v15 offset:28672
    ds_read_b128 a[56:59], v14 offset:30720
    ds_read_b128 a[60:63], v15 offset:30720
    v_add_u32 v14, s92, v12
    v_add_u32 v15, s92, v13
    ds_read_b128 a[112:115], v14 offset:0
    ds_read_b128 a[116:119], v15 offset:0
    ds_read_b128 a[120:123], v14 offset:2048
    ds_read_b128 a[124:127], v15 offset:2048
    ds_read_b128 a[176:179], v14 offset:4096
    ds_read_b128 a[180:183], v15 offset:4096
    ds_read_b128 a[184:187], v14 offset:6144
    ds_read_b128 a[188:191], v15 offset:6144
    v_add_u32 v14, s83, v12
    v_add_u32 v15, s83, v13
    ds_read_b128 a[240:243], v14 offset:0
    ds_read_b128 a[244:247], v15 offset:0
    ds_read_b128 a[248:251], v14 offset:2048
    ds_read_b128 a[252:255], v15 offset:2048
    s_waitcnt vmcnt(12)
    v_add_f32 v240, v240, v241
    s_waitcnt vmcnt(10)
    v_add_f32_e64 v242, v242, v243
    s_lshl_b32 s57, s52, 8
    s_add_u32 s57, s57, 154112
    v_add_f32 v240, v240, v242
    v_add_u32 v6, s57, v6
    v_cvt_pk_bf16_f32 v240, v240, v240
    v_and_b32 v240, 0xffff0000, v240
    ds_write_b32 v6, v240
    v_lshlrev_b32 v236, 16, v236
    v_mov_b32 v237, v236
    v_mov_b32 v238, v236
    v_mov_b32 v239, v236
    s_waitcnt vmcnt(9)
    s_nop 0
    v_mfma_f32_16x16x32_bf16 v[104:107], v[168:171], a[0:3], v[236:239]
    v_mfma_f32_16x16x32_bf16 v[112:115], v[168:171], a[64:67], 0
    v_mfma_f32_16x16x32_bf16 v[120:123], v[168:171], a[128:131], 0
    v_mfma_f32_16x16x32_bf16 v[128:131], v[168:171], a[192:195], 0
    buffer_load_dwordx4 v[168:171], v252, s[4:7], s25 offen offset:2048 sc1
    s_waitcnt vmcnt(9)
    v_mfma_f32_16x16x32_bf16 v[108:111], v[172:175], a[0:3], v[236:239]
    v_mfma_f32_16x16x32_bf16 v[116:119], v[172:175], a[64:67], 0
    v_mfma_f32_16x16x32_bf16 v[124:127], v[172:175], a[128:131], 0
    v_mfma_f32_16x16x32_bf16 v[132:135], v[172:175], a[192:195], 0
    buffer_load_dwordx4 v[172:175], v252, s[4:7], s25 offen offset:3072 sc1
    s_waitcnt vmcnt(9)
    v_mfma_f32_16x16x32_bf16 v[104:107], v[176:179], a[4:7], v[104:107]
    v_mfma_f32_16x16x32_bf16 v[112:115], v[176:179], a[68:71], v[112:115]
    v_mfma_f32_16x16x32_bf16 v[120:123], v[176:179], a[132:135], v[120:123]
    v_mfma_f32_16x16x32_bf16 v[128:131], v[176:179], a[196:199], v[128:131]
    s_add_u32 s93, s93, 4096
    s_and_b32 s93, s93, 32767
    s_add_u32 s25, s81, s93
    buffer_load_dwordx4 v[176:179], v252, s[4:7], s25 offen offset:0 sc1
    s_waitcnt vmcnt(9)
    v_mfma_f32_16x16x32_bf16 v[108:111], v[180:183], a[4:7], v[108:111]
    v_mfma_f32_16x16x32_bf16 v[116:119], v[180:183], a[68:71], v[116:119]
    v_mfma_f32_16x16x32_bf16 v[124:127], v[180:183], a[132:135], v[124:127]
    v_mfma_f32_16x16x32_bf16 v[132:135], v[180:183], a[196:199], v[132:135]
    buffer_load_dwordx4 v[180:183], v252, s[4:7], s25 offen offset:1024 sc1
    s_waitcnt vmcnt(9)
    v_mfma_f32_16x16x32_bf16 v[104:107], v[184:187], a[8:11], v[104:107]
    v_mfma_f32_16x16x32_bf16 v[112:115], v[184:187], a[72:75], v[112:115]
    v_mfma_f32_16x16x32_bf16 v[120:123], v[184:187], a[136:139], v[120:123]
    v_mfma_f32_16x16x32_bf16 v[128:131], v[184:187], a[200:203], v[128:131]
    buffer_load_dwordx4 v[184:187], v252, s[4:7], s25 offen offset:2048 sc1
    s_waitcnt vmcnt(9)
    v_mfma_f32_16x16x32_bf16 v[108:111], v[188:191], a[8:11], v[108:111]
    v_mfma_f32_16x16x32_bf16 v[116:119], v[188:191], a[72:75], v[116:119]
    v_mfma_f32_16x16x32_bf16 v[124:127], v[188:191], a[136:139], v[124:127]
    v_mfma_f32_16x16x32_bf16 v[132:135], v[188:191], a[200:203], v[132:135]
    buffer_load_dwordx4 v[188:191], v252, s[4:7], s25 offen offset:3072 sc1
    s_waitcnt vmcnt(9)
    v_mfma_f32_16x16x32_bf16 v[104:107], v[192:195], a[12:15], v[104:107]
    v_mfma_f32_16x16x32_bf16 v[112:115], v[192:195], a[76:79], v[112:115]
    v_mfma_f32_16x16x32_bf16 v[120:123], v[192:195], a[140:143], v[120:123]
    v_mfma_f32_16x16x32_bf16 v[128:131], v[192:195], a[204:207], v[128:131]
    s_add_u32 s93, s93, 4096
    s_and_b32 s93, s93, 32767
    s_add_u32 s25, s81, s93
    buffer_load_dwordx4 v[192:195], v252, s[4:7], s25 offen offset:0 sc1
    s_waitcnt vmcnt(9)
    v_mfma_f32_16x16x32_bf16 v[108:111], v[196:199], a[12:15], v[108:111]
    v_mfma_f32_16x16x32_bf16 v[116:119], v[196:199], a[76:79], v[116:119]
    v_mfma_f32_16x16x32_bf16 v[124:127], v[196:199], a[140:143], v[124:127]
    v_mfma_f32_16x16x32_bf16 v[132:135], v[196:199], a[204:207], v[132:135]
    buffer_load_dwordx4 v[196:199], v252, s[4:7], s25 offen offset:1024 sc1
    s_waitcnt vmcnt(9)
    v_mfma_f32_16x16x32_bf16 v[104:107], v[200:203], a[16:19], v[104:107]
    v_mfma_f32_16x16x32_bf16 v[112:115], v[200:203], a[80:83], v[112:115]
    v_mfma_f32_16x16x32_bf16 v[120:123], v[200:203], a[144:147], v[120:123]
    v_mfma_f32_16x16x32_bf16 v[128:131], v[200:203], a[208:211], v[128:131]
    buffer_load_dwordx4 v[200:203], v252, s[4:7], s25 offen offset:2048 sc1
    s_waitcnt vmcnt(9)
    v_mfma_f32_16x16x32_bf16 v[108:111], v[204:207], a[16:19], v[108:111]
    v_mfma_f32_16x16x32_bf16 v[116:119], v[204:207], a[80:83], v[116:119]
    v_mfma_f32_16x16x32_bf16 v[124:127], v[204:207], a[144:147], v[124:127]
    v_mfma_f32_16x16x32_bf16 v[132:135], v[204:207], a[208:211], v[132:135]
    buffer_load_dwordx4 v[204:207], v252, s[4:7], s25 offen offset:3072 sc1
    s_waitcnt vmcnt(9)
    v_mfma_f32_16x16x32_bf16 v[104:107], v[168:171], a[20:23], v[104:107]
    v_mfma_f32_16x16x32_bf16 v[112:115], v[168:171], a[84:87], v[112:115]
    v_mfma_f32_16x16x32_bf16 v[120:123], v[168:171], a[148:151], v[120:123]
    v_mfma_f32_16x16x32_bf16 v[128:131], v[168:171], a[212:215], v[128:131]
    s_add_u32 s93, s93, 4096
    s_and_b32 s93, s93, 32767
    s_add_u32 s25, s81, s93
    buffer_load_dwordx4 v[168:171], v252, s[4:7], s25 offen offset:0 sc1
    s_waitcnt vmcnt(9)
    v_mfma_f32_16x16x32_bf16 v[108:111], v[172:175], a[20:23], v[108:111]
    v_mfma_f32_16x16x32_bf16 v[116:119], v[172:175], a[84:87], v[116:119]
    v_mfma_f32_16x16x32_bf16 v[124:127], v[172:175], a[148:151], v[124:127]
    v_mfma_f32_16x16x32_bf16 v[132:135], v[172:175], a[212:215], v[132:135]
    buffer_load_dwordx4 v[172:175], v252, s[4:7], s25 offen offset:1024 sc1
    s_waitcnt vmcnt(9)
    v_mfma_f32_16x16x32_bf16 v[104:107], v[176:179], a[24:27], v[104:107]
    v_mfma_f32_16x16x32_bf16 v[112:115], v[176:179], a[88:91], v[112:115]
    v_mfma_f32_16x16x32_bf16 v[120:123], v[176:179], a[152:155], v[120:123]
    v_mfma_f32_16x16x32_bf16 v[128:131], v[176:179], a[216:219], v[128:131]
    buffer_load_dwordx4 v[176:179], v252, s[4:7], s25 offen offset:2048 sc1
    s_waitcnt vmcnt(9)
    v_mfma_f32_16x16x32_bf16 v[108:111], v[180:183], a[24:27], v[108:111]
    v_mfma_f32_16x16x32_bf16 v[116:119], v[180:183], a[88:91], v[116:119]
    v_mfma_f32_16x16x32_bf16 v[124:127], v[180:183], a[152:155], v[124:127]
    v_mfma_f32_16x16x32_bf16 v[132:135], v[180:183], a[216:219], v[132:135]
    buffer_load_dwordx4 v[180:183], v252, s[4:7], s25 offen offset:3072 sc1
    s_waitcnt vmcnt(9)
    v_mfma_f32_16x16x32_bf16 v[104:107], v[184:187], a[28:31], v[104:107]
    v_mfma_f32_16x16x32_bf16 v[112:115], v[184:187], a[92:95], v[112:115]
    v_mfma_f32_16x16x32_bf16 v[120:123], v[184:187], a[156:159], v[120:123]
    v_mfma_f32_16x16x32_bf16 v[128:131], v[184:187], a[220:223], v[128:131]
    s_add_u32 s93, s93, 4096
    s_and_b32 s93, s93, 32767
    s_add_u32 s25, s81, s93
    buffer_load_dwordx4 v[184:187], v252, s[4:7], s25 offen offset:0 sc1
    s_waitcnt vmcnt(9)
    v_mfma_f32_16x16x32_bf16 v[108:111], v[188:191], a[28:31], v[108:111]
    v_mfma_f32_16x16x32_bf16 v[116:119], v[188:191], a[92:95], v[116:119]
    v_mfma_f32_16x16x32_bf16 v[124:127], v[188:191], a[156:159], v[124:127]
    v_mfma_f32_16x16x32_bf16 v[132:135], v[188:191], a[220:223], v[132:135]
    buffer_load_dwordx4 v[188:191], v252, s[4:7], s25 offen offset:1024 sc1
    s_waitcnt vmcnt(9)
    v_mfma_f32_16x16x32_bf16 v[104:107], v[192:195], a[32:35], v[104:107]
    v_mfma_f32_16x16x32_bf16 v[112:115], v[192:195], a[96:99], v[112:115]
    v_mfma_f32_16x16x32_bf16 v[120:123], v[192:195], a[160:163], v[120:123]
    v_mfma_f32_16x16x32_bf16 v[128:131], v[192:195], a[224:227], v[128:131]
    buffer_load_dwordx4 v[192:195], v252, s[4:7], s25 offen offset:2048 sc1
    s_waitcnt vmcnt(9)
    v_mfma_f32_16x16x32_bf16 v[108:111], v[196:199], a[32:35], v[108:111]
    v_mfma_f32_16x16x32_bf16 v[116:119], v[196:199], a[96:99], v[116:119]
    v_mfma_f32_16x16x32_bf16 v[124:127], v[196:199], a[160:163], v[124:127]
    v_mfma_f32_16x16x32_bf16 v[132:135], v[196:199], a[224:227], v[132:135]
    buffer_load_dwordx4 v[196:199], v252, s[4:7], s25 offen offset:3072 sc1
    s_waitcnt vmcnt(9)
    v_mfma_f32_16x16x32_bf16 v[104:107], v[200:203], a[36:39], v[104:107]
    v_mfma_f32_16x16x32_bf16 v[112:115], v[200:203], a[100:103], v[112:115]
    v_mfma_f32_16x16x32_bf16 v[120:123], v[200:203], a[164:167], v[120:123]
    v_mfma_f32_16x16x32_bf16 v[128:131], v[200:203], a[228:231], v[128:131]
    s_add_u32 s93, s93, 4096
    s_and_b32 s93, s93, 32767
    s_add_u32 s25, s81, s93
    buffer_load_dwordx4 v[200:203], v252, s[4:7], s25 offen offset:0 sc1
    s_waitcnt vmcnt(9)
    v_mfma_f32_16x16x32_bf16 v[108:111], v[204:207], a[36:39], v[108:111]
    v_mfma_f32_16x16x32_bf16 v[116:119], v[204:207], a[100:103], v[116:119]
    v_mfma_f32_16x16x32_bf16 v[124:127], v[204:207], a[164:167], v[124:127]
    v_mfma_f32_16x16x32_bf16 v[132:135], v[204:207], a[228:231], v[132:135]
    buffer_load_dwordx4 v[204:207], v252, s[4:7], s25 offen offset:1024 sc1
    s_waitcnt vmcnt(9)
    v_mfma_f32_16x16x32_bf16 v[104:107], v[168:171], a[40:43], v[104:107]
    v_mfma_f32_16x16x32_bf16 v[112:115], v[168:171], a[104:107], v[112:115]
    v_mfma_f32_16x16x32_bf16 v[120:123], v[168:171], a[168:171], v[120:123]
    v_mfma_f32_16x16x32_bf16 v[128:131], v[168:171], a[232:235], v[128:131]
    buffer_load_dwordx4 v[168:171], v252, s[4:7], s25 offen offset:2048 sc1
    s_waitcnt vmcnt(9)
    v_mfma_f32_16x16x32_bf16 v[108:111], v[172:175], a[40:43], v[108:111]
    v_mfma_f32_16x16x32_bf16 v[116:119], v[172:175], a[104:107], v[116:119]
    v_mfma_f32_16x16x32_bf16 v[124:127], v[172:175], a[168:171], v[124:127]
    v_mfma_f32_16x16x32_bf16 v[132:135], v[172:175], a[232:235], v[132:135]
    buffer_load_dwordx4 v[172:175], v252, s[4:7], s25 offen offset:3072 sc1
    s_waitcnt vmcnt(9)
    v_mfma_f32_16x16x32_bf16 v[104:107], v[176:179], a[44:47], v[104:107]
    v_mfma_f32_16x16x32_bf16 v[112:115], v[176:179], a[108:111], v[112:115]
    v_mfma_f32_16x16x32_bf16 v[120:123], v[176:179], a[172:175], v[120:123]
    v_mfma_f32_16x16x32_bf16 v[128:131], v[176:179], a[236:239], v[128:131]
    s_lshl_b32 s93, s94, 13
    s_add_u32 s81, s28, 131072
    s_add_u32 s25, s81, s93
    buffer_load_dwordx4 v[176:179], v252, s[4:7], s25 offen offset:0 sc1
    s_waitcnt vmcnt(9)
    v_mfma_f32_16x16x32_bf16 v[108:111], v[180:183], a[44:47], v[108:111]
    v_mfma_f32_16x16x32_bf16 v[116:119], v[180:183], a[108:111], v[116:119]
    v_mfma_f32_16x16x32_bf16 v[124:127], v[180:183], a[172:175], v[124:127]
    v_mfma_f32_16x16x32_bf16 v[132:135], v[180:183], a[236:239], v[132:135]
    buffer_load_dwordx4 v[180:183], v252, s[4:7], s25 offen offset:1024 sc1
    s_waitcnt vmcnt(9) lgkmcnt(15)
    v_mfma_f32_16x16x32_bf16 v[104:107], v[184:187], a[48:51], v[104:107]
    s_waitcnt lgkmcnt(12)
    v_mfma_f32_16x16x32_bf16 v[112:115], v[184:187], a[112:115], v[112:115]
    s_waitcnt lgkmcnt(8)
    v_mfma_f32_16x16x32_bf16 v[120:123], v[184:187], a[176:179], v[120:123]
    s_waitcnt lgkmcnt(4)
    v_mfma_f32_16x16x32_bf16 v[128:131], v[184:187], a[240:243], v[128:131]
    buffer_load_dwordx4 v[184:187], v252, s[4:7], s25 offen offset:2048 sc1
    s_waitcnt vmcnt(9)
    v_mfma_f32_16x16x32_bf16 v[108:111], v[188:191], a[48:51], v[108:111]
    v_mfma_f32_16x16x32_bf16 v[116:119], v[188:191], a[112:115], v[116:119]
    v_mfma_f32_16x16x32_bf16 v[124:127], v[188:191], a[176:179], v[124:127]
    v_mfma_f32_16x16x32_bf16 v[132:135], v[188:191], a[240:243], v[132:135]
    buffer_load_dwordx4 v[188:191], v252, s[4:7], s25 offen offset:3072 sc1
    s_waitcnt vmcnt(9)
    v_mfma_f32_16x16x32_bf16 v[104:107], v[192:195], a[52:55], v[104:107]
    v_mfma_f32_16x16x32_bf16 v[112:115], v[192:195], a[116:119], v[112:115]
    v_mfma_f32_16x16x32_bf16 v[120:123], v[192:195], a[180:183], v[120:123]
    s_waitcnt lgkmcnt(3)
    v_mfma_f32_16x16x32_bf16 v[128:131], v[192:195], a[244:247], v[128:131]
    s_add_u32 s93, s93, 4096
    s_and_b32 s93, s93, 32767
    s_add_u32 s25, s81, s93
    buffer_load_dwordx4 v[192:195], v252, s[4:7], s25 offen offset:0 sc1
    s_waitcnt vmcnt(9)
    v_mfma_f32_16x16x32_bf16 v[108:111], v[196:199], a[52:55], v[108:111]
    v_mfma_f32_16x16x32_bf16 v[116:119], v[196:199], a[116:119], v[116:119]
    v_mfma_f32_16x16x32_bf16 v[124:127], v[196:199], a[180:183], v[124:127]
    v_mfma_f32_16x16x32_bf16 v[132:135], v[196:199], a[244:247], v[132:135]
    buffer_load_dwordx4 v[196:199], v252, s[4:7], s25 offen offset:1024 sc1
    s_waitcnt vmcnt(9)
    v_mfma_f32_16x16x32_bf16 v[104:107], v[200:203], a[56:59], v[104:107]
    v_mfma_f32_16x16x32_bf16 v[112:115], v[200:203], a[120:123], v[112:115]
    v_mfma_f32_16x16x32_bf16 v[120:123], v[200:203], a[184:187], v[120:123]
    s_waitcnt lgkmcnt(2)
    v_mfma_f32_16x16x32_bf16 v[128:131], v[200:203], a[248:251], v[128:131]
    buffer_load_dwordx4 v[200:203], v252, s[4:7], s25 offen offset:2048 sc1
    s_waitcnt vmcnt(9)
    v_mfma_f32_16x16x32_bf16 v[108:111], v[204:207], a[56:59], v[108:111]
    v_mfma_f32_16x16x32_bf16 v[116:119], v[204:207], a[120:123], v[116:119]
    v_mfma_f32_16x16x32_bf16 v[124:127], v[204:207], a[184:187], v[124:127]
    v_mfma_f32_16x16x32_bf16 v[132:135], v[204:207], a[248:251], v[132:135]
    buffer_load_dwordx4 v[204:207], v252, s[4:7], s25 offen offset:3072 sc1
    s_waitcnt vmcnt(9)
    v_mfma_f32_16x16x32_bf16 v[104:107], v[168:171], a[60:63], v[104:107]
    v_mfma_f32_16x16x32_bf16 v[112:115], v[168:171], a[124:127], v[112:115]
    v_mfma_f32_16x16x32_bf16 v[120:123], v[168:171], a[188:191], v[120:123]
    s_waitcnt lgkmcnt(1)
    v_mfma_f32_16x16x32_bf16 v[128:131], v[168:171], a[252:255], v[128:131]
    s_add_u32 s93, s93, 4096
    s_and_b32 s93, s93, 32767
    s_add_u32 s25, s81, s93
    buffer_load_dwordx4 v[168:171], v252, s[4:7], s25 offen offset:0 sc1
    s_waitcnt vmcnt(9)
    v_mfma_f32_16x16x32_bf16 v[108:111], v[172:175], a[60:63], v[108:111]
    v_mfma_f32_16x16x32_bf16 v[116:119], v[172:175], a[124:127], v[116:119]
    v_mfma_f32_16x16x32_bf16 v[124:127], v[172:175], a[188:191], v[124:127]
    v_mfma_f32_16x16x32_bf16 v[132:135], v[172:175], a[252:255], v[132:135]
    buffer_load_dwordx4 v[172:175], v252, s[4:7], s25 offen offset:1024 sc1
    s_waitcnt vmcnt(9)
    v_mfma_f32_16x16x32_bf16 v[136:139], v[176:179], a[0:3], v[236:239]
    v_mfma_f32_16x16x32_bf16 v[144:147], v[176:179], a[64:67], 0
    v_mfma_f32_16x16x32_bf16 v[152:155], v[176:179], a[128:131], 0
    v_mfma_f32_16x16x32_bf16 v[160:163], v[176:179], a[192:195], 0
    buffer_load_dwordx4 v[176:179], v252, s[4:7], s25 offen offset:2048 sc1
    s_waitcnt vmcnt(9)
    v_mfma_f32_16x16x32_bf16 v[140:143], v[180:183], a[0:3], v[236:239]
    s_waitcnt lgkmcnt(0)
    s_barrier
    v_mfma_f32_16x16x32_bf16 v[148:151], v[180:183], a[64:67], 0
    v_mfma_f32_16x16x32_bf16 v[156:159], v[180:183], a[128:131], 0
    v_mfma_f32_16x16x32_bf16 v[164:167], v[180:183], a[192:195], 0
    buffer_load_dwordx4 v[180:183], v252, s[4:7], s25 offen offset:3072 sc1
    s_waitcnt vmcnt(9)
    v_mfma_f32_16x16x32_bf16 v[136:139], v[184:187], a[4:7], v[136:139]
    ds_write_b128 v28, v[112:115] offset:0
    v_mfma_f32_16x16x32_bf16 v[144:147], v[184:187], a[68:71], v[144:147]
    v_mfma_f32_16x16x32_bf16 v[152:155], v[184:187], a[132:135], v[152:155]
    ds_write_b128 v28, v[116:119] offset:1024
    v_mfma_f32_16x16x32_bf16 v[160:163], v[184:187], a[196:199], v[160:163]
    s_add_u32 s93, s93, 4096
    s_and_b32 s93, s93, 32767
    s_add_u32 s25, s81, s93
    buffer_load_dwordx4 v[184:187], v252, s[4:7], s25 offen offset:0 sc1
    s_waitcnt vmcnt(9)
    v_mfma_f32_16x16x32_bf16 v[140:143], v[188:191], a[4:7], v[140:143]
    v_mfma_f32_16x16x32_bf16 v[148:151], v[188:191], a[68:71], v[148:151]
    ds_write_b128 v29, v[120:123] offset:0
    v_mfma_f32_16x16x32_bf16 v[156:159], v[188:191], a[132:135], v[156:159]
    v_mfma_f32_16x16x32_bf16 v[164:167], v[188:191], a[196:199], v[164:167]
    buffer_load_dwordx4 v[188:191], v252, s[4:7], s25 offen offset:1024 sc1
    s_waitcnt vmcnt(9)
    v_mfma_f32_16x16x32_bf16 v[136:139], v[192:195], a[8:11], v[136:139]
    ds_write_b128 v29, v[124:127] offset:1024
    v_mfma_f32_16x16x32_bf16 v[144:147], v[192:195], a[72:75], v[144:147]
    v_mfma_f32_16x16x32_bf16 v[152:155], v[192:195], a[136:139], v[152:155]
    v_mfma_f32_16x16x32_bf16 v[160:163], v[192:195], a[200:203], v[160:163]
    buffer_load_dwordx4 v[192:195], v252, s[4:7], s25 offen offset:2048 sc1
    s_waitcnt vmcnt(9)
    v_mfma_f32_16x16x32_bf16 v[140:143], v[196:199], a[8:11], v[140:143]
    ds_write_b128 v30, v[128:131] offset:0
    v_mfma_f32_16x16x32_bf16 v[148:151], v[196:199], a[72:75], v[148:151]
    v_mfma_f32_16x16x32_bf16 v[156:159], v[196:199], a[136:139], v[156:159]
    ds_write_b128 v30, v[132:135] offset:1024
    v_mfma_f32_16x16x32_bf16 v[164:167], v[196:199], a[200:203], v[164:167]
    buffer_load_dwordx4 v[196:199], v252, s[4:7], s25 offen offset:3072 sc1
    s_waitcnt vmcnt(9)
    v_mfma_f32_16x16x32_bf16 v[136:139], v[200:203], a[12:15], v[136:139]
    v_mfma_f32_16x16x32_bf16 v[144:147], v[200:203], a[76:79], v[144:147]
    v_mfma_f32_16x16x32_bf16 v[152:155], v[200:203], a[140:143], v[152:155]
    v_mfma_f32_16x16x32_bf16 v[160:163], v[200:203], a[204:207], v[160:163]
    s_add_u32 s93, s93, 4096
    s_and_b32 s93, s93, 32767
    s_add_u32 s25, s81, s93
    buffer_load_dwordx4 v[200:203], v252, s[4:7], s25 offen offset:0 sc1
    s_waitcnt vmcnt(9)
    v_mfma_f32_16x16x32_bf16 v[140:143], v[204:207], a[12:15], v[140:143]
    s_waitcnt lgkmcnt(0)
    s_barrier
    v_mfma_f32_16x16x32_bf16 v[148:151], v[204:207], a[76:79], v[148:151]
    ds_read_b128 v[208:211], v19 offset:0
    v_mfma_f32_16x16x32_bf16 v[156:159], v[204:207], a[140:143], v[156:159]
    ds_read_b128 v[216:219], v19 offset:2048
    v_mfma_f32_16x16x32_bf16 v[164:167], v[204:207], a[204:207], v[164:167]
    buffer_load_dwordx4 v[204:207], v252, s[4:7], s25 offen offset:1024 sc1
    s_waitcnt vmcnt(9)
    v_mfma_f32_16x16x32_bf16 v[136:139], v[168:171], a[16:19], v[136:139]
    ds_read_b128 v[224:227], v19 offset:4096
    v_mfma_f32_16x16x32_bf16 v[144:147], v[168:171], a[80:83], v[144:147]
    ds_read_b128 v[212:215], v19 offset:1024
    v_mfma_f32_16x16x32_bf16 v[152:155], v[168:171], a[144:147], v[152:155]
    v_mfma_f32_16x16x32_bf16 v[160:163], v[168:171], a[208:211], v[160:163]
    buffer_load_dwordx4 v[168:171], v252, s[4:7], s25 offen offset:2048 sc1
    s_waitcnt vmcnt(9)
    v_mfma_f32_16x16x32_bf16 v[140:143], v[172:175], a[16:19], v[140:143]
    ds_read_b128 v[220:223], v19 offset:3072
    v_mfma_f32_16x16x32_bf16 v[148:151], v[172:175], a[80:83], v[148:151]
    ds_read_b128 v[228:231], v19 offset:5120
    v_mfma_f32_16x16x32_bf16 v[156:159], v[172:175], a[144:147], v[156:159]
    ds_read_b64 v[232:233], v31 offset:0
    v_mfma_f32_16x16x32_bf16 v[164:167], v[172:175], a[208:211], v[164:167]
    buffer_load_dwordx4 v[172:175], v252, s[4:7], s25 offen offset:3072 sc1
    s_waitcnt vmcnt(9)
    v_mfma_f32_16x16x32_bf16 v[136:139], v[176:179], a[20:23], v[136:139]
    ds_read_b64 v[234:235], v31 offset:512
    v_mfma_f32_16x16x32_bf16 v[144:147], v[176:179], a[84:87], v[144:147]
    v_mfma_f32_16x16x32_bf16 v[152:155], v[176:179], a[148:151], v[152:155]
    v_mfma_f32_16x16x32_bf16 v[160:163], v[176:179], a[212:215], v[160:163]
    s_add_u32 s93, s93, 4096
    s_and_b32 s93, s93, 32767
    s_add_u32 s25, s81, s93
    buffer_load_dwordx4 v[176:179], v252, s[4:7], s25 offen offset:0 sc1
    s_waitcnt vmcnt(9)
    v_mfma_f32_16x16x32_bf16 v[140:143], v[180:183], a[20:23], v[140:143]
    v_mfma_f32_16x16x32_bf16 v[148:151], v[180:183], a[84:87], v[148:151]
    v_mfma_f32_16x16x32_bf16 v[156:159], v[180:183], a[148:151], v[156:159]
    s_waitcnt lgkmcnt(6)
    v_add_f32 v208, v208, v216
    v_add_f32 v209, v209, v217
    v_mfma_f32_16x16x32_bf16 v[164:167], v[180:183], a[212:215], v[164:167]
    buffer_load_dwordx4 v[180:183], v252, s[4:7], s25 offen offset:1024 sc1
    s_waitcnt vmcnt(9)
    v_mfma_f32_16x16x32_bf16 v[136:139], v[184:187], a[24:27], v[136:139]
    v_add_f32 v210, v210, v218
    v_add_f32_e64 v211, v211, v219
    v_mfma_f32_16x16x32_bf16 v[144:147], v[184:187], a[88:91], v[144:147]
    s_waitcnt lgkmcnt(5)
    v_add_f32 v224, v224, v104
    v_add_f32_e64 v225, v225, v105
    v_mfma_f32_16x16x32_bf16 v[152:155], v[184:187], a[152:155], v[152:155]
    v_add_f32 v226, v226, v106
    v_add_f32 v227, v227, v107
    v_mfma_f32_16x16x32_bf16 v[160:163], v[184:187], a[216:219], v[160:163]
    buffer_load_dwordx4 v[184:187], v252, s[4:7], s25 offen offset:2048 sc1
    s_waitcnt vmcnt(9)
    v_mfma_f32_16x16x32_bf16 v[140:143], v[188:191], a[24:27], v[140:143]
    s_waitcnt lgkmcnt(1)
    v_lshlrev_b32_e64 v216, 16, v232
    v_and_b32 v217, 0xffff0000, v232
    v_mfma_f32_16x16x32_bf16 v[148:151], v[188:191], a[88:91], v[148:151]
    v_lshlrev_b32_e64 v218, 16, v233
    v_and_b32 v219, 0xffff0000, v233
    v_mfma_f32_16x16x32_bf16 v[156:159], v[188:191], a[152:155], v[156:159]
    v_add_f32 v208, v208, v224
    v_add_f32 v209, v209, v225
    v_mfma_f32_16x16x32_bf16 v[164:167], v[188:191], a[216:219], v[164:167]
    buffer_load_dwordx4 v[188:191], v252, s[4:7], s25 offen offset:3072 sc1
    s_waitcnt vmcnt(9)
    v_mfma_f32_16x16x32_bf16 v[136:139], v[192:195], a[28:31], v[136:139]
    v_add_f32 v210, v210, v226
    v_add_f32_e64 v211, v211, v227
    v_mfma_f32_16x16x32_bf16 v[144:147], v[192:195], a[92:95], v[144:147]
    v_mul_f32 v208, v208, v216
    v_mul_f32 v209, v209, v217
    v_mfma_f32_16x16x32_bf16 v[152:155], v[192:195], a[156:159], v[152:155]
    v_mul_f32 v210, v210, v218
    v_mul_f32 v211, v211, v219
    v_mfma_f32_16x16x32_bf16 v[160:163], v[192:195], a[220:223], v[160:163]
    s_add_u32 s93, s93, 4096
    s_and_b32 s93, s93, 32767
    s_add_u32 s25, s81, s93
    buffer_load_dwordx4 v[192:195], v252, s[4:7], s25 offen offset:0 sc1
    v_cvt_pk_bf16_f32 v240, v208, v209
    s_waitcnt vmcnt(9)
    v_mfma_f32_16x16x32_bf16 v[140:143], v[196:199], a[28:31], v[140:143]
    v_cvt_pk_bf16_f32 v241, v210, v211
    v_add_f32_e64 v212, v212, v220
    v_mfma_f32_16x16x32_bf16 v[148:151], v[196:199], a[92:95], v[148:151]
    v_add_f32 v213, v213, v221
    v_add_f32 v214, v214, v222
    v_mfma_f32_16x16x32_bf16 v[156:159], v[196:199], a[156:159], v[156:159]
    v_add_f32 v215, v215, v223
    v_add_f32 v228, v228, v108
    v_mfma_f32_16x16x32_bf16 v[164:167], v[196:199], a[220:223], v[164:167]
    buffer_load_dwordx4 v[196:199], v252, s[4:7], s25 offen offset:1024 sc1
    s_waitcnt vmcnt(9)
    v_mfma_f32_16x16x32_bf16 v[136:139], v[200:203], a[32:35], v[136:139]
    v_add_f32 v229, v229, v109
    v_add_f32_e64 v230, v230, v110
    v_mfma_f32_16x16x32_bf16 v[144:147], v[200:203], a[96:99], v[144:147]
    v_add_f32 v231, v231, v111
    s_waitcnt lgkmcnt(0)
    v_lshlrev_b32_e64 v220, 16, v234
    v_mfma_f32_16x16x32_bf16 v[152:155], v[200:203], a[160:163], v[152:155]
    v_and_b32 v221, 0xffff0000, v234
    v_lshlrev_b32_e64 v222, 16, v235
    v_mfma_f32_16x16x32_bf16 v[160:163], v[200:203], a[224:227], v[160:163]
    buffer_load_dwordx4 v[200:203], v252, s[4:7], s25 offen offset:2048 sc1
    s_waitcnt vmcnt(9)
    v_mfma_f32_16x16x32_bf16 v[140:143], v[204:207], a[32:35], v[140:143]
    v_and_b32 v223, 0xffff0000, v235
    v_add_f32 v212, v212, v228
    v_mfma_f32_16x16x32_bf16 v[148:151], v[204:207], a[96:99], v[148:151]
    v_add_f32 v213, v213, v229
    v_add_f32 v214, v214, v230
    v_mfma_f32_16x16x32_bf16 v[156:159], v[204:207], a[160:163], v[156:159]
    v_add_f32 v215, v215, v231
    v_mul_f32 v212, v212, v220
    v_mfma_f32_16x16x32_bf16 v[164:167], v[204:207], a[224:227], v[164:167]
    buffer_load_dwordx4 v[204:207], v252, s[4:7], s25 offen offset:3072 sc1
    v_mul_f32 v213, v213, v221
    s_waitcnt vmcnt(9)
    v_mfma_f32_16x16x32_bf16 v[136:139], v[168:171], a[36:39], v[136:139]
    v_mul_f32 v214, v214, v222
    v_mul_f32 v215, v215, v223
    v_mfma_f32_16x16x32_bf16 v[144:147], v[168:171], a[100:103], v[144:147]
    v_cvt_pk_bf16_f32 v242, v212, v213
    v_cvt_pk_bf16_f32 v243, v214, v215
    v_mfma_f32_16x16x32_bf16 v[152:155], v[168:171], a[164:167], v[152:155]
    v_min_u32 v240, 0xfffffffe, v240
    v_min_u32 v241, 0xfffffffe, v241
    v_mfma_f32_16x16x32_bf16 v[160:163], v[168:171], a[228:231], v[160:163]
    s_add_u32 s93, s93, 4096
    s_and_b32 s93, s93, 32767
    s_add_u32 s25, s81, s93
    buffer_load_dwordx4 v[168:171], v252, s[4:7], s25 offen offset:0 sc1
    s_waitcnt vmcnt(9)
    v_mfma_f32_16x16x32_bf16 v[140:143], v[172:175], a[36:39], v[140:143]
    v_min_u32 v242, 0xfffffffe, v242
    v_min_u32 v243, 0xfffffffe, v243
    buffer_store_dwordx4 v[240:243], v252, s[4:7], s17 offen offset:0 sc1
    v_mfma_f32_16x16x32_bf16 v[148:151], v[172:175], a[100:103], v[148:151]
    v_mfma_f32_16x16x32_bf16 v[156:159], v[172:175], a[164:167], v[156:159]
    v_mfma_f32_16x16x32_bf16 v[164:167], v[172:175], a[228:231], v[164:167]
    buffer_load_dwordx4 v[172:175], v252, s[4:7], s25 offen offset:1024 sc1
    s_waitcnt vmcnt(10)
    v_mfma_f32_16x16x32_bf16 v[136:139], v[176:179], a[40:43], v[136:139]
    s_lshl_b32 s57, s50, 2
    v_mfma_f32_16x16x32_bf16 v[144:147], v[176:179], a[104:107], v[144:147]
    s_add_u32 s57, s57, s52
    v_mfma_f32_16x16x32_bf16 v[152:155], v[176:179], a[168:171], v[152:155]
    v_mfma_f32_16x16x32_bf16 v[160:163], v[176:179], a[232:235], v[160:163]
    buffer_load_dwordx4 v[176:179], v252, s[4:7], s25 offen offset:2048 sc1
    s_waitcnt vmcnt(10)
    v_mfma_f32_16x16x32_bf16 v[140:143], v[180:183], a[40:43], v[140:143]
    s_cmp_ge_u32 s57, 56
    s_cselect_b32 s58, 229376, 0
    s_mul_i32 s57, s57, 4096
    v_mfma_f32_16x16x32_bf16 v[148:151], v[180:183], a[104:107], v[148:151]
    v_mfma_f32_16x16x32_bf16 v[156:159], v[180:183], a[168:171], v[156:159]
    s_add_u32 s57, s57, s58
    v_mfma_f32_16x16x32_bf16 v[164:167], v[180:183], a[232:235], v[164:167]
    buffer_load_dwordx4 v[180:183], v252, s[4:7], s25 offen offset:3072 sc1
    s_waitcnt vmcnt(10)
    v_mfma_f32_16x16x32_bf16 v[136:139], v[184:187], a[44:47], v[136:139]
    s_add_u32 s57, s57, 229376
    v_mfma_f32_16x16x32_bf16 v[144:147], v[184:187], a[108:111], v[144:147]
    s_cmp_ge_u32 s50, 28
    s_cselect_b32 s57, 1073741824, s57
    v_mfma_f32_16x16x32_bf16 v[152:155], v[184:187], a[172:175], v[152:155]
    s_and_b32 s58, s3, 1
    v_mfma_f32_16x16x32_bf16 v[160:163], v[184:187], a[236:239], v[160:163]
    s_lshl_b32 s93, s94, 13
    s_add_u32 s81, s28, 262144
    s_add_u32 s25, s81, s93
    buffer_load_dwordx4 v[184:187], v252, s[4:7], s25 offen offset:0 sc1
    s_waitcnt vmcnt(10)
    v_mfma_f32_16x16x32_bf16 v[140:143], v[188:191], a[44:47], v[140:143]
    s_lshl_b32 s58, s58, 9
    v_mfma_f32_16x16x32_bf16 v[148:151], v[188:191], a[108:111], v[148:151]
    s_add_u32 s57, s57, s58
    v_mfma_f32_16x16x32_bf16 v[156:159], v[188:191], a[172:175], v[156:159]
    v_mfma_f32_16x16x32_bf16 v[164:167], v[188:191], a[236:239], v[164:167]
    buffer_load_dwordx4 v[188:191], v252, s[4:7], s25 offen offset:1024 sc1
    s_waitcnt vmcnt(10)
    v_mfma_f32_16x16x32_bf16 v[136:139], v[192:195], a[48:51], v[136:139]
    v_lshrrev_b32 v4, 2, v1
    v_and_b32 v5, 3, v1
    v_mfma_f32_16x16x32_bf16 v[144:147], v[192:195], a[112:115], v[144:147]
    v_mfma_f32_16x16x32_bf16 v[152:155], v[192:195], a[176:179], v[152:155]
    v_lshlrev_b32_e64 v5, 7, v5
    v_mfma_f32_16x16x32_bf16 v[160:163], v[192:195], a[240:243], v[160:163]
    buffer_load_dwordx4 v[192:195], v252, s[4:7], s25 offen offset:2048 sc1
    s_waitcnt vmcnt(10)
    v_mfma_f32_16x16x32_bf16 v[140:143], v[196:199], a[48:51], v[140:143]
    v_lshl_add_u32 v4, v4, 10, v5
    v_mfma_f32_16x16x32_bf16 v[148:151], v[196:199], a[112:115], v[148:151]
    v_mfma_f32_16x16x32_bf16 v[156:159], v[196:199], a[176:179], v[156:159]
    s_mov_b64 exec, 0xffff
    buffer_load_dword v254, v4, s[8:11], s57 offen
    s_mov_b64 exec, -1
    v_mfma_f32_16x16x32_bf16 v[164:167], v[196:199], a[240:243], v[164:167]
    buffer_load_dwordx4 v[196:199], v252, s[4:7], s25 offen offset:3072 sc1
    s_waitcnt vmcnt(11)
    v_mfma_f32_16x16x32_bf16 v[136:139], v[200:203], a[52:55], v[136:139]
    v_mfma_f32_16x16x32_bf16 v[144:147], v[200:203], a[116:119], v[144:147]
    v_mfma_f32_16x16x32_bf16 v[152:155], v[200:203], a[180:183], v[152:155]
    v_mfma_f32_16x16x32_bf16 v[160:163], v[200:203], a[244:247], v[160:163]
    s_add_u32 s93, s93, 4096
    s_and_b32 s93, s93, 32767
    s_add_u32 s25, s81, s93
    buffer_load_dwordx4 v[200:203], v252, s[4:7], s25 offen offset:0 sc1
    s_waitcnt vmcnt(11)
    v_mfma_f32_16x16x32_bf16 v[140:143], v[204:207], a[52:55], v[140:143]
    v_mfma_f32_16x16x32_bf16 v[148:151], v[204:207], a[116:119], v[148:151]
    v_mfma_f32_16x16x32_bf16 v[156:159], v[204:207], a[180:183], v[156:159]
    v_mfma_f32_16x16x32_bf16 v[164:167], v[204:207], a[244:247], v[164:167]
    buffer_load_dwordx4 v[204:207], v252, s[4:7], s25 offen offset:1024 sc1
    s_waitcnt vmcnt(11)
    v_mfma_f32_16x16x32_bf16 v[136:139], v[168:171], a[56:59], v[136:139]
    v_mfma_f32_16x16x32_bf16 v[144:147], v[168:171], a[120:123], v[144:147]
    v_mfma_f32_16x16x32_bf16 v[152:155], v[168:171], a[184:187], v[152:155]
    v_mfma_f32_16x16x32_bf16 v[160:163], v[168:171], a[248:251], v[160:163]
    buffer_load_dwordx4 v[168:171], v252, s[4:7], s25 offen offset:2048 sc1
    s_waitcnt vmcnt(10)
    v_mfma_f32_16x16x32_bf16 v[140:143], v[172:175], a[56:59], v[140:143]
    v_mfma_f32_16x16x32_bf16 v[148:151], v[172:175], a[120:123], v[148:151]
    v_mfma_f32_16x16x32_bf16 v[156:159], v[172:175], a[184:187], v[156:159]
    v_mfma_f32_16x16x32_bf16 v[164:167], v[172:175], a[248:251], v[164:167]
    buffer_load_dwordx4 v[172:175], v252, s[4:7], s25 offen offset:3072 sc1
    s_waitcnt vmcnt(10)
    v_mfma_f32_16x16x32_bf16 v[136:139], v[176:179], a[60:63], v[136:139]
    v_mfma_f32_16x16x32_bf16 v[144:147], v[176:179], a[124:127], v[144:147]
    v_mfma_f32_16x16x32_bf16 v[152:155], v[176:179], a[188:191], v[152:155]
    v_mfma_f32_16x16x32_bf16 v[160:163], v[176:179], a[252:255], v[160:163]
    s_add_u32 s93, s93, 4096
    s_and_b32 s93, s93, 32767
    s_add_u32 s25, s81, s93
    buffer_load_dwordx4 v[176:179], v252, s[4:7], s25 offen offset:0 sc1
    s_waitcnt vmcnt(10)
    v_mfma_f32_16x16x32_bf16 v[140:143], v[180:183], a[60:63], v[140:143]
    v_mfma_f32_16x16x32_bf16 v[148:151], v[180:183], a[124:127], v[148:151]
    v_mfma_f32_16x16x32_bf16 v[156:159], v[180:183], a[188:191], v[156:159]
    v_mfma_f32_16x16x32_bf16 v[164:167], v[180:183], a[252:255], v[164:167]
    buffer_load_dwordx4 v[180:183], v252, s[4:7], s25 offen offset:1024 sc1
    s_waitcnt vmcnt(10)
    v_mfma_f32_16x16x32_bf16 v[104:107], v[184:187], a[0:3], v[236:239]
    v_mfma_f32_16x16x32_bf16 v[112:115], v[184:187], a[64:67], 0
    v_mfma_f32_16x16x32_bf16 v[120:123], v[184:187], a[128:131], 0
    v_mfma_f32_16x16x32_bf16 v[128:131], v[184:187], a[192:195], 0
    buffer_load_dwordx4 v[184:187], v252, s[4:7], s25 offen offset:2048 sc1
    s_waitcnt vmcnt(10)
    v_mfma_f32_16x16x32_bf16 v[108:111], v[188:191], a[0:3], v[236:239]
    s_barrier
    v_mfma_f32_16x16x32_bf16 v[116:119], v[188:191], a[64:67], 0
    v_mfma_f32_16x16x32_bf16 v[124:127], v[188:191], a[128:131], 0
    v_mfma_f32_16x16x32_bf16 v[132:135], v[188:191], a[192:195], 0
    buffer_load_dwordx4 v[188:191], v252, s[4:7], s25 offen offset:3072 sc1
    s_waitcnt vmcnt(10)
    v_mfma_f32_16x16x32_bf16 v[104:107], v[192:195], a[4:7], v[104:107]
    ds_write_b128 v28, v[144:147] offset:0
    v_mfma_f32_16x16x32_bf16 v[112:115], v[192:195], a[68:71], v[112:115]
    v_mfma_f32_16x16x32_bf16 v[120:123], v[192:195], a[132:135], v[120:123]
    ds_write_b128 v28, v[148:151] offset:1024
    v_mfma_f32_16x16x32_bf16 v[128:131], v[192:195], a[196:199], v[128:131]
    s_add_u32 s93, s93, 4096
    s_and_b32 s93, s93, 32767
    s_add_u32 s25, s81, s93
    buffer_load_dwordx4 v[192:195], v252, s[4:7], s25 offen offset:0 sc1
    s_waitcnt vmcnt(9)
    v_mfma_f32_16x16x32_bf16 v[108:111], v[196:199], a[4:7], v[108:111]
    v_mfma_f32_16x16x32_bf16 v[116:119], v[196:199], a[68:71], v[116:119]
    ds_write_b128 v29, v[152:155] offset:0
    v_mfma_f32_16x16x32_bf16 v[124:127], v[196:199], a[132:135], v[124:127]
    v_mfma_f32_16x16x32_bf16 v[132:135], v[196:199], a[196:199], v[132:135]
    buffer_load_dwordx4 v[196:199], v252, s[4:7], s25 offen offset:1024 sc1
    s_waitcnt vmcnt(9)
    v_mfma_f32_16x16x32_bf16 v[104:107], v[200:203], a[8:11], v[104:107]
    ds_write_b128 v29, v[156:159] offset:1024
    v_mfma_f32_16x16x32_bf16 v[112:115], v[200:203], a[72:75], v[112:115]
    v_mfma_f32_16x16x32_bf16 v[120:123], v[200:203], a[136:139], v[120:123]
    v_mfma_f32_16x16x32_bf16 v[128:131], v[200:203], a[200:203], v[128:131]
    buffer_load_dwordx4 v[200:203], v252, s[4:7], s25 offen offset:2048 sc1
    s_waitcnt vmcnt(9)
    v_mfma_f32_16x16x32_bf16 v[108:111], v[204:207], a[8:11], v[108:111]
    ds_write_b128 v30, v[160:163] offset:0
    v_mfma_f32_16x16x32_bf16 v[116:119], v[204:207], a[72:75], v[116:119]
    v_mfma_f32_16x16x32_bf16 v[124:127], v[204:207], a[136:139], v[124:127]
    ds_write_b128 v30, v[164:167] offset:1024
    v_mfma_f32_16x16x32_bf16 v[132:135], v[204:207], a[200:203], v[132:135]
    buffer_load_dwordx4 v[204:207], v252, s[4:7], s25 offen offset:3072 sc1
    s_waitcnt vmcnt(9)
    v_mfma_f32_16x16x32_bf16 v[104:107], v[168:171], a[12:15], v[104:107]
    v_mfma_f32_16x16x32_bf16 v[112:115], v[168:171], a[76:79], v[112:115]
    v_mfma_f32_16x16x32_bf16 v[120:123], v[168:171], a[140:143], v[120:123]
    v_mfma_f32_16x16x32_bf16 v[128:131], v[168:171], a[204:207], v[128:131]
    s_add_u32 s93, s93, 4096
    s_and_b32 s93, s93, 32767
    s_add_u32 s25, s81, s93
    buffer_load_dwordx4 v[168:171], v252, s[4:7], s25 offen offset:0 sc1
    s_waitcnt vmcnt(9)
    v_mfma_f32_16x16x32_bf16 v[108:111], v[172:175], a[12:15], v[108:111]
    s_waitcnt lgkmcnt(0)
    s_barrier
    v_mfma_f32_16x16x32_bf16 v[116:119], v[172:175], a[76:79], v[116:119]
    ds_read_b128 v[208:211], v19 offset:0
    v_mfma_f32_16x16x32_bf16 v[124:127], v[172:175], a[140:143], v[124:127]
    ds_read_b128 v[216:219], v19 offset:2048
    v_mfma_f32_16x16x32_bf16 v[132:135], v[172:175], a[204:207], v[132:135]
    buffer_load_dwordx4 v[172:175], v252, s[4:7], s25 offen offset:1024 sc1
    s_waitcnt vmcnt(9)
    v_mfma_f32_16x16x32_bf16 v[104:107], v[176:179], a[16:19], v[104:107]
    ds_read_b128 v[224:227], v19 offset:4096
    v_mfma_f32_16x16x32_bf16 v[112:115], v[176:179], a[80:83], v[112:115]
    ds_read_b128 v[212:215], v19 offset:1024
    v_mfma_f32_16x16x32_bf16 v[120:123], v[176:179], a[144:147], v[120:123]
    v_mfma_f32_16x16x32_bf16 v[128:131], v[176:179], a[208:211], v[128:131]
    buffer_load_dwordx4 v[176:179], v252, s[4:7], s25 offen offset:2048 sc1
    s_waitcnt vmcnt(9)
    v_mfma_f32_16x16x32_bf16 v[108:111], v[180:183], a[16:19], v[108:111]
    ds_read_b128 v[220:223], v19 offset:3072
    v_mfma_f32_16x16x32_bf16 v[116:119], v[180:183], a[80:83], v[116:119]
    ds_read_b128 v[228:231], v19 offset:5120
    v_mfma_f32_16x16x32_bf16 v[124:127], v[180:183], a[144:147], v[124:127]
    ds_read_b64 v[232:233], v31 offset:1024
    v_mfma_f32_16x16x32_bf16 v[132:135], v[180:183], a[208:211], v[132:135]
    buffer_load_dwordx4 v[180:183], v252, s[4:7], s25 offen offset:3072 sc1
    s_waitcnt vmcnt(9)
    v_mfma_f32_16x16x32_bf16 v[104:107], v[184:187], a[20:23], v[104:107]
    ds_read_b64 v[234:235], v31 offset:1536
    v_mfma_f32_16x16x32_bf16 v[112:115], v[184:187], a[84:87], v[112:115]
    v_mfma_f32_16x16x32_bf16 v[120:123], v[184:187], a[148:151], v[120:123]
    v_mfma_f32_16x16x32_bf16 v[128:131], v[184:187], a[212:215], v[128:131]
    s_add_u32 s93, s93, 4096
    s_and_b32 s93, s93, 32767
    s_add_u32 s25, s81, s93
    buffer_load_dwordx4 v[184:187], v252, s[4:7], s25 offen offset:0 sc1
    s_waitcnt vmcnt(9)
    v_mfma_f32_16x16x32_bf16 v[108:111], v[188:191], a[20:23], v[108:111]
    v_mfma_f32_16x16x32_bf16 v[116:119], v[188:191], a[84:87], v[116:119]
    v_mfma_f32_16x16x32_bf16 v[124:127], v[188:191], a[148:151], v[124:127]
    s_waitcnt lgkmcnt(6)
    v_add_f32 v208, v208, v216
    v_add_f32_e64 v209, v209, v217
    v_mfma_f32_16x16x32_bf16 v[132:135], v[188:191], a[212:215], v[132:135]
    buffer_load_dwordx4 v[188:191], v252, s[4:7], s25 offen offset:1024 sc1
    s_waitcnt vmcnt(9)
    v_mfma_f32_16x16x32_bf16 v[104:107], v[192:195], a[24:27], v[104:107]
    v_add_f32 v210, v210, v218
    v_add_f32_e64 v211, v211, v219
    v_mfma_f32_16x16x32_bf16 v[112:115], v[192:195], a[88:91], v[112:115]
    s_waitcnt lgkmcnt(5)
    v_add_f32 v224, v224, v136
    v_add_f32_e64 v225, v225, v137
    v_mfma_f32_16x16x32_bf16 v[120:123], v[192:195], a[152:155], v[120:123]
    v_add_f32 v226, v226, v138
    v_add_f32 v227, v227, v139
    v_mfma_f32_16x16x32_bf16 v[128:131], v[192:195], a[216:219], v[128:131]
    buffer_load_dwordx4 v[192:195], v252, s[4:7], s25 offen offset:2048 sc1
    s_waitcnt vmcnt(9)
    v_mfma_f32_16x16x32_bf16 v[108:111], v[196:199], a[24:27], v[108:111]
    s_waitcnt lgkmcnt(1)
    v_lshlrev_b32_e64 v216, 16, v232
    v_and_b32 v217, 0xffff0000, v232
    v_mfma_f32_16x16x32_bf16 v[116:119], v[196:199], a[88:91], v[116:119]
    v_lshlrev_b32_e64 v218, 16, v233
    v_and_b32 v219, 0xffff0000, v233
    v_mfma_f32_16x16x32_bf16 v[124:127], v[196:199], a[152:155], v[124:127]
    v_add_f32 v208, v208, v224
    v_add_f32 v209, v209, v225
    v_mfma_f32_16x16x32_bf16 v[132:135], v[196:199], a[216:219], v[132:135]
    buffer_load_dwordx4 v[196:199], v252, s[4:7], s25 offen offset:3072 sc1
    s_waitcnt vmcnt(9)
    v_mfma_f32_16x16x32_bf16 v[104:107], v[200:203], a[28:31], v[104:107]
    v_add_f32 v210, v210, v226
    v_add_f32_e64 v211, v211, v227
    v_mfma_f32_16x16x32_bf16 v[112:115], v[200:203], a[92:95], v[112:115]
    v_mul_f32 v208, v208, v216
    v_mul_f32 v209, v209, v217
    v_mfma_f32_16x16x32_bf16 v[120:123], v[200:203], a[156:159], v[120:123]
    v_mul_f32 v210, v210, v218
    v_mul_f32 v211, v211, v219
    v_mfma_f32_16x16x32_bf16 v[128:131], v[200:203], a[220:223], v[128:131]
    s_add_u32 s93, s93, 4096
    s_and_b32 s93, s93, 32767
    s_add_u32 s25, s81, s93
    buffer_load_dwordx4 v[200:203], v252, s[4:7], s25 offen offset:0 sc1
    v_cvt_pk_bf16_f32 v240, v208, v209
    s_waitcnt vmcnt(9)
    v_mfma_f32_16x16x32_bf16 v[108:111], v[204:207], a[28:31], v[108:111]
    v_cvt_pk_bf16_f32 v241, v210, v211
    v_add_f32_e64 v212, v212, v220
    v_mfma_f32_16x16x32_bf16 v[116:119], v[204:207], a[92:95], v[116:119]
    v_add_f32 v213, v213, v221
    v_add_f32 v214, v214, v222
    v_mfma_f32_16x16x32_bf16 v[124:127], v[204:207], a[156:159], v[124:127]
    v_add_f32 v215, v215, v223
    v_add_f32 v228, v228, v140
    v_mfma_f32_16x16x32_bf16 v[132:135], v[204:207], a[220:223], v[132:135]
    buffer_load_dwordx4 v[204:207], v252, s[4:7], s25 offen offset:1024 sc1
    s_waitcnt vmcnt(9)
    v_mfma_f32_16x16x32_bf16 v[104:107], v[168:171], a[32:35], v[104:107]
    v_add_f32 v229, v229, v141
    v_add_f32_e64 v230, v230, v142
    v_mfma_f32_16x16x32_bf16 v[112:115], v[168:171], a[96:99], v[112:115]
    v_add_f32 v231, v231, v143
    s_waitcnt lgkmcnt(0)
    v_lshlrev_b32_e64 v220, 16, v234
    v_mfma_f32_16x16x32_bf16 v[120:123], v[168:171], a[160:163], v[120:123]
    v_and_b32 v221, 0xffff0000, v234
    v_lshlrev_b32_e64 v222, 16, v235
    v_mfma_f32_16x16x32_bf16 v[128:131], v[168:171], a[224:227], v[128:131]
    buffer_load_dwordx4 v[168:171], v252, s[4:7], s25 offen offset:2048 sc1
    s_waitcnt vmcnt(9)
    v_mfma_f32_16x16x32_bf16 v[108:111], v[172:175], a[32:35], v[108:111]
    v_and_b32 v223, 0xffff0000, v235
    v_add_f32 v212, v212, v228
    v_mfma_f32_16x16x32_bf16 v[116:119], v[172:175], a[96:99], v[116:119]
    v_add_f32 v213, v213, v229
    v_add_f32 v214, v214, v230
    v_mfma_f32_16x16x32_bf16 v[124:127], v[172:175], a[160:163], v[124:127]
    v_add_f32 v215, v215, v231
    v_mul_f32 v212, v212, v220
    v_mfma_f32_16x16x32_bf16 v[132:135], v[172:175], a[224:227], v[132:135]
    buffer_load_dwordx4 v[172:175], v252, s[4:7], s25 offen offset:3072 sc1
    v_mul_f32 v213, v213, v221
    s_waitcnt vmcnt(9)
    v_mfma_f32_16x16x32_bf16 v[104:107], v[176:179], a[36:39], v[104:107]
    v_mul_f32 v214, v214, v222
    v_mul_f32 v215, v215, v223
    v_mfma_f32_16x16x32_bf16 v[112:115], v[176:179], a[100:103], v[112:115]
    v_cvt_pk_bf16_f32 v242, v212, v213
    v_cvt_pk_bf16_f32 v243, v214, v215
    v_mfma_f32_16x16x32_bf16 v[120:123], v[176:179], a[164:167], v[120:123]
    v_min_u32 v240, 0xfffffffe, v240
    v_min_u32 v241, 0xfffffffe, v241
    v_mfma_f32_16x16x32_bf16 v[128:131], v[176:179], a[228:231], v[128:131]
    s_add_u32 s93, s93, 4096
    s_and_b32 s93, s93, 32767
    s_add_u32 s25, s81, s93
    buffer_load_dwordx4 v[176:179], v252, s[4:7], s25 offen offset:0 sc1
    s_waitcnt vmcnt(9)
    v_mfma_f32_16x16x32_bf16 v[108:111], v[180:183], a[36:39], v[108:111]
    v_min_u32 v242, 0xfffffffe, v242
    v_min_u32 v243, 0xfffffffe, v243
    buffer_store_dwordx4 v[240:243], v252, s[4:7], s17 offen offset:1024 sc1
    v_mfma_f32_16x16x32_bf16 v[116:119], v[180:183], a[100:103], v[116:119]
    v_mfma_f32_16x16x32_bf16 v[124:127], v[180:183], a[164:167], v[124:127]
    v_mfma_f32_16x16x32_bf16 v[132:135], v[180:183], a[228:231], v[132:135]
    buffer_load_dwordx4 v[180:183], v252, s[4:7], s25 offen offset:1024 sc1
    s_waitcnt vmcnt(10)
    v_mfma_f32_16x16x32_bf16 v[104:107], v[184:187], a[40:43], v[104:107]
    v_mfma_f32_16x16x32_bf16 v[112:115], v[184:187], a[104:107], v[112:115]
    v_mfma_f32_16x16x32_bf16 v[120:123], v[184:187], a[168:171], v[120:123]
    v_mfma_f32_16x16x32_bf16 v[128:131], v[184:187], a[232:235], v[128:131]
    buffer_load_dwordx4 v[184:187], v252, s[4:7], s25 offen offset:2048 sc1
    s_waitcnt vmcnt(10)
    v_mfma_f32_16x16x32_bf16 v[108:111], v[188:191], a[40:43], v[108:111]
    v_mfma_f32_16x16x32_bf16 v[116:119], v[188:191], a[104:107], v[116:119]
    v_mfma_f32_16x16x32_bf16 v[124:127], v[188:191], a[168:171], v[124:127]
    v_mfma_f32_16x16x32_bf16 v[132:135], v[188:191], a[232:235], v[132:135]
    buffer_load_dwordx4 v[188:191], v252, s[4:7], s25 offen offset:3072 sc1
    s_waitcnt vmcnt(10)
    v_mfma_f32_16x16x32_bf16 v[104:107], v[192:195], a[44:47], v[104:107]
    v_mfma_f32_16x16x32_bf16 v[112:115], v[192:195], a[108:111], v[112:115]
    v_mfma_f32_16x16x32_bf16 v[120:123], v[192:195], a[172:175], v[120:123]
    v_mfma_f32_16x16x32_bf16 v[128:131], v[192:195], a[236:239], v[128:131]
    s_lshl_b32 s57, s52, 14
    s_sub_u32 s28, s28, s57
    s_lshl_b32 s93, s94, 12
    s_add_u32 s81, s28, 393216
    s_add_u32 s25, s81, s93
    buffer_load_dwordx4 v[192:195], v252, s[4:7], s25 offen offset:0 sc1
    s_waitcnt vmcnt(10)
    v_mfma_f32_16x16x32_bf16 v[108:111], v[196:199], a[44:47], v[108:111]
    v_mfma_f32_16x16x32_bf16 v[116:119], v[196:199], a[108:111], v[116:119]
    v_mfma_f32_16x16x32_bf16 v[124:127], v[196:199], a[172:175], v[124:127]
    v_mfma_f32_16x16x32_bf16 v[132:135], v[196:199], a[236:239], v[132:135]
    buffer_load_dwordx4 v[196:199], v252, s[4:7], s25 offen offset:1024 sc1
    s_waitcnt vmcnt(10)
    v_mfma_f32_16x16x32_bf16 v[104:107], v[200:203], a[48:51], v[104:107]
    v_mfma_f32_16x16x32_bf16 v[112:115], v[200:203], a[112:115], v[112:115]
    v_mfma_f32_16x16x32_bf16 v[120:123], v[200:203], a[176:179], v[120:123]
    v_mfma_f32_16x16x32_bf16 v[128:131], v[200:203], a[240:243], v[128:131]
    buffer_load_dwordx4 v[200:203], v252, s[4:7], s25 offen offset:2048 sc1
    s_waitcnt vmcnt(10)
    v_mfma_f32_16x16x32_bf16 v[108:111], v[204:207], a[48:51], v[108:111]
    v_mfma_f32_16x16x32_bf16 v[116:119], v[204:207], a[112:115], v[116:119]
    v_mfma_f32_16x16x32_bf16 v[124:127], v[204:207], a[176:179], v[124:127]
    v_mfma_f32_16x16x32_bf16 v[132:135], v[204:207], a[240:243], v[132:135]
    buffer_load_dwordx4 v[204:207], v252, s[4:7], s25 offen offset:3072 sc1
    s_waitcnt vmcnt(10)
    v_mfma_f32_16x16x32_bf16 v[104:107], v[168:171], a[52:55], v[104:107]
    s_add_u32 s57, s52, 0
    s_and_b32 s57, s57, 3
    v_mfma_f32_16x16x32_bf16 v[112:115], v[168:171], a[116:119], v[112:115]
    s_sub_u32 s57, s57, s52
    v_mfma_f32_16x16x32_bf16 v[120:123], v[168:171], a[180:183], v[120:123]
    s_mul_i32 s57, s57, 28672
    v_mfma_f32_16x16x32_bf16 v[128:131], v[168:171], a[244:247], v[128:131]
    s_add_u32 s93, s93, 4096
    s_and_b32 s93, s93, 16383
    s_add_u32 s25, s81, s93
    buffer_load_dwordx4 v[168:171], v252, s[4:7], s25 offen offset:0 sc1
    s_waitcnt vmcnt(10)
    v_mfma_f32_16x16x32_bf16 v[108:111], v[172:175], a[52:55], v[108:111]
    s_add_u32 s57, s57, s29
    s_add_u32 s88, s57, s19
    s_add_u32 s61, s88, 3584
    v_mfma_f32_16x16x32_bf16 v[116:119], v[172:175], a[116:119], v[116:119]
    s_add_u32 s57, s52, 1
    v_mfma_f32_16x16x32_bf16 v[124:127], v[172:175], a[180:183], v[124:127]
    s_and_b32 s57, s57, 3
    v_mfma_f32_16x16x32_bf16 v[132:135], v[172:175], a[244:247], v[132:135]
    buffer_load_dwordx4 v[172:175], v252, s[4:7], s25 offen offset:1024 sc1
    s_waitcnt vmcnt(10)
    v_mfma_f32_16x16x32_bf16 v[104:107], v[176:179], a[56:59], v[104:107]
    s_sub_u32 s57, s57, s52
    s_mul_i32 s57, s57, 28672
    v_mfma_f32_16x16x32_bf16 v[112:115], v[176:179], a[120:123], v[112:115]
    s_add_u32 s57, s57, s29
    s_add_u32 s89, s57, s19
    v_mfma_f32_16x16x32_bf16 v[120:123], v[176:179], a[184:187], v[120:123]
    s_add_u32 s64, s89, 3584
    v_mfma_f32_16x16x32_bf16 v[128:131], v[176:179], a[248:251], v[128:131]
    buffer_load_dwordx4 v[176:179], v252, s[4:7], s25 offen offset:2048 sc1
    s_waitcnt vmcnt(9)
    v_mfma_f32_16x16x32_bf16 v[108:111], v[180:183], a[56:59], v[108:111]
    s_add_u32 s57, s52, 2
    s_and_b32 s57, s57, 3
    v_mfma_f32_16x16x32_bf16 v[116:119], v[180:183], a[120:123], v[116:119]
    s_sub_u32 s57, s57, s52
    s_mul_i32 s57, s57, 28672
    v_mfma_f32_16x16x32_bf16 v[124:127], v[180:183], a[184:187], v[124:127]
    s_add_u32 s57, s57, s29
    v_mfma_f32_16x16x32_bf16 v[132:135], v[180:183], a[248:251], v[132:135]
    buffer_load_dwordx4 v[180:183], v252, s[4:7], s25 offen offset:3072 sc1
    s_waitcnt vmcnt(9)
    v_mfma_f32_16x16x32_bf16 v[104:107], v[184:187], a[60:63], v[104:107]
    s_add_u32 s90, s57, s19
    s_add_u32 s65, s90, 3584
    v_mfma_f32_16x16x32_bf16 v[112:115], v[184:187], a[124:127], v[112:115]
    s_add_u32 s57, s52, 3
    v_mfma_f32_16x16x32_bf16 v[120:123], v[184:187], a[188:191], v[120:123]
    s_and_b32 s57, s57, 3
    s_sub_u32 s57, s57, s52
    v_mfma_f32_16x16x32_bf16 v[128:131], v[184:187], a[252:255], v[128:131]
    s_add_u32 s93, s93, 4096
    s_and_b32 s93, s93, 16383
    s_add_u32 s25, s81, s93
    buffer_load_dwordx4 v[184:187], v252, s[4:7], s25 offen offset:0 sc1
    s_waitcnt vmcnt(9)
    v_mfma_f32_16x16x32_bf16 v[108:111], v[188:191], a[60:63], v[108:111]
    s_mul_i32 s57, s57, 28672
    s_add_u32 s57, s57, s29
    v_mfma_f32_16x16x32_bf16 v[116:119], v[188:191], a[124:127], v[116:119]
    s_add_u32 s91, s57, s19
    v_mfma_f32_16x16x32_bf16 v[124:127], v[188:191], a[188:191], v[124:127]
    s_add_u32 s66, s91, 3584
    v_mfma_f32_16x16x32_bf16 v[132:135], v[188:191], a[252:255], v[132:135]
    buffer_load_dwordx4 v[188:191], v252, s[4:7], s25 offen offset:1024 sc1
    s_waitcnt vmcnt(9)
    v_mfma_f32_16x16x32_bf16 v[136:139], v[192:195], a[0:3], v[236:239]
    v_mfma_f32_16x16x32_bf16 v[144:147], v[192:195], a[64:67], 0
    v_mfma_f32_16x16x32_bf16 v[152:155], v[192:195], a[128:131], 0
    v_mfma_f32_16x16x32_bf16 v[160:163], v[192:195], a[192:195], 0
    buffer_load_dwordx4 v[192:195], v252, s[4:7], s25 offen offset:2048 sc1
    s_waitcnt vmcnt(9)
    v_mfma_f32_16x16x32_bf16 v[136:139], v[196:199], a[4:7], v[136:139]
    s_barrier
    v_mfma_f32_16x16x32_bf16 v[144:147], v[196:199], a[68:71], v[144:147]
    ds_write_b128 v28, v[112:115] offset:0
    v_mfma_f32_16x16x32_bf16 v[152:155], v[196:199], a[132:135], v[152:155]
    s_add_u32 m0, s19, 28672
    s_add_u32 s58, s26, 229376
    buffer_load_dwordx4 v18, s[8:11], s58 offen offset:0 lds
    v_mfma_f32_16x16x32_bf16 v[160:163], v[196:199], a[196:199], v[160:163]
    buffer_load_dwordx4 v[196:199], v252, s[4:7], s25 offen offset:3072 sc1
    s_waitcnt vmcnt(10)
    v_mfma_f32_16x16x32_bf16 v[136:139], v[200:203], a[8:11], v[136:139]
    ds_write_b128 v28, v[116:119] offset:1024
    v_mfma_f32_16x16x32_bf16 v[144:147], v[200:203], a[72:75], v[144:147]
    s_add_u32 s58, s26, 236544
    buffer_load_dwordx4 v18, s[8:11], s58 offen offset:1024 lds
    v_mfma_f32_16x16x32_bf16 v[152:155], v[200:203], a[136:139], v[152:155]
    ds_write_b128 v29, v[120:123] offset:0
    v_mfma_f32_16x16x32_bf16 v[160:163], v[200:203], a[200:203], v[160:163]
    ds_write_b128 v29, v[124:127] offset:1024
    s_add_u32 s93, s93, 4096
    s_and_b32 s93, s93, 16383
    s_add_u32 s25, s81, s93
    buffer_load_dwordx4 v[200:203], v252, s[4:7], s25 offen offset:0 sc1
    s_waitcnt vmcnt(11)
    v_mfma_f32_16x16x32_bf16 v[136:139], v[204:207], a[12:15], v[136:139]
    s_add_u32 s58, s26, 243712
    buffer_load_dwordx4 v18, s[8:11], s58 offen offset:2048 lds
    v_mfma_f32_16x16x32_bf16 v[144:147], v[204:207], a[76:79], v[144:147]
    ds_write_b128 v30, v[128:131] offset:0
    v_mfma_f32_16x16x32_bf16 v[152:155], v[204:207], a[140:143], v[152:155]
    s_add_u32 s58, s26, 250880
    buffer_load_dwordx4 v18, s[8:11], s58 offen offset:3072 lds
    ds_write_b128 v30, v[132:135] offset:1024
    v_mfma_f32_16x16x32_bf16 v[160:163], v[204:207], a[204:207], v[160:163]
    buffer_load_dwordx4 v[204:207], v252, s[4:7], s25 offen offset:1024 sc1
    s_waitcnt vmcnt(13)
    v_mfma_f32_16x16x32_bf16 v[136:139], v[168:171], a[16:19], v[136:139]
    v_mfma_f32_16x16x32_bf16 v[144:147], v[168:171], a[80:83], v[144:147]
    s_add_u32 m0, s19, 32768
    s_add_u32 s58, s26, 262144
    buffer_load_dwordx4 v18, s[8:11], s58 offen offset:0 lds
    v_mfma_f32_16x16x32_bf16 v[152:155], v[168:171], a[144:147], v[152:155]
    s_waitcnt lgkmcnt(0)
    s_barrier
    v_mfma_f32_16x16x32_bf16 v[160:163], v[168:171], a[208:211], v[160:163]
    ds_read_b128 v[208:211], v19 offset:0
    buffer_load_dwordx4 v[168:171], v252, s[4:7], s25 offen offset:2048 sc1
    s_waitcnt vmcnt(14)
    v_mfma_f32_16x16x32_bf16 v[136:139], v[172:175], a[20:23], v[136:139]
    ds_read_b128 v[216:219], v19 offset:2048
    v_mfma_f32_16x16x32_bf16 v[144:147], v[172:175], a[84:87], v[144:147]
    s_add_u32 s58, s26, 269312
    buffer_load_dwordx4 v18, s[8:11], s58 offen offset:1024 lds
    v_mfma_f32_16x16x32_bf16 v[152:155], v[172:175], a[148:151], v[152:155]
    ds_read_b128 v[224:227], v19 offset:4096
    v_mfma_f32_16x16x32_bf16 v[160:163], v[172:175], a[212:215], v[160:163]
    ds_read_b128 v[212:215], v19 offset:1024
    buffer_load_dwordx4 v[172:175], v252, s[4:7], s25 offen offset:3072 sc1
    s_waitcnt vmcnt(15)
    v_mfma_f32_16x16x32_bf16 v[136:139], v[176:179], a[24:27], v[136:139]
    ds_read_b128 v[220:223], v19 offset:3072
    v_mfma_f32_16x16x32_bf16 v[144:147], v[176:179], a[88:91], v[144:147]
    s_nop 0
    ds_read_b128 v[228:231], v19 offset:5120
    s_add_u32 s58, s26, 276480
    buffer_load_dwordx4 v18, s[8:11], s58 offen offset:2048 lds
    ds_read_b64 v[232:233], v31 offset:2048
    ds_read_b64 v[234:235], v31 offset:2560
    v_mfma_f32_16x16x32_bf16 v[152:155], v[176:179], a[152:155], v[152:155]
    s_add_u32 m0, s19, 86016
    s_add_u32 s58, s26, 688128
    buffer_load_dwordx4 v18, s[8:11], s58 offen offset:0 lds
    v_mfma_f32_16x16x32_bf16 v[160:163], v[176:179], a[216:219], v[160:163]
    s_waitcnt vmcnt(16)
    v_mfma_f32_16x16x32_bf16 v[136:139], v[180:183], a[28:31], v[136:139]
    s_add_u32 s58, s26, 695296
    buffer_load_dwordx4 v18, s[8:11], s58 offen offset:1024 lds
    v_mfma_f32_16x16x32_bf16 v[144:147], v[180:183], a[92:95], v[144:147]
    v_mfma_f32_16x16x32_bf16 v[152:155], v[180:183], a[156:159], v[152:155]
    s_waitcnt lgkmcnt(6)
    v_add_f32 v208, v208, v216
    v_add_f32 v209, v209, v217
    v_mfma_f32_16x16x32_bf16 v[160:163], v[180:183], a[220:223], v[160:163]
    s_add_u32 s58, s26, 702464
    buffer_load_dwordx4 v18, s[8:11], s58 offen offset:2048 lds
    v_add_f32 v210, v210, v218
    s_waitcnt vmcnt(17)
    v_mfma_f32_16x16x32_bf16 v[136:139], v[184:187], a[32:35], v[136:139]
    v_add_f32 v211, v211, v219
    s_waitcnt lgkmcnt(5)
    v_add_f32_e64 v224, v224, v104
    v_mfma_f32_16x16x32_bf16 v[144:147], v[184:187], a[96:99], v[144:147]
    s_add_u32 s58, s26, 709632
    buffer_load_dwordx4 v18, s[8:11], s58 offen offset:3072 lds
    v_add_f32 v225, v225, v105
    v_add_f32 v226, v226, v106
    v_mfma_f32_16x16x32_bf16 v[152:155], v[184:187], a[160:163], v[152:155]
    v_add_f32 v227, v227, v107
    s_waitcnt lgkmcnt(1)
    v_lshlrev_b32_e64 v216, 16, v232
    v_mfma_f32_16x16x32_bf16 v[160:163], v[184:187], a[224:227], v[160:163]
    v_and_b32 v217, 0xffff0000, v232
    v_lshlrev_b32 v218, 16, v233
    s_waitcnt vmcnt(17)
    v_mfma_f32_16x16x32_bf16 v[136:139], v[188:191], a[36:39], v[136:139]
    s_add_u32 m0, s19, 90112
    s_add_u32 s58, s26, 720896
    buffer_load_dwordx4 v18, s[8:11], s58 offen offset:0 lds
    v_and_b32 v219, 0xffff0000, v233
    v_add_f32_e64 v208, v208, v224
    v_mfma_f32_16x16x32_bf16 v[144:147], v[188:191], a[100:103], v[144:147]
    v_add_f32 v209, v209, v225
    v_add_f32 v210, v210, v226
    v_add_f32_e64 v211, v211, v227
    v_mfma_f32_16x16x32_bf16 v[152:155], v[188:191], a[164:167], v[152:155]
    v_mul_f32 v208, v208, v216
    v_mul_f32 v209, v209, v217
    v_mfma_f32_16x16x32_bf16 v[160:163], v[188:191], a[228:231], v[160:163]
    s_add_u32 s58, s26, 728064
    buffer_load_dwordx4 v18, s[8:11], s58 offen offset:1024 lds
    v_mul_f32 v210, v210, v218
    v_mul_f32_e64 v211, v211, v219
    s_waitcnt vmcnt(18)
    v_mfma_f32_16x16x32_bf16 v[136:139], v[192:195], a[40:43], v[136:139]
    v_cvt_pk_bf16_f32 v240, v208, v209
    v_cvt_pk_bf16_f32 v241, v210, v211
    v_mfma_f32_16x16x32_bf16 v[144:147], v[192:195], a[104:107], v[144:147]
    v_add_f32 v212, v212, v220
    v_add_f32 v213, v213, v221
    v_mfma_f32_16x16x32_bf16 v[152:155], v[192:195], a[168:171], v[152:155]
    s_add_u32 s58, s26, 735232
    buffer_load_dwordx4 v18, s[8:11], s58 offen offset:2048 lds
    v_add_f32 v214, v214, v222
    v_add_f32 v215, v215, v223
    v_mfma_f32_16x16x32_bf16 v[160:163], v[192:195], a[232:235], v[160:163]
    buffer_load_dwordx4 v[40:43], v252, s[4:7], s88 offen offset:0 sc1
    v_add_f32 v228, v228, v108
    v_add_f32_e64 v229, v229, v109
    s_waitcnt vmcnt(18)
    v_mfma_f32_16x16x32_bf16 v[136:139], v[196:199], a[44:47], v[136:139]
    buffer_load_dwordx4 v[48:51], v252, s[4:7], s89 offen offset:0 sc1
    v_add_f32 v230, v230, v110
    v_add_f32 v231, v231, v111
    v_mfma_f32_16x16x32_bf16 v[144:147], v[196:199], a[108:111], v[144:147]
    s_waitcnt lgkmcnt(0)
    v_lshlrev_b32 v220, 16, v234
    v_and_b32 v221, 0xffff0000, v234
    v_lshlrev_b32_e64 v222, 16, v235
    v_mfma_f32_16x16x32_bf16 v[152:155], v[196:199], a[172:175], v[152:155]
    v_and_b32 v223, 0xffff0000, v235
    v_add_f32_e64 v212, v212, v228
    v_mfma_f32_16x16x32_bf16 v[160:163], v[196:199], a[236:239], v[160:163]
    buffer_load_dwordx4 v[56:59], v252, s[4:7], s90 offen offset:0 sc1
    v_add_f32 v213, v213, v229
    v_add_f32_e64 v214, v214, v230
    s_waitcnt vmcnt(18)
    v_mfma_f32_16x16x32_bf16 v[136:139], v[200:203], a[48:51], v[136:139]
    v_add_f32 v215, v215, v231
    v_mul_f32 v212, v212, v220
    v_mfma_f32_16x16x32_bf16 v[144:147], v[200:203], a[112:115], v[144:147]
    v_mul_f32 v213, v213, v221
    v_mul_f32 v214, v214, v222
    v_mfma_f32_16x16x32_bf16 v[152:155], v[200:203], a[176:179], v[152:155]
    buffer_load_dwordx4 v[64:67], v252, s[4:7], s91 offen offset:0 sc1
    v_mul_f32_e64 v215, v215, v223
    v_cvt_pk_bf16_f32 v242, v212, v213
    v_mfma_f32_16x16x32_bf16 v[160:163], v[200:203], a[240:243], v[160:163]
    v_cvt_pk_bf16_f32 v243, v214, v215
    v_min_u32 v240, 0xfffffffe, v240
    s_waitcnt vmcnt(16)
    v_mfma_f32_16x16x32_bf16 v[136:139], v[204:207], a[52:55], v[136:139]
    v_min_u32 v241, 0xfffffffe, v241
    v_min_u32 v242, 0xfffffffe, v242
    v_min_u32_e64 v243, 0xfffffffe, v243
    buffer_store_dwordx4 v[240:243], v252, s[4:7], s17 offen offset:2048 sc1
    v_mfma_f32_16x16x32_bf16 v[144:147], v[204:207], a[116:119], v[144:147]
    buffer_load_dwordx4 v[44:47], v252, s[4:7], s61 offen offset:0 sc1
    v_mfma_f32_16x16x32_bf16 v[152:155], v[204:207], a[180:183], v[152:155]
    v_mfma_f32_16x16x32_bf16 v[160:163], v[204:207], a[244:247], v[160:163]
    buffer_load_dwordx4 v[52:55], v252, s[4:7], s64 offen offset:0 sc1
    s_waitcnt vmcnt(17)
    v_mfma_f32_16x16x32_bf16 v[136:139], v[168:171], a[56:59], v[136:139]
    v_mfma_f32_16x16x32_bf16 v[144:147], v[168:171], a[120:123], v[144:147]
    v_mfma_f32_16x16x32_bf16 v[152:155], v[168:171], a[184:187], v[152:155]
    s_barrier
    v_mfma_f32_16x16x32_bf16 v[160:163], v[168:171], a[248:251], v[160:163]
    buffer_load_dwordx4 v[60:63], v252, s[4:7], s65 offen offset:0 sc1
    s_waitcnt vmcnt(16)
    v_mfma_f32_16x16x32_bf16 v[136:139], v[172:175], a[60:63], v[136:139]
    v_mfma_f32_16x16x32_bf16 v[144:147], v[172:175], a[124:127], v[144:147]
    buffer_load_dwordx4 v[68:71], v252, s[4:7], s66 offen offset:0 sc1
    v_mfma_f32_16x16x32_bf16 v[152:155], v[172:175], a[188:191], v[152:155]
    v_mfma_f32_16x16x32_bf16 v[160:163], v[172:175], a[252:255], v[160:163]
    s_lshl_b32 s57, s52, 8
    s_add_u32 s57, s57, 154112
    v_lshl_add_u32 v4, v3, 4, s57
    s_mul_i32 s57, s52, 28672
    v_add_u32 v168, s57, v32
    v_add_u32 v169, s57, v33
    v_add_u32 v170, s57, v34
    v_add_u32 v171, s57, v35
    ds_write_b128 v28, v[144:147] offset:0
    ds_write_b128 v29, v[152:155] offset:0
    ds_write_b128 v30, v[160:163] offset:0
    s_waitcnt vmcnt(9)
    s_waitcnt lgkmcnt(0)
    s_barrier
    s_nop 0
    ds_read_b128 v[208:211], v19 offset:0
    ds_read_b128 v[216:219], v19 offset:2048
    ds_read_b128 v[224:227], v19 offset:4096
    ds_read_b64 v[232:233], v31 offset:3072
    ds_read_b128 v[172:175], v4 offset:0
    ds_read_b128 v[176:179], v4 offset:64
    ds_read_b128 v[180:183], v4 offset:128
    ds_read_b128 v[184:187], v4 offset:192
    ds_read_b64_tr_b16 a[0:1], v168 offset:0
    ds_read_b64_tr_b16 a[2:3], v168 offset:2048
    ds_read_b64_tr_b16 a[4:5], v169 offset:0
    ds_read_b64_tr_b16 a[6:7], v169 offset:2048
    ds_read_b64_tr_b16 a[8:9], v170 offset:0
    ds_read_b64_tr_b16 a[10:11], v170 offset:2048
    s_waitcnt lgkmcnt(12)
    v_add_f32 v208, v208, v216
    v_add_f32 v209, v209, v217
    v_add_f32 v210, v210, v218
    v_add_f32 v211, v211, v219
    s_waitcnt lgkmcnt(11)
    v_add_f32 v224, v224, v136
    v_add_f32 v225, v225, v137
    v_add_f32 v226, v226, v138
    v_add_f32 v227, v227, v139
    s_waitcnt lgkmcnt(10)
    v_lshlrev_b32 v216, 16, v232
    v_and_b32 v217, 0xffff0000, v232
    v_lshlrev_b32_e64 v218, 16, v233
    v_and_b32 v219, 0xffff0000, v233
    v_add_f32 v208, v208, v224
    v_add_f32 v209, v209, v225
    v_add_f32 v210, v210, v226
    v_add_f32 v211, v211, v227
    v_mul_f32 v208, v208, v216
    v_mul_f32 v209, v209, v217
    v_mul_f32 v210, v210, v218
    v_mul_f32 v211, v211, v219
    v_cvt_pk_bf16_f32 v240, v208, v209
    v_cvt_pk_bf16_f32 v241, v210, v211
    v_min_u32 v240, 0xfffffffe, v240
    v_min_u32 v241, 0xfffffffe, v241
    buffer_store_dwordx2 v[240:241], v17, s[4:7], s17 offen offset:3072 sc1
    ds_read_b64_tr_b16 a[12:13], v171 offset:0
    ds_read_b64_tr_b16 a[14:15], v171 offset:2048
    ds_read_b64_tr_b16 a[16:17], v168 offset:14336
    ds_read_b64_tr_b16 a[18:19], v168 offset:16384
    ds_read_b64_tr_b16 a[20:21], v169 offset:14336
    ds_read_b64_tr_b16 a[22:23], v169 offset:16384
    ds_read_b64_tr_b16 a[24:25], v170 offset:14336
    ds_read_b64_tr_b16 a[26:27], v170 offset:16384
    ds_read_b64_tr_b16 a[28:29], v171 offset:14336
    ds_read_b64_tr_b16 a[30:31], v171 offset:16384
    s_load_dwordx2 s[62:63], s[0:1], 112
    buffer_load_dwordx4 v[72:75], v252, s[4:7], s88 offen offset:1024 sc1
    buffer_load_dwordx4 v[80:83], v252, s[4:7], s89 offen offset:1024 sc1
    buffer_load_dwordx4 v[88:91], v252, s[4:7], s90 offen offset:1024 sc1
    buffer_load_dwordx4 v[96:99], v252, s[4:7], s91 offen offset:1024 sc1
    buffer_load_dwordx4 v[76:79], v252, s[4:7], s61 offen offset:1024 sc1
    buffer_load_dwordx4 v[84:87], v252, s[4:7], s64 offen offset:1024 sc1
    buffer_load_dwordx4 v[92:95], v252, s[4:7], s65 offen offset:1024 sc1
    buffer_load_dwordx4 v[100:103], v252, s[4:7], s66 offen offset:1024 sc1
    s_waitcnt vmcnt(17)
    v_max3_u32 v6, v40, v41, v42
    s_waitcnt vmcnt(12)
    v_max3_u32 v7, v43, v44, v45
    v_max3_u32 v7, v7, v46, v47
    v_max3_u32 v6, v6, v48, v49
    v_max3_u32 v7, v7, v50, v51
    s_waitcnt vmcnt(11)
    s_nop 0
    v_max3_u32 v6, v6, v52, v53
    v_max3_u32 v7, v7, v54, v55
    v_max3_u32 v6, v6, v56, v57
    v_max3_u32 v7, v7, v58, v59
    s_waitcnt vmcnt(10)
    s_nop 0
    v_max3_u32 v6, v6, v60, v61
    v_max3_u32 v7, v7, v62, v63
    v_max3_u32 v6, v6, v64, v65
    v_max3_u32 v7, v7, v66, v67
    s_waitcnt vmcnt(9)
    v_max3_u32 v6, v6, v68, v69
    v_max3_u32 v7, v7, v70, v71
    v_max_u32 v6, v6, v7
    v_cmp_eq_u32_e64 vcc, -1, v6
    s_mov_b32 s59, 0
    s_cbranch_vccz adaLN_cond__ssm_conv_s4d__mixer_gmlp__prompt_kernel_std25
adaLN_cond__ssm_conv_s4d__mixer_gmlp__prompt_kernel_st24:
    buffer_load_dwordx4 v[40:43], v252, s[4:7], s88 offen offset:0 sc1
    buffer_load_dwordx4 v[48:51], v252, s[4:7], s89 offen offset:0 sc1
    buffer_load_dwordx4 v[56:59], v252, s[4:7], s90 offen offset:0 sc1
    buffer_load_dwordx4 v[64:67], v252, s[4:7], s91 offen offset:0 sc1
    buffer_load_dwordx4 v[44:47], v252, s[4:7], s61 offen offset:0 sc1
    buffer_load_dwordx4 v[52:55], v252, s[4:7], s64 offen offset:0 sc1
    buffer_load_dwordx4 v[60:63], v252, s[4:7], s65 offen offset:0 sc1
    buffer_load_dwordx4 v[68:71], v252, s[4:7], s66 offen offset:0 sc1
    s_add_u32 s59, s59, 1
    s_waitcnt vmcnt(7)
    v_max3_u32 v6, v40, v41, v42
    s_waitcnt vmcnt(3)
    s_nop 0
    v_max3_u32 v7, v43, v44, v45
    v_max3_u32 v7, v7, v46, v47
    v_max3_u32 v6, v6, v48, v49
    v_max3_u32 v7, v7, v50, v51
    s_waitcnt vmcnt(2)
    s_nop 0
    v_max3_u32 v6, v6, v52, v53
    v_max3_u32 v7, v7, v54, v55
    v_max3_u32 v6, v6, v56, v57
    v_max3_u32 v7, v7, v58, v59
    s_waitcnt vmcnt(1)
    s_nop 0
    v_max3_u32 v6, v6, v60, v61
    v_max3_u32 v7, v7, v62, v63
    v_max3_u32 v6, v6, v64, v65
    v_max3_u32 v7, v7, v66, v67
    s_waitcnt vmcnt(0)
    v_max3_u32 v6, v6, v68, v69
    v_max3_u32 v7, v7, v70, v71
    v_max_u32 v6, v6, v7
    v_cmp_eq_u32_e64 vcc, -1, v6
    s_nop 0
    s_cbranch_vccz adaLN_cond__ssm_conv_s4d__mixer_gmlp__prompt_kernel_std25
    s_cmp_lt_u32 s59, 524288
    s_cbranch_scc1 adaLN_cond__ssm_conv_s4d__mixer_gmlp__prompt_kernel_st24
adaLN_cond__ssm_conv_s4d__mixer_gmlp__prompt_kernel_std25:
    s_waitcnt lgkmcnt(0)
    v_mfma_f32_16x16x32_bf16 v[104:107], a[0:3], v[40:43], 0
    ds_read_b64_tr_b16 a[32:33], v168 offset:4096
    v_mfma_f32_16x16x32_bf16 v[108:111], a[4:7], v[40:43], 0
    ds_read_b64_tr_b16 a[34:35], v168 offset:6144
    v_mfma_f32_16x16x32_bf16 v[112:115], a[8:11], v[40:43], 0
    ds_read_b64_tr_b16 a[36:37], v169 offset:4096
    v_mfma_f32_16x16x32_bf16 v[116:119], a[12:15], v[40:43], 0
    v_mfma_f32_16x16x32_bf16 v[120:123], a[0:3], v[48:51], 0
    ds_read_b64_tr_b16 a[38:39], v169 offset:6144
    v_mfma_f32_16x16x32_bf16 v[124:127], a[4:7], v[48:51], 0
    buffer_load_dwordx4 v[208:211], v252, s[4:7], s88 offen offset:2048 sc1
    v_mfma_f32_16x16x32_bf16 v[128:131], a[8:11], v[48:51], 0
    ds_read_b64_tr_b16 a[40:41], v170 offset:4096
    v_mfma_f32_16x16x32_bf16 v[132:135], a[12:15], v[48:51], 0
    ds_read_b64_tr_b16 a[42:43], v170 offset:6144
    v_mfma_f32_16x16x32_bf16 v[136:139], a[0:3], v[56:59], 0
    ds_read_b64_tr_b16 a[44:45], v171 offset:4096
    v_mfma_f32_16x16x32_bf16 v[140:143], a[4:7], v[56:59], 0
    buffer_load_dwordx4 v[216:219], v252, s[4:7], s89 offen offset:2048 sc1
    v_mfma_f32_16x16x32_bf16 v[144:147], a[8:11], v[56:59], 0
    ds_read_b64_tr_b16 a[46:47], v171 offset:6144
    v_mfma_f32_16x16x32_bf16 v[148:151], a[12:15], v[56:59], 0
    ds_read_b64_tr_b16 a[48:49], v168 offset:18432
    v_mfma_f32_16x16x32_bf16 v[152:155], a[0:3], v[64:67], 0
    ds_read_b64_tr_b16 a[50:51], v168 offset:20480
    v_mfma_f32_16x16x32_bf16 v[156:159], a[4:7], v[64:67], 0
    buffer_load_dwordx4 v[224:227], v252, s[4:7], s90 offen offset:2048 sc1
    v_mfma_f32_16x16x32_bf16 v[160:163], a[8:11], v[64:67], 0
    ds_read_b64_tr_b16 a[52:53], v169 offset:18432
    v_mfma_f32_16x16x32_bf16 v[164:167], a[12:15], v[64:67], 0
    ds_read_b64_tr_b16 a[54:55], v169 offset:20480
    v_mfma_f32_16x16x32_bf16 v[104:107], a[16:19], v[44:47], v[104:107]
    ds_read_b64_tr_b16 a[56:57], v170 offset:18432
    v_mfma_f32_16x16x32_bf16 v[108:111], a[20:23], v[44:47], v[108:111]
    buffer_load_dwordx4 v[188:191], v252, s[4:7], s91 offen offset:2048 sc1
    v_mfma_f32_16x16x32_bf16 v[112:115], a[24:27], v[44:47], v[112:115]
    ds_read_b64_tr_b16 a[58:59], v170 offset:20480
    v_mfma_f32_16x16x32_bf16 v[116:119], a[28:31], v[44:47], v[116:119]
    ds_read_b64_tr_b16 a[60:61], v171 offset:18432
    v_mfma_f32_16x16x32_bf16 v[120:123], a[16:19], v[52:55], v[120:123]
    buffer_load_dwordx4 v[212:215], v252, s[4:7], s61 offen offset:2048 sc1
    v_mfma_f32_16x16x32_bf16 v[124:127], a[20:23], v[52:55], v[124:127]
    ds_read_b64_tr_b16 a[62:63], v171 offset:20480
    v_mfma_f32_16x16x32_bf16 v[128:131], a[24:27], v[52:55], v[128:131]
    ds_read_b64_tr_b16 a[64:65], v168 offset:8192
    v_mfma_f32_16x16x32_bf16 v[132:135], a[28:31], v[52:55], v[132:135]
    ds_read_b64_tr_b16 a[66:67], v168 offset:10240
    v_mfma_f32_16x16x32_bf16 v[136:139], a[16:19], v[60:63], v[136:139]
    buffer_load_dwordx4 v[220:223], v252, s[4:7], s64 offen offset:2048 sc1
    v_mfma_f32_16x16x32_bf16 v[140:143], a[20:23], v[60:63], v[140:143]
    ds_read_b64_tr_b16 a[68:69], v169 offset:8192
    v_mfma_f32_16x16x32_bf16 v[144:147], a[24:27], v[60:63], v[144:147]
    ds_read_b64_tr_b16 a[70:71], v169 offset:10240
    v_mfma_f32_16x16x32_bf16 v[148:151], a[28:31], v[60:63], v[148:151]
    ds_read_b64_tr_b16 a[72:73], v170 offset:8192
    v_mfma_f32_16x16x32_bf16 v[152:155], a[16:19], v[68:71], v[152:155]
    buffer_load_dwordx4 v[228:231], v252, s[4:7], s65 offen offset:2048 sc1
    v_mfma_f32_16x16x32_bf16 v[156:159], a[20:23], v[68:71], v[156:159]
    ds_read_b64_tr_b16 a[74:75], v170 offset:10240
    v_mfma_f32_16x16x32_bf16 v[160:163], a[24:27], v[68:71], v[160:163]
    ds_read_b64_tr_b16 a[76:77], v171 offset:8192
    v_mfma_f32_16x16x32_bf16 v[164:167], a[28:31], v[68:71], v[164:167]
    ds_read_b64_tr_b16 a[78:79], v171 offset:10240
    buffer_load_dwordx4 v[192:195], v252, s[4:7], s66 offen offset:2048 sc1
    s_waitcnt vmcnt(15)
    v_max3_u32 v6, v72, v73, v74
    s_waitcnt vmcnt(11)
    v_max3_u32 v7, v75, v76, v77
    v_max3_u32 v7, v7, v78, v79
    v_max3_u32 v6, v6, v80, v81
    v_max3_u32 v7, v7, v82, v83
    s_waitcnt vmcnt(10)
    s_nop 0
    v_max3_u32 v6, v6, v84, v85
    v_max3_u32 v7, v7, v86, v87
    v_max3_u32 v6, v6, v88, v89
    v_max3_u32 v7, v7, v90, v91
    s_waitcnt vmcnt(9)
    s_nop 0
    v_max3_u32 v6, v6, v92, v93
    v_max3_u32 v7, v7, v94, v95
    v_max3_u32 v6, v6, v96, v97
    v_max3_u32 v7, v7, v98, v99
    s_waitcnt vmcnt(8)
    v_max3_u32 v6, v6, v100, v101
    v_max3_u32 v7, v7, v102, v103
    v_max_u32 v6, v6, v7
    v_cmp_eq_u32_e64 vcc, -1, v6
    s_mov_b32 s59, 0
    s_cbranch_vccz adaLN_cond__ssm_conv_s4d__mixer_gmlp__prompt_kernel_std27
adaLN_cond__ssm_conv_s4d__mixer_gmlp__prompt_kernel_st26:
    buffer_load_dwordx4 v[72:75], v252, s[4:7], s88 offen offset:1024 sc1
    buffer_load_dwordx4 v[80:83], v252, s[4:7], s89 offen offset:1024 sc1
    buffer_load_dwordx4 v[88:91], v252, s[4:7], s90 offen offset:1024 sc1
    buffer_load_dwordx4 v[96:99], v252, s[4:7], s91 offen offset:1024 sc1
    buffer_load_dwordx4 v[76:79], v252, s[4:7], s61 offen offset:1024 sc1
    buffer_load_dwordx4 v[84:87], v252, s[4:7], s64 offen offset:1024 sc1
    buffer_load_dwordx4 v[92:95], v252, s[4:7], s65 offen offset:1024 sc1
    buffer_load_dwordx4 v[100:103], v252, s[4:7], s66 offen offset:1024 sc1
    s_add_u32 s59, s59, 1
    s_waitcnt vmcnt(7)
    v_max3_u32 v6, v72, v73, v74
    s_waitcnt vmcnt(3)
    s_nop 0
    v_max3_u32 v7, v75, v76, v77
    v_max3_u32 v7, v7, v78, v79
    v_max3_u32 v6, v6, v80, v81
    v_max3_u32 v7, v7, v82, v83
    s_waitcnt vmcnt(2)
    s_nop 0
    v_max3_u32 v6, v6, v84, v85
    v_max3_u32 v7, v7, v86, v87
    v_max3_u32 v6, v6, v88, v89
    v_max3_u32 v7, v7, v90, v91
    s_waitcnt vmcnt(1)
    s_nop 0
    v_max3_u32 v6, v6, v92, v93
    v_max3_u32 v7, v7, v94, v95
    v_max3_u32 v6, v6, v96, v97
    v_max3_u32 v7, v7, v98, v99
    s_waitcnt vmcnt(0)
    v_max3_u32 v6, v6, v100, v101
    v_max3_u32 v7, v7, v102, v103
    v_max_u32 v6, v6, v7
    v_cmp_eq_u32_e64 vcc, -1, v6
    s_nop 0
    s_cbranch_vccz adaLN_cond__ssm_conv_s4d__mixer_gmlp__prompt_kernel_std27
    s_cmp_lt_u32 s59, 524288
    s_cbranch_scc1 adaLN_cond__ssm_conv_s4d__mixer_gmlp__prompt_kernel_st26
adaLN_cond__ssm_conv_s4d__mixer_gmlp__prompt_kernel_std27:
    s_waitcnt lgkmcnt(15)
    v_mfma_f32_16x16x32_bf16 v[104:107], a[32:35], v[72:75], v[104:107]
    ds_read_b64_tr_b16 a[80:81], v168 offset:22528
    s_add_u32 s57, s52, 1
    v_mfma_f32_16x16x32_bf16 v[108:111], a[36:39], v[72:75], v[108:111]
    ds_read_b64_tr_b16 a[82:83], v168 offset:24576
    s_and_b32 s57, s57, 3
    v_mfma_f32_16x16x32_bf16 v[112:115], a[40:43], v[72:75], v[112:115]
    ds_read_b64_tr_b16 a[84:85], v169 offset:22528
    v_mfma_f32_16x16x32_bf16 v[116:119], a[44:47], v[72:75], v[116:119]
    s_mul_i32 s57, s57, 12288
    v_mfma_f32_16x16x32_bf16 v[120:123], a[32:35], v[80:83], v[120:123]
    ds_read_b64_tr_b16 a[86:87], v169 offset:24576
    v_mfma_f32_16x16x32_bf16 v[124:127], a[36:39], v[80:83], v[124:127]
    ds_read_b64_tr_b16 a[88:89], v170 offset:22528
    s_add_u32 s57, s57, 114688
    v_mfma_f32_16x16x32_bf16 v[128:131], a[40:43], v[80:83], v[128:131]
    ds_read_b64_tr_b16 a[90:91], v170 offset:24576
    v_mfma_f32_16x16x32_bf16 v[132:135], a[44:47], v[80:83], v[132:135]
    v_add_u32_e64 v28, s57, v252
    v_mfma_f32_16x16x32_bf16 v[136:139], a[32:35], v[88:91], v[136:139]
    ds_read_b64_tr_b16 a[92:93], v171 offset:22528
    s_add_u32 s57, s52, 2
    v_mfma_f32_16x16x32_bf16 v[140:143], a[36:39], v[88:91], v[140:143]
    ds_read_b64_tr_b16 a[94:95], v171 offset:24576
    v_mfma_f32_16x16x32_bf16 v[144:147], a[40:43], v[88:91], v[144:147]
    s_add_u32 s24, s29, 0
    buffer_load_dwordx2 v[232:233], v17, s[4:7], s24 offen offset:3072 sc1
    v_mfma_f32_16x16x32_bf16 v[148:151], a[44:47], v[88:91], v[148:151]
    ds_read_b64_tr_b16 a[96:97], v32 offset:12288
    s_and_b32 s57, s57, 3
    v_mfma_f32_16x16x32_bf16 v[152:155], a[32:35], v[96:99], v[152:155]
    ds_read_b64_tr_b16 a[98:99], v32 offset:26624
    s_mul_i32 s57, s57, 12288
    v_mfma_f32_16x16x32_bf16 v[156:159], a[36:39], v[96:99], v[156:159]
    s_add_u32 s24, s29, 3584
    buffer_load_dwordx2 v[234:235], v17, s[4:7], s24 offen offset:3072 sc1
    v_mfma_f32_16x16x32_bf16 v[160:163], a[40:43], v[96:99], v[160:163]
    ds_read_b64_tr_b16 a[100:101], v33 offset:12288
    s_add_u32 s57, s57, 118784
    v_mfma_f32_16x16x32_bf16 v[164:167], a[44:47], v[96:99], v[164:167]
    ds_read_b64_tr_b16 a[102:103], v33 offset:26624
    s_waitcnt lgkmcnt(15)
    v_mfma_f32_16x16x32_bf16 v[104:107], a[48:51], v[76:79], v[104:107]
    s_add_u32 s24, s29, 7168
    buffer_load_dwordx2 v[236:237], v17, s[4:7], s24 offen offset:3072 sc1
    v_mfma_f32_16x16x32_bf16 v[108:111], a[52:55], v[76:79], v[108:111]
    ds_read_b64_tr_b16 a[104:105], v34 offset:12288
    v_add_u32_e64 v29, s57, v252
    v_mfma_f32_16x16x32_bf16 v[112:115], a[56:59], v[76:79], v[112:115]
    ds_read_b64_tr_b16 a[106:107], v34 offset:26624
    s_add_u32 s57, s52, 3
    v_mfma_f32_16x16x32_bf16 v[116:119], a[60:63], v[76:79], v[116:119]
    ds_read_b64_tr_b16 a[108:109], v35 offset:12288
    s_and_b32 s57, s57, 3
    v_mfma_f32_16x16x32_bf16 v[120:123], a[48:51], v[84:87], v[120:123]
    s_add_u32 s24, s29, 10752
    buffer_load_dwordx2 v[238:239], v17, s[4:7], s24 offen offset:3072 sc1
    v_mfma_f32_16x16x32_bf16 v[124:127], a[52:55], v[84:87], v[124:127]
    ds_read_b64_tr_b16 a[110:111], v35 offset:26624
    s_mul_i32 s57, s57, 12288
    v_mfma_f32_16x16x32_bf16 v[128:131], a[56:59], v[84:87], v[128:131]
    ds_read_b64_tr_b16 a[112:113], v32 offset:40960
    v_mfma_f32_16x16x32_bf16 v[132:135], a[60:63], v[84:87], v[132:135]
    s_add_u32 s24, s29, 14336
    buffer_load_dwordx2 v[240:241], v17, s[4:7], s24 offen offset:3072 sc1
    v_mfma_f32_16x16x32_bf16 v[136:139], a[48:51], v[92:95], v[136:139]
    ds_read_b64_tr_b16 a[114:115], v32 offset:55296
    s_add_u32 s57, s57, 122880
    v_mfma_f32_16x16x32_bf16 v[140:143], a[52:55], v[92:95], v[140:143]
    ds_read_b64_tr_b16 a[116:117], v33 offset:40960
    v_add_u32_e64 v30, s57, v252
    v_mfma_f32_16x16x32_bf16 v[144:147], a[56:59], v[92:95], v[144:147]
    s_add_u32 s24, s29, 17920
    buffer_load_dwordx2 v[242:243], v17, s[4:7], s24 offen offset:3072 sc1
    v_mfma_f32_16x16x32_bf16 v[148:151], a[60:63], v[92:95], v[148:151]
    ds_read_b64_tr_b16 a[118:119], v33 offset:55296
    s_mul_i32 s57, s52, 12288
    v_mfma_f32_16x16x32_bf16 v[152:155], a[48:51], v[100:103], v[152:155]
    ds_read_b64_tr_b16 a[120:121], v34 offset:40960
    s_barrier
    v_mfma_f32_16x16x32_bf16 v[156:159], a[52:55], v[100:103], v[156:159]
    ds_read_b64_tr_b16 a[122:123], v34 offset:55296
    s_add_u32 s57, s57, 114688
    v_mfma_f32_16x16x32_bf16 v[160:163], a[56:59], v[100:103], v[160:163]
    s_add_u32 s24, s29, 21504
    buffer_load_dwordx2 v[244:245], v17, s[4:7], s24 offen offset:3072 sc1
    v_mfma_f32_16x16x32_bf16 v[164:167], a[60:63], v[100:103], v[164:167]
    s_nop 0
    ds_read_b64_tr_b16 a[124:125], v35 offset:40960
    ds_read_b64_tr_b16 a[126:127], v35 offset:55296
    s_add_u32 s24, s29, 25088
    buffer_load_dwordx2 v[246:247], v17, s[4:7], s24 offen offset:3072 sc1
    v_add_u32 v18, s57, v252
    s_waitcnt vmcnt(15)
    v_max3_u32 v6, v208, v209, v210
    s_waitcnt vmcnt(11)
    s_nop 0
    v_max3_u32 v7, v211, v212, v213
    v_max3_u32 v7, v7, v214, v215
    v_max3_u32 v6, v6, v216, v217
    v_max3_u32 v7, v7, v218, v219
    s_waitcnt vmcnt(10)
    s_nop 0
    v_max3_u32 v6, v6, v220, v221
    v_max3_u32 v7, v7, v222, v223
    v_max3_u32 v6, v6, v224, v225
    v_max3_u32 v7, v7, v226, v227
    s_waitcnt vmcnt(9)
    s_nop 0
    v_max3_u32 v6, v6, v228, v229
    v_max3_u32 v7, v7, v230, v231
    v_max3_u32 v6, v6, v188, v189
    v_max3_u32 v7, v7, v190, v191
    s_waitcnt vmcnt(8)
    v_max3_u32 v6, v6, v192, v193
    v_max3_u32 v7, v7, v194, v195
    v_max_u32 v6, v6, v7
    v_cmp_eq_u32_e64 vcc, -1, v6
    s_mov_b32 s59, 0
    s_cbranch_vccz adaLN_cond__ssm_conv_s4d__mixer_gmlp__prompt_kernel_std29
adaLN_cond__ssm_conv_s4d__mixer_gmlp__prompt_kernel_st28:
    buffer_load_dwordx4 v[208:211], v252, s[4:7], s88 offen offset:2048 sc1
    buffer_load_dwordx4 v[216:219], v252, s[4:7], s89 offen offset:2048 sc1
    buffer_load_dwordx4 v[224:227], v252, s[4:7], s90 offen offset:2048 sc1
    buffer_load_dwordx4 v[188:191], v252, s[4:7], s91 offen offset:2048 sc1
    buffer_load_dwordx4 v[212:215], v252, s[4:7], s61 offen offset:2048 sc1
    buffer_load_dwordx4 v[220:223], v252, s[4:7], s64 offen offset:2048 sc1
    buffer_load_dwordx4 v[228:231], v252, s[4:7], s65 offen offset:2048 sc1
    buffer_load_dwordx4 v[192:195], v252, s[4:7], s66 offen offset:2048 sc1
    s_add_u32 s59, s59, 1
    s_waitcnt vmcnt(7)
    v_max3_u32 v6, v208, v209, v210
    s_waitcnt vmcnt(3)
    s_nop 0
    v_max3_u32 v7, v211, v212, v213
    v_max3_u32 v7, v7, v214, v215
    v_max3_u32 v6, v6, v216, v217
    v_max3_u32 v7, v7, v218, v219
    s_waitcnt vmcnt(2)
    s_nop 0
    v_max3_u32 v6, v6, v220, v221
    v_max3_u32 v7, v7, v222, v223
    v_max3_u32 v6, v6, v224, v225
    v_max3_u32 v7, v7, v226, v227
    s_waitcnt vmcnt(1)
    s_nop 0
    v_max3_u32 v6, v6, v228, v229
    v_max3_u32 v7, v7, v230, v231
    v_max3_u32 v6, v6, v188, v189
    v_max3_u32 v7, v7, v190, v191
    s_waitcnt vmcnt(0)
    v_max3_u32 v6, v6, v192, v193
    v_max3_u32 v7, v7, v194, v195
    v_max_u32 v6, v6, v7
    v_cmp_eq_u32_e64 vcc, -1, v6
    s_nop 0
    s_cbranch_vccz adaLN_cond__ssm_conv_s4d__mixer_gmlp__prompt_kernel_std29
    s_cmp_lt_u32 s59, 524288
    s_cbranch_scc1 adaLN_cond__ssm_conv_s4d__mixer_gmlp__prompt_kernel_st28
adaLN_cond__ssm_conv_s4d__mixer_gmlp__prompt_kernel_std29:
    v_mfma_f32_16x16x32_bf16 v[120:123], a[64:67], v[216:219], v[120:123]
    ds_read_b64_tr_b16 a[128:129], v36 offset:4096
    v_mfma_f32_16x16x32_bf16 v[124:127], a[68:71], v[216:219], v[124:127]
    ds_read_b64_tr_b16 a[130:131], v36 offset:18432
    s_waitcnt lgkmcnt(15)
    v_mfma_f32_16x16x32_bf16 v[128:131], a[72:75], v[216:219], v[128:131]
    ds_read_b64_tr_b16 a[132:133], v37 offset:4096
    v_mfma_f32_16x16x32_bf16 v[132:135], a[76:79], v[216:219], v[132:135]
    ds_read_b64_tr_b16 a[134:135], v37 offset:18432
    v_mfma_f32_16x16x32_bf16 v[120:123], a[80:83], v[220:223], v[120:123]
    ds_read_b64_tr_b16 a[136:137], v38 offset:4096
    v_mfma_f32_16x16x32_bf16 v[124:127], a[84:87], v[220:223], v[124:127]
    ds_read_b64_tr_b16 a[138:139], v38 offset:18432
    v_mfma_f32_16x16x32_bf16 v[128:131], a[88:91], v[220:223], v[128:131]
    ds_read_b64_tr_b16 a[140:141], v39 offset:4096
    v_mfma_f32_16x16x32_bf16 v[132:135], a[92:95], v[220:223], v[132:135]
    ds_read_b64_tr_b16 a[142:143], v39 offset:18432
    v_mfma_f32_16x16x32_bf16 v[136:139], a[64:67], v[224:227], v[136:139]
    ds_read_b64_tr_b16 a[144:145], v36 offset:32768
    v_mfma_f32_16x16x32_bf16 v[140:143], a[68:71], v[224:227], v[140:143]
    ds_read_b64_tr_b16 a[146:147], v36 offset:47104
    v_mfma_f32_16x16x32_bf16 v[144:147], a[72:75], v[224:227], v[144:147]
    ds_read_b64_tr_b16 a[148:149], v37 offset:32768
    v_mfma_f32_16x16x32_bf16 v[148:151], a[76:79], v[224:227], v[148:151]
    ds_read_b64_tr_b16 a[150:151], v37 offset:47104
    v_mfma_f32_16x16x32_bf16 v[136:139], a[80:83], v[228:231], v[136:139]
    ds_read_b64_tr_b16 a[152:153], v38 offset:32768
    v_mfma_f32_16x16x32_bf16 v[140:143], a[84:87], v[228:231], v[140:143]
    ds_read_b64_tr_b16 a[154:155], v38 offset:47104
    v_mfma_f32_16x16x32_bf16 v[144:147], a[88:91], v[228:231], v[144:147]
    ds_write_b128 v28, v[120:123] offset:0
    v_mfma_f32_16x16x32_bf16 v[148:151], a[92:95], v[228:231], v[148:151]
    ds_read_b64_tr_b16 a[156:157], v39 offset:32768
    ds_read_b64_tr_b16 a[158:159], v39 offset:47104
    v_mfma_f32_16x16x32_bf16 v[152:155], a[64:67], v[188:191], v[152:155]
    ds_write_b128 v28, v[124:127] offset:1024
    v_mfma_f32_16x16x32_bf16 v[156:159], a[68:71], v[188:191], v[156:159]
    ds_write_b128 v28, v[128:131] offset:2048
    v_mfma_f32_16x16x32_bf16 v[160:163], a[72:75], v[188:191], v[160:163]
    ds_write_b128 v28, v[132:135] offset:3072
    v_mfma_f32_16x16x32_bf16 v[164:167], a[76:79], v[188:191], v[164:167]
    v_mfma_f32_16x16x32_bf16 v[152:155], a[80:83], v[192:195], v[152:155]
    ds_write_b128 v29, v[136:139] offset:0
    v_mfma_f32_16x16x32_bf16 v[156:159], a[84:87], v[192:195], v[156:159]
    v_mfma_f32_16x16x32_bf16 v[160:163], a[88:91], v[192:195], v[160:163]
    ds_write_b128 v29, v[140:143] offset:1024
    v_mfma_f32_16x16x32_bf16 v[164:167], a[92:95], v[192:195], v[164:167]
    v_mfma_f32_16x16x32_bf16 v[104:107], a[64:67], v[208:211], v[104:107]
    ds_write_b128 v29, v[144:147] offset:2048
    v_mfma_f32_16x16x32_bf16 v[108:111], a[68:71], v[208:211], v[108:111]
    v_mfma_f32_16x16x32_bf16 v[112:115], a[72:75], v[208:211], v[112:115]
    ds_write_b128 v29, v[148:151] offset:3072
    v_mfma_f32_16x16x32_bf16 v[116:119], a[76:79], v[208:211], v[116:119]
    v_mfma_f32_16x16x32_bf16 v[104:107], a[80:83], v[212:215], v[104:107]
    ds_write_b128 v30, v[152:155] offset:0
    v_mfma_f32_16x16x32_bf16 v[108:111], a[84:87], v[212:215], v[108:111]
    v_mfma_f32_16x16x32_bf16 v[112:115], a[88:91], v[212:215], v[112:115]
    ds_write_b128 v30, v[156:159] offset:1024
    v_mfma_f32_16x16x32_bf16 v[116:119], a[92:95], v[212:215], v[116:119]
    ds_write_b128 v30, v[160:163] offset:2048
    ds_write_b128 v30, v[164:167] offset:3072
    v_lshlrev_b32_e64 v196, 16, v20
    v_and_b32 v197, 0xffff0000, v20
    v_lshlrev_b32_e64 v198, 16, v21
    v_and_b32 v199, 0xffff0000, v21
    v_lshlrev_b32_e64 v200, 16, v22
    v_and_b32 v201, 0xffff0000, v22
    v_lshlrev_b32_e64 v202, 16, v23
    v_and_b32 v203, 0xffff0000, v23
    v_lshlrev_b32_e64 v8, 16, v24
    v_and_b32 v9, 0xffff0000, v24
    v_lshlrev_b32_e64 v10, 16, v25
    v_and_b32 v11, 0xffff0000, v25
    v_lshlrev_b32_e64 v12, 16, v26
    v_and_b32 v13, 0xffff0000, v26
    v_lshlrev_b32_e64 v14, 16, v27
    v_and_b32 v15, 0xffff0000, v27
    v_and_b32 v4, 1, v3
    v_lshlrev_b32 v4, 5, v4
    v_lshrrev_b32_e64 v5, 1, v3
    v_lshl_add_u32 v4, v5, 4, v4
    v_lshl_add_u32 v16, v16, 10, v4
    s_mov_b32 s12, s62
    s_mov_b32 s13, s63
    s_mov_b32 s14, 0x200000
    s_mov_b32 s15, 0x20000
    s_lshl_b32 s16, s54, 7
    s_waitcnt vmcnt(6)
    v_max3_u32 v6, v232, v233, v234
    s_waitcnt vmcnt(5)
    v_max3_u32 v7, v235, v236, v237
    s_waitcnt vmcnt(4)
    v_max3_u32 v7, v7, v238, v239
    s_waitcnt vmcnt(3)
    v_max3_u32 v6, v6, v240, v241
    s_waitcnt vmcnt(2)
    v_max3_u32 v7, v7, v242, v243
    s_waitcnt vmcnt(1)
    v_max3_u32 v6, v6, v244, v245
    s_waitcnt vmcnt(0)
    v_max3_u32 v7, v7, v246, v247
    v_max_u32 v6, v6, v7
    v_cmp_eq_u32_e64 vcc, -1, v6
    s_mov_b32 s59, 0
    s_cbranch_vccz adaLN_cond__ssm_conv_s4d__mixer_gmlp__prompt_kernel_std31
adaLN_cond__ssm_conv_s4d__mixer_gmlp__prompt_kernel_st30:
    s_add_u32 s24, s29, 0
    buffer_load_dwordx2 v[232:233], v17, s[4:7], s24 offen offset:3072 sc1
    s_add_u32 s24, s29, 3584
    buffer_load_dwordx2 v[234:235], v17, s[4:7], s24 offen offset:3072 sc1
    s_add_u32 s24, s29, 7168
    buffer_load_dwordx2 v[236:237], v17, s[4:7], s24 offen offset:3072 sc1
    s_add_u32 s24, s29, 10752
    buffer_load_dwordx2 v[238:239], v17, s[4:7], s24 offen offset:3072 sc1
    s_add_u32 s24, s29, 14336
    buffer_load_dwordx2 v[240:241], v17, s[4:7], s24 offen offset:3072 sc1
    s_add_u32 s24, s29, 17920
    buffer_load_dwordx2 v[242:243], v17, s[4:7], s24 offen offset:3072 sc1
    s_add_u32 s24, s29, 21504
    buffer_load_dwordx2 v[244:245], v17, s[4:7], s24 offen offset:3072 sc1
    s_add_u32 s24, s29, 25088
    buffer_load_dwordx2 v[246:247], v17, s[4:7], s24 offen offset:3072 sc1
    s_add_u32 s59, s59, 1
    s_waitcnt vmcnt(6)
    v_max3_u32 v6, v232, v233, v234
    s_waitcnt vmcnt(5)
    v_max3_u32 v7, v235, v236, v237
    s_waitcnt vmcnt(4)
    v_max3_u32 v7, v7, v238, v239
    s_waitcnt vmcnt(3)
    v_max3_u32 v6, v6, v240, v241
    s_waitcnt vmcnt(2)
    v_max3_u32 v7, v7, v242, v243
    s_waitcnt vmcnt(1)
    v_max3_u32 v6, v6, v244, v245
    s_waitcnt vmcnt(0)
    v_max3_u32 v7, v7, v246, v247
    v_max_u32 v6, v6, v7
    v_cmp_eq_u32 vcc, -1, v6
    s_nop 0
    s_cbranch_vccz adaLN_cond__ssm_conv_s4d__mixer_gmlp__prompt_kernel_std31
    s_cmp_lt_u32 s59, 524288
    s_cbranch_scc1 adaLN_cond__ssm_conv_s4d__mixer_gmlp__prompt_kernel_st30
adaLN_cond__ssm_conv_s4d__mixer_gmlp__prompt_kernel_std31:
    v_mfma_f32_16x16x32_bf16 v[104:107], a[96:99], v[232:235], v[104:107]
    s_waitcnt lgkmcnt(15)
    v_mfma_f32_16x16x32_bf16 v[108:111], a[100:103], v[232:235], v[108:111]
    v_mfma_f32_16x16x32_bf16 v[112:115], a[104:107], v[232:235], v[112:115]
    v_mfma_f32_16x16x32_bf16 v[116:119], a[108:111], v[232:235], v[116:119]
    v_mfma_f32_16x16x32_bf16 v[104:107], a[112:115], v[236:239], v[104:107]
    v_mfma_f32_16x16x32_bf16 v[108:111], a[116:119], v[236:239], v[108:111]
    v_mfma_f32_16x16x32_bf16 v[112:115], a[120:123], v[236:239], v[112:115]
    v_mfma_f32_16x16x32_bf16 v[116:119], a[124:127], v[236:239], v[116:119]
    v_mfma_f32_16x16x32_bf16 v[104:107], a[128:131], v[240:243], v[104:107]
    v_mfma_f32_16x16x32_bf16 v[108:111], a[132:135], v[240:243], v[108:111]
    v_mfma_f32_16x16x32_bf16 v[112:115], a[136:139], v[240:243], v[112:115]
    v_mfma_f32_16x16x32_bf16 v[116:119], a[140:143], v[240:243], v[116:119]
    v_mfma_f32_16x16x32_bf16 v[104:107], a[144:147], v[244:247], v[104:107]
    v_mfma_f32_16x16x32_bf16 v[108:111], a[148:151], v[244:247], v[108:111]
    s_waitcnt lgkmcnt(14)
    v_mfma_f32_16x16x32_bf16 v[112:115], a[152:155], v[244:247], v[112:115]
    s_waitcnt lgkmcnt(11)
    v_mfma_f32_16x16x32_bf16 v[116:119], a[156:159], v[244:247], v[116:119]
    s_waitcnt lgkmcnt(0)
    s_barrier
    ds_read_b128 v[40:43], v18 offset:0
    ds_read_b128 v[56:59], v18 offset:4096
    ds_read_b128 v[72:75], v18 offset:8192
    ds_read_b128 v[44:47], v18 offset:1024
    ds_read_b128 v[60:63], v18 offset:5120
    ds_read_b128 v[76:79], v18 offset:9216
    ds_read_b128 v[48:51], v18 offset:2048
    ds_read_b128 v[64:67], v18 offset:6144
    ds_read_b128 v[80:83], v18 offset:10240
    ds_read_b128 v[52:55], v18 offset:3072
    ds_read_b128 v[68:71], v18 offset:7168
    ds_read_b128 v[84:87], v18 offset:11264
    s_waitcnt lgkmcnt(10)
    v_pk_add_f32 v[40:41], v[40:41], v[56:57]
    s_waitcnt lgkmcnt(9)
    v_pk_add_f32 v[104:105], v[104:105], v[72:73]
    v_pk_add_f32 v[42:43], v[42:43], v[58:59]
    v_pk_add_f32 v[106:107], v[106:107], v[74:75]
    s_waitcnt lgkmcnt(7)
    v_pk_add_f32 v[44:45], v[44:45], v[60:61]
    s_waitcnt lgkmcnt(6)
    v_pk_add_f32 v[108:109], v[108:109], v[76:77]
    v_pk_add_f32 v[46:47], v[46:47], v[62:63]
    v_pk_add_f32 v[110:111], v[110:111], v[78:79]
    s_waitcnt lgkmcnt(4)
    v_pk_add_f32 v[48:49], v[48:49], v[64:65]
    s_waitcnt lgkmcnt(3)
    v_pk_add_f32 v[112:113], v[112:113], v[80:81]
    v_pk_add_f32 v[50:51], v[50:51], v[66:67]
    v_pk_add_f32 v[114:115], v[114:115], v[82:83]
    s_waitcnt lgkmcnt(1)
    v_pk_add_f32 v[52:53], v[52:53], v[68:69]
    s_waitcnt lgkmcnt(0)
    v_pk_add_f32 v[116:117], v[116:117], v[84:85]
    v_pk_add_f32 v[54:55], v[54:55], v[70:71]
    v_pk_add_f32 v[118:119], v[118:119], v[86:87]
    v_pk_add_f32 v[104:105], v[104:105], v[40:41]
    v_pk_add_f32 v[106:107], v[106:107], v[42:43]
    v_pk_add_f32 v[108:109], v[108:109], v[44:45]
    v_pk_add_f32 v[110:111], v[110:111], v[46:47]
    v_pk_add_f32 v[112:113], v[112:113], v[48:49]
    v_pk_add_f32 v[114:115], v[114:115], v[50:51]
    v_pk_add_f32 v[116:117], v[116:117], v[52:53]
    v_pk_add_f32 v[118:119], v[118:119], v[54:55]
    v_pk_fma_f32 v[104:105], v[104:105], v[172:173], v[196:197]
    v_pk_fma_f32 v[106:107], v[106:107], v[174:175], v[198:199]
    v_pk_fma_f32 v[108:109], v[108:109], v[176:177], v[200:201]
    v_pk_fma_f32 v[110:111], v[110:111], v[178:179], v[202:203]
    v_cvt_pk_bf16_f32 v248, v104, v105
    v_cvt_pk_bf16_f32 v249, v106, v107
    v_cvt_pk_bf16_f32 v250, v108, v109
    v_cvt_pk_bf16_f32 v251, v110, v111
    s_nop 0
    v_permlane16_swap_b32 v248, v250
    v_permlane16_swap_b32 v249, v251
    s_nop 0
    buffer_store_dwordx4 v[248:251], v16, s[12:15], s16 offen offset:0
    v_pk_fma_f32 v[112:113], v[112:113], v[180:181], v[8:9]
    v_pk_fma_f32 v[114:115], v[114:115], v[182:183], v[10:11]
    v_pk_fma_f32 v[116:117], v[116:117], v[184:185], v[12:13]
    v_pk_fma_f32 v[118:119], v[118:119], v[186:187], v[14:15]
    v_cvt_pk_bf16_f32 v204, v112, v113
    v_cvt_pk_bf16_f32 v205, v114, v115
    v_cvt_pk_bf16_f32 v206, v116, v117
    v_cvt_pk_bf16_f32 v207, v118, v119
    s_nop 0
    v_permlane16_swap_b32 v204, v206
    v_permlane16_swap_b32 v205, v207
    buffer_store_dwordx4 v[204:207], v16, s[12:15], s16 offen offset:64
    s_endpgm
adaLN_cond__ssm_conv_s4d__mixer_gmlp__prompt_kernel_end1:
    s_endpgm
.section .rodata,"a"
.p2align 6
.amdhsa_kernel adaLN_cond__ssm_conv_s4d__mixer_gmlp__prompt_kernel
  .amdhsa_next_free_vgpr 512
  .amdhsa_next_free_sgpr 95
  .amdhsa_accum_offset 256
  .amdhsa_group_segment_fixed_size 0
  .amdhsa_kernarg_size 136
  .amdhsa_user_sgpr_count 2
  .amdhsa_user_sgpr_kernarg_segment_ptr 1
  .amdhsa_system_sgpr_workgroup_id_x 1
  .amdhsa_float_denorm_mode_32 3
  .amdhsa_float_denorm_mode_16_64 3
.end_amdhsa_kernel
```
